```python
import torch

def _softmax(x, axis=-1):
    return torch.softmax(x, dim=axis)
def _gelu(x):
    return torch.nn.functional.gelu(x, approximate="tanh")
def _silu(x):
    return torch.nn.functional.silu(x)
def _sigmoid(x):
    return torch.sigmoid(x)
def _layernorm(x, axis=-1, eps=1e-5):
    m = x.mean(dim=axis, keepdim=True)
    v = x.var(dim=axis, keepdim=True, unbiased=False)
    return (x - m) / torch.sqrt(v + eps)
def _scatter_add(tgt, idx, src, axis=0):
    return tgt.clone().index_add_(axis, idx, src)
def _segment_sum(src, seg, n):
    out = torch.zeros((n,) + src.shape[1:], dtype=src.dtype)
    return out.index_add_(0, seg, src)
def _pad(x, pw):
    flat = tuple(v for pair in reversed(pw) for v in pair)
    return torch.nn.functional.pad(x, flat)

kernel_name = 'concat_heads__ssm_conv_h3__compressed_kv_cla__prompt'

def setup_inputs():

    _w = (lambda a: (lambda t: t.to(torch.bfloat16) if t.is_floating_point() else t)(torch.as_tensor(a)))
    def _A_setup():
        B, S, D = 1, 2048, 576
        ks = 4
        return {
            "q": _w((lambda *s: torch.randn(*s, dtype=torch.bfloat16) * 0.05)(B, S, D)),
            "k": _w((lambda *s: torch.randn(*s, dtype=torch.bfloat16) * 0.1)(B, S, D)),
            "v": _w((lambda *s: torch.randn(*s, dtype=torch.bfloat16) * 0.1)(B, S, D)),
            "shift_k": _w((lambda *s: torch.randn(*s, dtype=torch.bfloat16) * 0.1)(D, ks) * 0.5),
            "ssm_k": _w((lambda *s: torch.randn(*s, dtype=torch.bfloat16) * 0.1)(D, S) * (1.0 / S ** 0.5)),
            "ssm_D": _w((lambda *s: torch.randn(*s, dtype=torch.bfloat16) * 0.1)(D)),
        }
    _A_in = _A_setup()

    def _B_setup():
        B, H, Sq, Sk, D, M = 1, 32, 2048, 2048, 128, 576
        Dc = 4 * D
        return {
            "x": _w((lambda *s: torch.randn(*s, dtype=torch.bfloat16) * 3.2)(B, Sq, M)),
            "c_kv": _w((lambda *s: torch.randn(*s, dtype=torch.bfloat16) * 0.05)(B, Sk, Dc)),
            "w_q": _w((lambda *s: torch.randn(*s, dtype=torch.bfloat16) * 3.2)(M, H, D) * (M ** -0.5)),
            "w_uk": _w((lambda *s: torch.randn(*s, dtype=torch.bfloat16) * 3.2)(Dc, H, D) * (Dc ** -0.5)),
            "w_uv": _w((lambda *s: torch.randn(*s, dtype=torch.bfloat16) * 0.05)(Dc, H, D) * (Dc ** -0.5)),
            "w_o": _w((lambda *s: torch.randn(*s, dtype=torch.bfloat16) * 0.05)(H, D, M) * ((H * D) ** -0.5)),
        }
    _B_in = _B_setup()

    return {
        "A_q": _A_in["q"],
        "A_k": _A_in["k"],
        "A_v": _A_in["v"],
        "A_shift_k": _A_in["shift_k"],
        "A_ssm_k": _A_in["ssm_k"],
        "A_ssm_D": _A_in["ssm_D"],
        "B_x": _B_in["x"],
        "B_c_kv": _B_in["c_kv"],
        "B_w_q": _B_in["w_q"],
        "B_w_uk": _B_in["w_uk"],
        "B_w_uv": _B_in["w_uv"],
        "B_w_o": _B_in["w_o"],
    }

def reference(A_q, A_k, A_v, A_shift_k, A_ssm_k, A_ssm_D, B_x, B_c_kv, B_w_q, B_w_uk, B_w_uv, B_w_o):
    def _A_ref(q, k, v, shift_k, ssm_k, ssm_D):
        B, S, D = q.shape
        ks = shift_k.shape[-1]
        k_pad = _pad(k, ((0, 0), (ks - 1, 0), (0, 0)))
        k_shift = torch.zeros_like(k)
        for t in range(ks):
            k_shift = k_shift + k_pad[:, t:t + S, :] * shift_k[:, ks - 1 - t][None, None, :]
        kv = k_shift * v
        L = 2 * S
        kv_pad = _pad(kv, ((0, 0), (0, S), (0, 0)))
        kf_pad = _pad(ssm_k, ((0, 0), (0, S)))
        kv_f = (lambda x, axes=(-2,-1): torch.fft.rfft2(x.float(), dim=axes))(kv_pad[:, None, :, :], axes=(1, 2))
        kf_f = (lambda x, axes=(-2,-1): torch.fft.rfft2(x.float(), dim=axes))(kf_pad[:, None, :], axes=(1, 2))
        kf_f = (lambda x, *d: x.permute(*d))(kf_f, 1, 2, 0)
        y_f = kv_f * kf_f[None, :, :, :]
        y = (lambda x, s, axes=(-2,-1): torch.fft.irfft2(x, s=s, dim=axes).to(torch.bfloat16))(y_f, (1, L), axes=(1, 2))[:, 0, :S, :]
        y = y + kv * ssm_D[None, None, :]
        return q * y

    def _B_ref(x, c_kv, w_q, w_uk, w_uv, w_o):
        B, Sq, M = x.shape[0], x.shape[1], x.shape[2]
        Sk = c_kv.shape[1]
        H, D = w_q.shape[1], w_q.shape[2]
        q = torch.einsum("bqm,mhd->bhqd", x, w_q)
        k = torch.einsum("bkc,chd->bhkd", c_kv, w_uk)
        v = torch.einsum("bkc,chd->bhkd", c_kv, w_uv)
        scores = torch.einsum("bhqd,bhkd->bhqk", q, k) * (D ** -0.5)
        off = Sk - Sq
        qi = torch.arange(Sq)[:, None]
        kj = torch.arange(Sk)[None, :]
        cmask = kj <= (qi + off)
        scores = torch.where(cmask[None, None], scores, -1e9)
        p = _softmax(scores, axis=-1)
        ctx = torch.einsum("bhqk,bhkd->bhqd", p, v)
        return torch.einsum("bhqd,hdm->bqm", ctx, w_o)

    a = _A_ref(A_q, A_k, A_v, A_shift_k, A_ssm_k, A_ssm_D)
    b = _B_ref(B_x, B_c_kv, B_w_q, B_w_uk, B_w_uv, B_w_o)
    return torch.concatenate([a, b], axis=-1)
```

```asm
; @launch grid=(256,1,1) block=(512,1,1) lds=163840
.amdgcn_target "amdgcn-amd-amdhsa--gfx950"
.text
.globl concat_heads__ssm_conv_h3__compressed_kv_cla__prompt_kernel
.p2align 8
.type concat_heads__ssm_conv_h3__compressed_kv_cla__prompt_kernel,@function
concat_heads__ssm_conv_h3__compressed_kv_cla__prompt_kernel:
  s_cmp_ge_u32 s2, 256
  s_cbranch_scc1 F1_END
  s_load_dwordx4 s[44:47], s[0:1], 48
  s_load_dwordx4 s[48:51], s[0:1], 64
  s_load_dwordx2 s[52:53], s[0:1], 80
  s_load_dwordx4 s[56:59], s[0:1], 104
  s_mov_b32 s90, s0
  s_mov_b32 s91, s1
  v_lshrrev_b32 v12, 6, v0
  v_and_b32 v1, 63, v0
  v_readfirstlane_b32 s28, v12
  s_getpc_b64 s[60:61]
F1_CODE0_ct12:
  s_add_u32 s60, s60, F1_CODE0-F1_CODE0_ct12
  s_addc_u32 s61, s61, 0
  v_lshlrev_b32 v12, 7, v0
  v_min_u32 v12, F1_END-F1_CODE0, v12
  v_mov_b32 v13, s61
  v_add_co_u32 v12, vcc, s60, v12
  s_nop 1
  v_addc_co_u32 v13, vcc, 0, v13, vcc
  global_load_dword v15, v[12:13], off
  s_lshr_b32 s29, s2, 3
  s_and_b32 s29, s29, 7
  s_and_b32 s34, s2, 7
  s_lshl_b32 s34, s34, 2
  s_lshr_b32 s35, s2, 6
  s_add_u32 s30, s34, s35
  s_and_b32 s37, s28, 3
  v_lshrrev_b32 v12, 3, v1
  s_lshl_b32 s34, s37, 3
  v_add_u32 v12, s34, v12
  v_lshrrev_b32 v13, 4, v1
  s_and_b32 s34, s28, 1
  s_lshl_b32 s34, s34, 2
  v_add_u32 v14, s34, v13
  v_and_b32 v10, 7, v1
  v_xor_b32 v14, v14, v10
  v_lshlrev_b32 v14, 4, v14
  v_lshl_add_u32 v2, v12, 10, v14
  v_mul_u32_u24 v3, 1152, v12
  v_add_u32 v3, v3, v14
  s_lshl_b32 s34, s37, 2
  v_add_u32 v12, s34, v13
  v_lshlrev_b32 v12, 13, v12
  s_and_b32 s34, s28, 2
  s_lshl_b32 s34, s34, 1
  v_add_u32 v14, s34, v13
  v_lshlrev_b32 v14, 1, v14
  v_and_b32 v10, 15, v1
  v_xor_b32 v14, v14, v10
  v_lshl_add_u32 v4, v14, 4, v12
  s_lshl_b32 s34, s30, 8
  v_add_u32 v4, s34, v4
  s_lshl_b32 s31, s37, 10
  s_lshl_b32 s32, s29, 18
  s_mov_b32 s33, 0
  s_waitcnt lgkmcnt(0)
  s_mov_b32 s8, s46
  s_mov_b32 s9, s47
  s_mov_b32 s10, 2097152
  s_mov_b32 s11, 0x20000
  s_mov_b32 s16, s50
  s_mov_b32 s17, s51
  s_mov_b32 s18, 4194304
  s_mov_b32 s19, 0x20000
  s_mov_b32 s20, s52
  s_mov_b32 s21, s53
  s_mov_b32 s22, 4194304
  s_mov_b32 s23, 0x20000
  s_cmp_ge_u32 s28, 4
  s_cbranch_scc1 F1_I1
  s_add_u32 m0, s31, 32768
  s_add_u32 s34, s33, 0
  buffer_load_dwordx4 v4, s[16:19], s34 offen nt lds
  s_add_u32 m0, s31, 49152
  s_nop 0
  buffer_load_dwordx4 v4, s[20:23], s34 offen nt lds
  s_add_u32 m0, s31, 36864
  s_add_u32 s34, s33, 131072
  buffer_load_dwordx4 v4, s[16:19], s34 offen nt lds
  s_add_u32 m0, s31, 53248
  s_nop 0
  buffer_load_dwordx4 v4, s[20:23], s34 offen nt lds
  s_add_u32 m0, s31, 40960
  s_add_u32 s34, s33, 262144
  buffer_load_dwordx4 v4, s[16:19], s34 offen nt lds
  s_add_u32 m0, s31, 57344
  s_nop 0
  buffer_load_dwordx4 v4, s[20:23], s34 offen nt lds
  s_add_u32 m0, s31, 45056
  s_add_u32 s34, s33, 393216
  buffer_load_dwordx4 v4, s[16:19], s34 offen nt lds
  s_add_u32 m0, s31, 61440
  s_nop 0
  buffer_load_dwordx4 v4, s[20:23], s34 offen nt lds
  s_branch F1_I2
F1_I1:
  s_add_u32 m0, s31, 0
  s_add_u32 s34, s32, 0
  buffer_load_dwordx4 v2, s[8:11], s34 offen  lds
  s_add_u32 m0, s31, 4096
  s_add_u32 s34, s32, 32768
  buffer_load_dwordx4 v2, s[8:11], s34 offen  lds
  s_add_u32 m0, s31, 8192
  s_add_u32 s34, s32, 65536
  buffer_load_dwordx4 v2, s[8:11], s34 offen  lds
  s_add_u32 m0, s31, 12288
  s_add_u32 s34, s32, 98304
  buffer_load_dwordx4 v2, s[8:11], s34 offen  lds
  s_add_u32 m0, s31, 16384
  s_add_u32 s34, s32, 131072
  buffer_load_dwordx4 v2, s[8:11], s34 offen  lds
  s_add_u32 m0, s31, 20480
  s_add_u32 s34, s32, 163840
  buffer_load_dwordx4 v2, s[8:11], s34 offen  lds
  s_add_u32 m0, s31, 24576
  s_add_u32 s34, s32, 196608
  buffer_load_dwordx4 v2, s[8:11], s34 offen  lds
  s_add_u32 m0, s31, 28672
  s_add_u32 s34, s32, 229376
  buffer_load_dwordx4 v2, s[8:11], s34 offen  lds
F1_I2:
  s_add_u32 s32, s32, 128
  s_add_u32 s33, s33, 524288
  s_xor_b32 s31, s31, 0x10000
  s_mov_b32 s12, s44
  s_mov_b32 s13, s45
  s_mov_b32 s14, 2359296
  s_mov_b32 s15, 0x20000
  s_mov_b32 s24, s48
  s_mov_b32 s25, s49
  s_mov_b32 s26, 4718592
  s_mov_b32 s27, 0x20000
  s_mov_b32 s4, s58
  s_mov_b32 s5, s59
  s_mov_b32 s6, 268435456
  s_mov_b32 s7, 0x20000
  s_or_b32 s34, s2, s28
  s_cmp_lg_u32 s34, 0
  s_cbranch_scc1 F1_NOEP
  s_memrealtime s[98:99]
  s_mov_b32 s60, s56
  s_mov_b32 s61, s57
  s_mov_b32 s62, 256
  s_mov_b32 s63, 0x20000
  s_waitcnt lgkmcnt(0)
  s_or_b32 s98, s98, 1
  v_mov_b32 v12, s98
  v_mov_b32 v13, s99
  v_mov_b32 v14, 0
  s_mov_b32 s34, 126877696
  s_mov_b64 exec, 1
  buffer_store_dwordx2 v[12:13], v14, s[60:63], 0 offen sc0 sc1
  buffer_store_dwordx2 v[12:13], v14, s[4:7], s34 offen
  s_mov_b64 exec, -1
  v_lshrrev_b32 v13, 4, v1
F1_NOEP:
  s_mov_b32 s95, 0x20000
  s_cmp_eq_u32 s37, 3
  s_cbranch_scc1 F1_PFQ
  s_cmp_eq_u32 s37, 0
  s_cbranch_scc0 F1_PFW
  v_lshlrev_b32 v9, 7, v1
  s_lshl_b32 s34, s2, 13
  s_cmp_lt_u32 s28, 4
  s_cbranch_scc1 F1_PFC
  buffer_load_dword v15, v9, s[8:11], s34 offen sc1
F1_PFC:
  s_mov_b32 s92, s44
  s_mov_b32 s93, s45
  s_mov_b32 s94, 2359296
  v_min_u32 v9, 11, v1
  v_lshlrev_b32 v9, 7, v9
  s_mul_i32 s96, s2, 9216
  s_mov_b32 s97, 1536
  s_branch F1_PFD
F1_PFW:
  s_cmp_eq_u32 s37, 1
  s_cselect_b32 s92, s50, s52
  s_cselect_b32 s93, s51, s53
  s_mov_b32 s94, 4194304
  s_lshr_b32 s35, s2, 3
  s_and_b32 s36, s2, 7
  s_lshl_b32 s36, s36, 10
  s_lshl_b32 s96, s35, 14
  s_add_u32 s96, s96, s36
  v_bfe_u32 v14, v1, 3, 1
  v_and_b32 v12, 7, v1
  v_lshlrev_b32 v12, 7, v12
  v_lshl_add_u32 v9, v14, 13, v12
  v_lshrrev_b32 v14, 4, v1
  v_min_u32 v14, 0, v14
  v_lshl_add_u32 v12, v14, 19, v9
  s_add_u32 s34, s96, 524288
  s_cmp_lt_u32 s28, 4
  s_cbranch_scc1 F1_PFW2
  buffer_load_dword v15, v12, s[92:95], s34 offen nt
F1_PFW2:
  s_add_u32 s96, s96, 1048576
  s_mov_b32 s97, 524288
  s_branch F1_PFD
F1_PFQ:
  s_mov_b32 s92, s48
  s_mov_b32 s93, s49
  s_mov_b32 s94, 4718592
  v_min_u32 v9, 23, v1
  v_lshlrev_b32 v9, 7, v9
  s_mul_i32 s96, s2, 3072
  s_mov_b32 s97, 786432
  s_cmp_lt_u32 s28, 4
  s_cbranch_scc1 F1_PFD
  buffer_load_dword v15, v9, s[92:95], s96 offen sc1
F1_PFD:
  v_and_b32 v12, 15, v1
  v_lshlrev_b32 v12, 7, v12
  s_lshr_b32 s34, s28, 2
  s_lshl_b32 s34, s34, 14
  v_add_u32 v12, s34, v12
  v_bfe_u32 v14, v1, 1, 3
  v_xor_b32 v14, v14, v13
  v_xor_b32 v11, 0, v14
  v_lshl_add_u32 v5, v11, 4, v12
  v_xor_b32 v11, 4, v14
  v_lshl_add_u32 v6, v11, 4, v12
  s_lshl_b32 s38, s37, 2
  v_bfe_u32 v12, v1, 2, 2
  v_lshl_add_u32 v14, v13, 3, v12
  v_lshlrev_b32 v14, 8, v14
  v_and_b32 v8, 1, v13
  v_lshl_add_u32 v12, v8, 2, v12
  v_lshlrev_b32 v12, 1, v12
  v_xor_b32 v12, s38, v12
  v_lshl_add_u32 v14, v12, 4, v14
  v_and_b32 v12, 3, v1
  v_lshl_add_u32 v7, v12, 3, v14
  v_xor_b32 v8, 32, v7
  v_lshlrev_b32 v11, 4, v1
  v_mov_b32 v16, 0
  v_mov_b32 v17, 0
  v_mov_b32 v18, 0
  v_mov_b32 v19, 0
  v_mov_b32 v20, 0
  v_mov_b32 v21, 0
  v_mov_b32 v22, 0
  v_mov_b32 v23, 0
  v_mov_b32 v24, 0
  v_mov_b32 v25, 0
  v_mov_b32 v26, 0
  v_mov_b32 v27, 0
  v_mov_b32 v28, 0
  v_mov_b32 v29, 0
  v_mov_b32 v30, 0
  v_mov_b32 v31, 0
  v_mov_b32 v32, 0
  v_mov_b32 v33, 0
  v_mov_b32 v34, 0
  v_mov_b32 v35, 0
  v_mov_b32 v36, 0
  v_mov_b32 v37, 0
  v_mov_b32 v38, 0
  v_mov_b32 v39, 0
  v_mov_b32 v40, 0
  v_mov_b32 v41, 0
  v_mov_b32 v42, 0
  v_mov_b32 v43, 0
  v_mov_b32 v44, 0
  v_mov_b32 v45, 0
  v_mov_b32 v46, 0
  v_mov_b32 v47, 0
  v_mov_b32 v48, 0
  v_mov_b32 v49, 0
  v_mov_b32 v50, 0
  v_mov_b32 v51, 0
  v_mov_b32 v52, 0
  v_mov_b32 v53, 0
  v_mov_b32 v54, 0
  v_mov_b32 v55, 0
  v_mov_b32 v56, 0
  v_mov_b32 v57, 0
  v_mov_b32 v58, 0
  v_mov_b32 v59, 0
  v_mov_b32 v60, 0
  v_mov_b32 v61, 0
  v_mov_b32 v62, 0
  v_mov_b32 v63, 0
  v_mov_b32 v64, 0
  v_mov_b32 v65, 0
  v_mov_b32 v66, 0
  v_mov_b32 v67, 0
  v_mov_b32 v68, 0
  v_mov_b32 v69, 0
  v_mov_b32 v70, 0
  v_mov_b32 v71, 0
  v_mov_b32 v72, 0
  v_mov_b32 v73, 0
  v_mov_b32 v74, 0
  v_mov_b32 v75, 0
  v_mov_b32 v76, 0
  v_mov_b32 v77, 0
  v_mov_b32 v78, 0
  v_mov_b32 v79, 0
  v_mov_b32 v80, 0
  v_mov_b32 v81, 0
  v_mov_b32 v82, 0
  v_mov_b32 v83, 0
  v_mov_b32 v84, 0
  v_mov_b32 v85, 0
  v_mov_b32 v86, 0
  v_mov_b32 v87, 0
  v_mov_b32 v88, 0
  v_mov_b32 v89, 0
  v_mov_b32 v90, 0
  v_mov_b32 v91, 0
  v_mov_b32 v92, 0
  v_mov_b32 v93, 0
  v_mov_b32 v94, 0
  v_mov_b32 v95, 0
  v_mov_b32 v96, 0
  v_mov_b32 v97, 0
  v_mov_b32 v98, 0
  v_mov_b32 v99, 0
  v_mov_b32 v100, 0
  v_mov_b32 v101, 0
  v_mov_b32 v102, 0
  v_mov_b32 v103, 0
  v_mov_b32 v104, 0
  v_mov_b32 v105, 0
  v_mov_b32 v106, 0
  v_mov_b32 v107, 0
  v_mov_b32 v108, 0
  v_mov_b32 v109, 0
  v_mov_b32 v110, 0
  v_mov_b32 v111, 0
  v_mov_b32 v112, 0
  v_mov_b32 v113, 0
  v_mov_b32 v114, 0
  v_mov_b32 v115, 0
  v_mov_b32 v116, 0
  v_mov_b32 v117, 0
  v_mov_b32 v118, 0
  v_mov_b32 v119, 0
  v_mov_b32 v120, 0
  v_mov_b32 v121, 0
  v_mov_b32 v122, 0
  v_mov_b32 v123, 0
  v_mov_b32 v124, 0
  v_mov_b32 v125, 0
  v_mov_b32 v126, 0
  v_mov_b32 v127, 0
  v_mov_b32 v128, 0
  v_mov_b32 v129, 0
  v_mov_b32 v130, 0
  v_mov_b32 v131, 0
  v_mov_b32 v132, 0
  v_mov_b32 v133, 0
  v_mov_b32 v134, 0
  v_mov_b32 v135, 0
  v_mov_b32 v136, 0
  v_mov_b32 v137, 0
  v_mov_b32 v138, 0
  v_mov_b32 v139, 0
  v_mov_b32 v140, 0
  v_mov_b32 v141, 0
  v_mov_b32 v142, 0
  v_mov_b32 v143, 0
  v_accvgpr_write_b32 a0, 0
  v_accvgpr_write_b32 a1, 0
  v_accvgpr_write_b32 a2, 0
  v_accvgpr_write_b32 a3, 0
  v_accvgpr_write_b32 a4, 0
  v_accvgpr_write_b32 a5, 0
  v_accvgpr_write_b32 a6, 0
  v_accvgpr_write_b32 a7, 0
  v_accvgpr_write_b32 a8, 0
  v_accvgpr_write_b32 a9, 0
  v_accvgpr_write_b32 a10, 0
  v_accvgpr_write_b32 a11, 0
  v_accvgpr_write_b32 a12, 0
  v_accvgpr_write_b32 a13, 0
  v_accvgpr_write_b32 a14, 0
  v_accvgpr_write_b32 a15, 0
  v_accvgpr_write_b32 a16, 0
  v_accvgpr_write_b32 a17, 0
  v_accvgpr_write_b32 a18, 0
  v_accvgpr_write_b32 a19, 0
  v_accvgpr_write_b32 a20, 0
  v_accvgpr_write_b32 a21, 0
  v_accvgpr_write_b32 a22, 0
  v_accvgpr_write_b32 a23, 0
  v_accvgpr_write_b32 a24, 0
  v_accvgpr_write_b32 a25, 0
  v_accvgpr_write_b32 a26, 0
  v_accvgpr_write_b32 a27, 0
  v_accvgpr_write_b32 a28, 0
  v_accvgpr_write_b32 a29, 0
  v_accvgpr_write_b32 a30, 0
  v_accvgpr_write_b32 a31, 0
  v_accvgpr_write_b32 a32, 0
  v_accvgpr_write_b32 a33, 0
  v_accvgpr_write_b32 a34, 0
  v_accvgpr_write_b32 a35, 0
  v_accvgpr_write_b32 a36, 0
  v_accvgpr_write_b32 a37, 0
  v_accvgpr_write_b32 a38, 0
  v_accvgpr_write_b32 a39, 0
  v_accvgpr_write_b32 a40, 0
  v_accvgpr_write_b32 a41, 0
  v_accvgpr_write_b32 a42, 0
  v_accvgpr_write_b32 a43, 0
  v_accvgpr_write_b32 a44, 0
  v_accvgpr_write_b32 a45, 0
  v_accvgpr_write_b32 a46, 0
  v_accvgpr_write_b32 a47, 0
  v_accvgpr_write_b32 a48, 0
  v_accvgpr_write_b32 a49, 0
  v_accvgpr_write_b32 a50, 0
  v_accvgpr_write_b32 a51, 0
  v_accvgpr_write_b32 a52, 0
  v_accvgpr_write_b32 a53, 0
  v_accvgpr_write_b32 a54, 0
  v_accvgpr_write_b32 a55, 0
  v_accvgpr_write_b32 a56, 0
  v_accvgpr_write_b32 a57, 0
  v_accvgpr_write_b32 a58, 0
  v_accvgpr_write_b32 a59, 0
  v_accvgpr_write_b32 a60, 0
  v_accvgpr_write_b32 a61, 0
  v_accvgpr_write_b32 a62, 0
  v_accvgpr_write_b32 a63, 0
  v_accvgpr_write_b32 a64, 0
  v_accvgpr_write_b32 a65, 0
  v_accvgpr_write_b32 a66, 0
  v_accvgpr_write_b32 a67, 0
  v_accvgpr_write_b32 a68, 0
  v_accvgpr_write_b32 a69, 0
  v_accvgpr_write_b32 a70, 0
  v_accvgpr_write_b32 a71, 0
  v_accvgpr_write_b32 a72, 0
  v_accvgpr_write_b32 a73, 0
  v_accvgpr_write_b32 a74, 0
  v_accvgpr_write_b32 a75, 0
  v_accvgpr_write_b32 a76, 0
  v_accvgpr_write_b32 a77, 0
  v_accvgpr_write_b32 a78, 0
  v_accvgpr_write_b32 a79, 0
  v_accvgpr_write_b32 a80, 0
  v_accvgpr_write_b32 a81, 0
  v_accvgpr_write_b32 a82, 0
  v_accvgpr_write_b32 a83, 0
  v_accvgpr_write_b32 a84, 0
  v_accvgpr_write_b32 a85, 0
  v_accvgpr_write_b32 a86, 0
  v_accvgpr_write_b32 a87, 0
  v_accvgpr_write_b32 a88, 0
  v_accvgpr_write_b32 a89, 0
  v_accvgpr_write_b32 a90, 0
  v_accvgpr_write_b32 a91, 0
  v_accvgpr_write_b32 a92, 0
  v_accvgpr_write_b32 a93, 0
  v_accvgpr_write_b32 a94, 0
  v_accvgpr_write_b32 a95, 0
  v_accvgpr_write_b32 a96, 0
  v_accvgpr_write_b32 a97, 0
  v_accvgpr_write_b32 a98, 0
  v_accvgpr_write_b32 a99, 0
  v_accvgpr_write_b32 a100, 0
  v_accvgpr_write_b32 a101, 0
  v_accvgpr_write_b32 a102, 0
  v_accvgpr_write_b32 a103, 0
  v_accvgpr_write_b32 a104, 0
  v_accvgpr_write_b32 a105, 0
  v_accvgpr_write_b32 a106, 0
  v_accvgpr_write_b32 a107, 0
  v_accvgpr_write_b32 a108, 0
  v_accvgpr_write_b32 a109, 0
  v_accvgpr_write_b32 a110, 0
  v_accvgpr_write_b32 a111, 0
  s_load_dwordx2 s[44:45], s[90:91], 8
  s_load_dwordx2 s[48:49], s[90:91], 16
  s_load_dwordx2 s[52:53], s[90:91], 0
  s_mov_b32 s46, 2359296
  s_mov_b32 s47, 0x20000
  s_mov_b32 s50, 2359296
  s_mov_b32 s51, 0x20000
  s_mov_b32 s54, 2359296
  s_mov_b32 s55, 0x20000
  s_mov_b32 s41, 0
  s_waitcnt vmcnt(1) lgkmcnt(0)
  s_cmp_ge_u32 s28, 4
  s_cbranch_scc1 F1_KVENTRY1
  s_setprio 1
  s_waitcnt vmcnt(0)
  s_branch F1_KVENTRY0
F1_CODE0:
F1_KVLOOP0:
  s_waitcnt vmcnt(0) lgkmcnt(0)
F1_KVENTRY0:
  s_barrier
  v_mfma_f32_16x16x32_bf16 a[24:27], a[80:83], a[104:107], a[24:27]
  ds_read_b64_tr_b16 a[64:65], v7 offset:32768
  ds_read_b64_tr_b16 a[66:67], v7 offset:33792
  v_mfma_f32_16x16x32_bf16 a[56:59], a[84:87], a[104:107], a[56:59]
  ds_read_b64_tr_b16 a[68:69], v8 offset:32768
  ds_read_b64_tr_b16 a[70:71], v8 offset:33792
  v_mfma_f32_16x16x32_bf16 v[64:67], a[104:107], a[88:91], v[64:67]
  ds_read_b128 a[96:99], v5 offset:0
  v_mfma_f32_16x16x32_bf16 v[68:71], a[104:107], a[92:95], v[68:71]
  ds_read_b64_tr_b16 a[72:73], v7 offset:49152
  ds_read_b128 a[104:107], v5 offset:4096
  v_mfma_f32_16x16x32_bf16 a[28:31], a[80:83], a[108:111], a[28:31]
  ds_read_b64_tr_b16 a[74:75], v7 offset:50176
  v_mfma_f32_16x16x32_bf16 a[60:63], a[84:87], a[108:111], a[60:63]
  ds_read_b64_tr_b16 a[76:77], v8 offset:49152
  v_mfma_f32_16x16x32_bf16 v[72:75], a[108:111], a[88:91], v[72:75]
  ds_read_b64_tr_b16 a[78:79], v8 offset:50176
  v_mfma_f32_16x16x32_bf16 v[76:79], a[108:111], a[92:95], v[76:79]
  ds_read_b128 a[100:103], v5 offset:2048
  ds_read_b128 a[108:111], v5 offset:6144
  s_waitcnt lgkmcnt(2)
  v_mfma_f32_16x16x32_bf16 a[0:3], a[64:67], a[96:99], a[0:3]
  ds_read_b64_tr_b16 a[80:81], v7 offset:40960
  v_mfma_f32_16x16x32_bf16 a[32:35], a[68:71], a[96:99], a[32:35]
  ds_read_b64_tr_b16 a[82:83], v7 offset:41984
  v_mfma_f32_16x16x32_bf16 v[16:19], a[96:99], a[72:75], v[16:19]
  s_add_u32 m0, s31, 32768
  s_add_u32 s34, s33, 0
  buffer_load_dwordx4 v4, s[16:19], s34 offen nt lds
  v_mfma_f32_16x16x32_bf16 v[20:23], a[96:99], a[76:79], v[20:23]
  ds_read_b128 a[96:99], v5 offset:8192
  s_add_u32 m0, s31, 49152
  s_nop 0
  buffer_load_dwordx4 v4, s[20:23], s34 offen nt lds
  s_waitcnt lgkmcnt(4)
  v_mfma_f32_16x16x32_bf16 a[4:7], a[64:67], a[100:103], a[4:7]
  ds_read_b64_tr_b16 a[84:85], v8 offset:40960
  v_mfma_f32_16x16x32_bf16 a[36:39], a[68:71], a[100:103], a[36:39]
  ds_read_b64_tr_b16 a[86:87], v8 offset:41984
  v_mfma_f32_16x16x32_bf16 v[24:27], a[100:103], a[72:75], v[24:27]
  s_add_u32 m0, s31, 36864
  s_add_u32 s34, s33, 131072
  buffer_load_dwordx4 v4, s[16:19], s34 offen nt lds
  v_mfma_f32_16x16x32_bf16 v[28:31], a[100:103], a[76:79], v[28:31]
  ds_read_b128 a[100:103], v5 offset:10240
  s_add_u32 m0, s31, 53248
  s_nop 0
  buffer_load_dwordx4 v4, s[20:23], s34 offen nt lds
  s_waitcnt lgkmcnt(8)
  v_mfma_f32_16x16x32_bf16 a[8:11], a[64:67], a[104:107], a[8:11]
  ds_read_b64_tr_b16 a[88:89], v7 offset:57344
  v_mfma_f32_16x16x32_bf16 a[40:43], a[68:71], a[104:107], a[40:43]
  ds_read_b64_tr_b16 a[90:91], v7 offset:58368
  v_mfma_f32_16x16x32_bf16 v[32:35], a[104:107], a[72:75], v[32:35]
  s_add_u32 m0, s31, 40960
  s_add_u32 s34, s33, 262144
  buffer_load_dwordx4 v4, s[16:19], s34 offen nt lds
  v_mfma_f32_16x16x32_bf16 v[36:39], a[104:107], a[76:79], v[36:39]
  ds_read_b128 a[104:107], v5 offset:12288
  s_add_u32 m0, s31, 57344
  s_nop 0
  buffer_load_dwordx4 v4, s[20:23], s34 offen nt lds
  s_waitcnt lgkmcnt(9)
  v_mfma_f32_16x16x32_bf16 a[12:15], a[64:67], a[108:111], a[12:15]
  ds_read_b64_tr_b16 a[92:93], v8 offset:57344
  v_mfma_f32_16x16x32_bf16 a[44:47], a[68:71], a[108:111], a[44:47]
  ds_read_b64_tr_b16 a[94:95], v8 offset:58368
  v_mfma_f32_16x16x32_bf16 v[40:43], a[108:111], a[72:75], v[40:43]
  s_add_u32 m0, s31, 45056
  s_add_u32 s34, s33, 393216
  buffer_load_dwordx4 v4, s[16:19], s34 offen nt lds
  v_mfma_f32_16x16x32_bf16 v[44:47], a[108:111], a[76:79], v[44:47]
  ds_read_b128 a[108:111], v5 offset:14336
  s_add_u32 m0, s31, 61440
  s_nop 0
  buffer_load_dwordx4 v4, s[20:23], s34 offen nt lds
  s_waitcnt lgkmcnt(9)
  v_mfma_f32_16x16x32_bf16 a[16:19], a[64:67], a[96:99], a[16:19]
  v_mfma_f32_16x16x32_bf16 a[48:51], a[68:71], a[96:99], a[48:51]
  v_mfma_f32_16x16x32_bf16 v[48:51], a[96:99], a[72:75], v[48:51]
  s_add_u32 m0, s31, 0
  s_add_u32 s34, s32, 0
  buffer_load_dwordx4 v2, s[8:11], s34 offen  lds
  v_mfma_f32_16x16x32_bf16 v[52:55], a[96:99], a[76:79], v[52:55]
  ds_read_b128 a[96:99], v6 offset:0
  s_add_u32 m0, s31, 4096
  s_add_u32 s34, s32, 32768
  buffer_load_dwordx4 v2, s[8:11], s34 offen  lds
  s_waitcnt lgkmcnt(7)
  v_mfma_f32_16x16x32_bf16 a[20:23], a[64:67], a[100:103], a[20:23]
  v_mfma_f32_16x16x32_bf16 a[52:55], a[68:71], a[100:103], a[52:55]
  v_mfma_f32_16x16x32_bf16 v[56:59], a[100:103], a[72:75], v[56:59]
  s_add_u32 m0, s31, 8192
  s_add_u32 s34, s32, 65536
  buffer_load_dwordx4 v2, s[8:11], s34 offen  lds
  v_mfma_f32_16x16x32_bf16 v[60:63], a[100:103], a[76:79], v[60:63]
  ds_read_b128 a[100:103], v6 offset:2048
  s_add_u32 m0, s31, 12288
  s_add_u32 s34, s32, 98304
  buffer_load_dwordx4 v2, s[8:11], s34 offen  lds
  s_waitcnt lgkmcnt(5)
  v_mfma_f32_16x16x32_bf16 a[24:27], a[64:67], a[104:107], a[24:27]
  v_mfma_f32_16x16x32_bf16 a[56:59], a[68:71], a[104:107], a[56:59]
  v_mfma_f32_16x16x32_bf16 v[64:67], a[104:107], a[72:75], v[64:67]
  s_add_u32 m0, s31, 16384
  s_add_u32 s34, s32, 131072
  buffer_load_dwordx4 v2, s[8:11], s34 offen  lds
  v_mfma_f32_16x16x32_bf16 v[68:71], a[104:107], a[76:79], v[68:71]
  ds_read_b128 a[104:107], v6 offset:4096
  s_add_u32 m0, s31, 20480
  s_add_u32 s34, s32, 163840
  buffer_load_dwordx4 v2, s[8:11], s34 offen  lds
  s_waitcnt lgkmcnt(3)
  v_mfma_f32_16x16x32_bf16 a[28:31], a[64:67], a[108:111], a[28:31]
  v_mfma_f32_16x16x32_bf16 a[60:63], a[68:71], a[108:111], a[60:63]
  v_mfma_f32_16x16x32_bf16 v[72:75], a[108:111], a[72:75], v[72:75]
  s_add_u32 m0, s31, 24576
  s_add_u32 s34, s32, 196608
  buffer_load_dwordx4 v2, s[8:11], s34 offen  lds
  v_mfma_f32_16x16x32_bf16 v[76:79], a[108:111], a[76:79], v[76:79]
  ds_read_b128 a[108:111], v6 offset:6144
  s_add_u32 m0, s31, 28672
  s_add_u32 s34, s32, 229376
  buffer_load_dwordx4 v2, s[8:11], s34 offen  lds
  s_add_u32 s32, s32, 128
  s_add_u32 s33, s33, 524288
  s_xor_b32 s31, s31, 0x10000
  s_waitcnt lgkmcnt(3)
  v_mfma_f32_16x16x32_bf16 a[0:3], a[80:83], a[96:99], a[0:3]
  v_mfma_f32_16x16x32_bf16 a[32:35], a[84:87], a[96:99], a[32:35]
  v_mfma_f32_16x16x32_bf16 v[16:19], a[96:99], a[88:91], v[16:19]
  v_mfma_f32_16x16x32_bf16 v[20:23], a[96:99], a[92:95], v[20:23]
  ds_read_b128 a[96:99], v6 offset:8192
  s_waitcnt lgkmcnt(3)
  v_mfma_f32_16x16x32_bf16 a[4:7], a[80:83], a[100:103], a[4:7]
  v_mfma_f32_16x16x32_bf16 a[36:39], a[84:87], a[100:103], a[36:39]
  v_mfma_f32_16x16x32_bf16 v[24:27], a[100:103], a[88:91], v[24:27]
  v_mfma_f32_16x16x32_bf16 v[28:31], a[100:103], a[92:95], v[28:31]
  ds_read_b128 a[100:103], v6 offset:10240
  s_waitcnt lgkmcnt(3)
  v_mfma_f32_16x16x32_bf16 a[8:11], a[80:83], a[104:107], a[8:11]
  v_mfma_f32_16x16x32_bf16 a[40:43], a[84:87], a[104:107], a[40:43]
  v_mfma_f32_16x16x32_bf16 v[32:35], a[104:107], a[88:91], v[32:35]
  v_mfma_f32_16x16x32_bf16 v[36:39], a[104:107], a[92:95], v[36:39]
  ds_read_b128 a[104:107], v6 offset:12288
  s_waitcnt lgkmcnt(3)
  v_mfma_f32_16x16x32_bf16 a[12:15], a[80:83], a[108:111], a[12:15]
  v_mfma_f32_16x16x32_bf16 a[44:47], a[84:87], a[108:111], a[44:47]
  v_mfma_f32_16x16x32_bf16 v[40:43], a[108:111], a[88:91], v[40:43]
  v_mfma_f32_16x16x32_bf16 v[44:47], a[108:111], a[92:95], v[44:47]
  ds_read_b128 a[108:111], v6 offset:14336
  s_waitcnt lgkmcnt(3)
  v_mfma_f32_16x16x32_bf16 a[16:19], a[80:83], a[96:99], a[16:19]
  v_mfma_f32_16x16x32_bf16 a[48:51], a[84:87], a[96:99], a[48:51]
  v_mfma_f32_16x16x32_bf16 v[48:51], a[96:99], a[88:91], v[48:51]
  v_mfma_f32_16x16x32_bf16 v[52:55], a[96:99], a[92:95], v[52:55]
  s_waitcnt lgkmcnt(2)
  v_mfma_f32_16x16x32_bf16 a[20:23], a[80:83], a[100:103], a[20:23]
  v_mfma_f32_16x16x32_bf16 a[52:55], a[84:87], a[100:103], a[52:55]
  v_mfma_f32_16x16x32_bf16 v[56:59], a[100:103], a[88:91], v[56:59]
  v_mfma_f32_16x16x32_bf16 v[60:63], a[100:103], a[92:95], v[60:63]
  v_xor_b32 v5, 0x10000, v5
  v_xor_b32 v6, 0x10000, v6
  v_xor_b32 v7, 0x10000, v7
  v_xor_b32 v8, 0x10000, v8
  s_add_u32 s41, s41, 1
  s_cmp_lt_u32 s41, 7
  s_cbranch_scc1 F1_KVLOOP0
  s_mul_i32 s32, s29, 147456
  s_sub_u32 s36, 2211840, s32
  s_lshl_b32 s31, s37, 10
  s_waitcnt vmcnt(0) lgkmcnt(0)
  s_barrier
  v_mfma_f32_16x16x32_bf16 a[24:27], a[80:83], a[104:107], a[24:27]
  ds_read_b64_tr_b16 a[64:65], v7 offset:32768
  ds_read_b64_tr_b16 a[66:67], v7 offset:33792
  v_mfma_f32_16x16x32_bf16 a[56:59], a[84:87], a[104:107], a[56:59]
  ds_read_b64_tr_b16 a[68:69], v8 offset:32768
  ds_read_b64_tr_b16 a[70:71], v8 offset:33792
  v_mfma_f32_16x16x32_bf16 v[64:67], a[104:107], a[88:91], v[64:67]
  ds_read_b128 a[96:99], v5 offset:0
  v_mfma_f32_16x16x32_bf16 v[68:71], a[104:107], a[92:95], v[68:71]
  ds_read_b64_tr_b16 a[72:73], v7 offset:49152
  ds_read_b128 a[104:107], v5 offset:4096
  v_mfma_f32_16x16x32_bf16 a[28:31], a[80:83], a[108:111], a[28:31]
  ds_read_b64_tr_b16 a[74:75], v7 offset:50176
  v_mfma_f32_16x16x32_bf16 a[60:63], a[84:87], a[108:111], a[60:63]
  ds_read_b64_tr_b16 a[76:77], v8 offset:49152
  v_mfma_f32_16x16x32_bf16 v[72:75], a[108:111], a[88:91], v[72:75]
  ds_read_b64_tr_b16 a[78:79], v8 offset:50176
  v_mfma_f32_16x16x32_bf16 v[76:79], a[108:111], a[92:95], v[76:79]
  ds_read_b128 a[100:103], v5 offset:2048
  ds_read_b128 a[108:111], v5 offset:6144
  s_waitcnt lgkmcnt(2)
  v_mfma_f32_16x16x32_bf16 a[0:3], a[64:67], a[96:99], a[0:3]
  ds_read_b64_tr_b16 a[80:81], v7 offset:40960
  v_mfma_f32_16x16x32_bf16 a[32:35], a[68:71], a[96:99], a[32:35]
  ds_read_b64_tr_b16 a[82:83], v7 offset:41984
  v_mfma_f32_16x16x32_bf16 v[16:19], a[96:99], a[72:75], v[16:19]
  s_add_u32 m0, s31, 32768
  s_mov_b32 s34, 0
  buffer_load_dwordx4 v4, s[24:27], s34 offen  lds
  v_mfma_f32_16x16x32_bf16 v[20:23], a[96:99], a[76:79], v[20:23]
  ds_read_b128 a[96:99], v5 offset:8192
  s_add_u32 m0, s31, 36864
  s_mov_b32 s34, 131072
  buffer_load_dwordx4 v4, s[24:27], s34 offen  lds
  s_waitcnt lgkmcnt(4)
  v_mfma_f32_16x16x32_bf16 a[4:7], a[64:67], a[100:103], a[4:7]
  ds_read_b64_tr_b16 a[84:85], v8 offset:40960
  v_mfma_f32_16x16x32_bf16 a[36:39], a[68:71], a[100:103], a[36:39]
  ds_read_b64_tr_b16 a[86:87], v8 offset:41984
  v_mfma_f32_16x16x32_bf16 v[24:27], a[100:103], a[72:75], v[24:27]
  s_add_u32 m0, s31, 40960
  s_mov_b32 s34, 262144
  buffer_load_dwordx4 v4, s[24:27], s34 offen  lds
  v_mfma_f32_16x16x32_bf16 v[28:31], a[100:103], a[76:79], v[28:31]
  ds_read_b128 a[100:103], v5 offset:10240
  s_add_u32 m0, s31, 45056
  s_mov_b32 s34, 393216
  buffer_load_dwordx4 v4, s[24:27], s34 offen  lds
  s_waitcnt lgkmcnt(8)
  v_mfma_f32_16x16x32_bf16 a[8:11], a[64:67], a[104:107], a[8:11]
  ds_read_b64_tr_b16 a[88:89], v7 offset:57344
  v_mfma_f32_16x16x32_bf16 a[40:43], a[68:71], a[104:107], a[40:43]
  ds_read_b64_tr_b16 a[90:91], v7 offset:58368
  v_mfma_f32_16x16x32_bf16 v[32:35], a[104:107], a[72:75], v[32:35]
  s_add_u32 m0, s31, 0
  s_add_u32 s34, s32, 0
  buffer_load_dwordx4 v3, s[12:15], s34 offen  lds
  v_mfma_f32_16x16x32_bf16 v[36:39], a[104:107], a[76:79], v[36:39]
  ds_read_b128 a[104:107], v5 offset:12288
  s_add_u32 m0, s31, 4096
  s_add_u32 s34, s32, 36864
  buffer_load_dwordx4 v3, s[12:15], s34 offen  lds
  s_waitcnt lgkmcnt(9)
  v_mfma_f32_16x16x32_bf16 a[12:15], a[64:67], a[108:111], a[12:15]
  ds_read_b64_tr_b16 a[92:93], v8 offset:57344
  v_mfma_f32_16x16x32_bf16 a[44:47], a[68:71], a[108:111], a[44:47]
  ds_read_b64_tr_b16 a[94:95], v8 offset:58368
  v_mfma_f32_16x16x32_bf16 v[40:43], a[108:111], a[72:75], v[40:43]
  s_add_u32 m0, s31, 8192
  s_add_u32 s34, s32, 73728
  buffer_load_dwordx4 v3, s[12:15], s34 offen  lds
  v_mfma_f32_16x16x32_bf16 v[44:47], a[108:111], a[76:79], v[44:47]
  ds_read_b128 a[108:111], v5 offset:14336
  s_add_u32 m0, s31, 12288
  s_add_u32 s34, s32, 110592
  buffer_load_dwordx4 v3, s[12:15], s34 offen  lds
  s_waitcnt lgkmcnt(9)
  v_mfma_f32_16x16x32_bf16 a[16:19], a[64:67], a[96:99], a[16:19]
  v_mfma_f32_16x16x32_bf16 a[48:51], a[68:71], a[96:99], a[48:51]
  v_mfma_f32_16x16x32_bf16 v[48:51], a[96:99], a[72:75], v[48:51]
  s_add_u32 m0, s31, 16384
  s_add_u32 s34, s36, 0
  buffer_load_dwordx4 v3, s[12:15], s34 offen  lds
  v_mfma_f32_16x16x32_bf16 v[52:55], a[96:99], a[76:79], v[52:55]
  ds_read_b128 a[96:99], v6 offset:0
  s_add_u32 m0, s31, 20480
  s_add_u32 s34, s36, 36864
  buffer_load_dwordx4 v3, s[12:15], s34 offen  lds
  s_waitcnt lgkmcnt(7)
  v_mfma_f32_16x16x32_bf16 a[20:23], a[64:67], a[100:103], a[20:23]
  v_mfma_f32_16x16x32_bf16 a[52:55], a[68:71], a[100:103], a[52:55]
  v_mfma_f32_16x16x32_bf16 v[56:59], a[100:103], a[72:75], v[56:59]
  s_add_u32 m0, s31, 24576
  s_add_u32 s34, s36, 73728
  buffer_load_dwordx4 v3, s[12:15], s34 offen  lds
  v_mfma_f32_16x16x32_bf16 v[60:63], a[100:103], a[76:79], v[60:63]
  ds_read_b128 a[100:103], v6 offset:2048
  s_add_u32 m0, s31, 28672
  s_add_u32 s34, s36, 110592
  buffer_load_dwordx4 v3, s[12:15], s34 offen  lds
  s_waitcnt lgkmcnt(5)
  v_mfma_f32_16x16x32_bf16 a[24:27], a[64:67], a[104:107], a[24:27]
  v_mfma_f32_16x16x32_bf16 a[56:59], a[68:71], a[104:107], a[56:59]
  v_mfma_f32_16x16x32_bf16 v[64:67], a[104:107], a[72:75], v[64:67]
  s_add_u32 m0, s31, 49152
  s_mov_b32 s34, 524288
  buffer_load_dwordx4 v4, s[24:27], s34 offen  lds
  v_mfma_f32_16x16x32_bf16 v[68:71], a[104:107], a[76:79], v[68:71]
  ds_read_b128 a[104:107], v6 offset:4096
  s_add_u32 m0, s31, 53248
  s_mov_b32 s34, 655360
  buffer_load_dwordx4 v4, s[24:27], s34 offen  lds
  s_waitcnt lgkmcnt(3)
  v_mfma_f32_16x16x32_bf16 a[28:31], a[64:67], a[108:111], a[28:31]
  v_mfma_f32_16x16x32_bf16 a[60:63], a[68:71], a[108:111], a[60:63]
  v_mfma_f32_16x16x32_bf16 v[72:75], a[108:111], a[72:75], v[72:75]
  s_add_u32 m0, s31, 57344
  s_mov_b32 s34, 786432
  buffer_load_dwordx4 v4, s[24:27], s34 offen  lds
  v_mfma_f32_16x16x32_bf16 v[76:79], a[108:111], a[76:79], v[76:79]
  ds_read_b128 a[108:111], v6 offset:6144
  s_add_u32 m0, s31, 61440
  s_mov_b32 s34, 917504
  buffer_load_dwordx4 v4, s[24:27], s34 offen  lds
  s_waitcnt lgkmcnt(3)
  v_mfma_f32_16x16x32_bf16 a[0:3], a[80:83], a[96:99], a[0:3]
  v_mfma_f32_16x16x32_bf16 a[32:35], a[84:87], a[96:99], a[32:35]
  v_mfma_f32_16x16x32_bf16 v[16:19], a[96:99], a[88:91], v[16:19]
  s_add_u32 m0, s31, 131072
  s_add_u32 s34, s32, 128
  buffer_load_dwordx4 v3, s[12:15], s34 offen  lds
  v_mfma_f32_16x16x32_bf16 v[20:23], a[96:99], a[92:95], v[20:23]
  ds_read_b128 a[96:99], v6 offset:8192
  s_add_u32 m0, s31, 135168
  s_add_u32 s34, s32, 36992
  buffer_load_dwordx4 v3, s[12:15], s34 offen  lds
  s_waitcnt lgkmcnt(3)
  v_mfma_f32_16x16x32_bf16 a[4:7], a[80:83], a[100:103], a[4:7]
  v_mfma_f32_16x16x32_bf16 a[36:39], a[84:87], a[100:103], a[36:39]
  v_mfma_f32_16x16x32_bf16 v[24:27], a[100:103], a[88:91], v[24:27]
  s_add_u32 m0, s31, 139264
  s_add_u32 s34, s32, 73856
  buffer_load_dwordx4 v3, s[12:15], s34 offen  lds
  v_mfma_f32_16x16x32_bf16 v[28:31], a[100:103], a[92:95], v[28:31]
  ds_read_b128 a[100:103], v6 offset:10240
  s_add_u32 m0, s31, 143360
  s_add_u32 s34, s32, 110720
  buffer_load_dwordx4 v3, s[12:15], s34 offen  lds
  s_waitcnt lgkmcnt(3)
  v_mfma_f32_16x16x32_bf16 a[8:11], a[80:83], a[104:107], a[8:11]
  v_mfma_f32_16x16x32_bf16 a[40:43], a[84:87], a[104:107], a[40:43]
  v_mfma_f32_16x16x32_bf16 v[32:35], a[104:107], a[88:91], v[32:35]
  s_add_u32 m0, s31, 147456
  s_add_u32 s34, s36, 128
  buffer_load_dwordx4 v3, s[12:15], s34 offen  lds
  v_mfma_f32_16x16x32_bf16 v[36:39], a[104:107], a[92:95], v[36:39]
  ds_read_b128 a[104:107], v6 offset:12288
  s_waitcnt lgkmcnt(3)
  v_mfma_f32_16x16x32_bf16 a[12:15], a[80:83], a[108:111], a[12:15]
  v_mfma_f32_16x16x32_bf16 a[44:47], a[84:87], a[108:111], a[44:47]
  v_mfma_f32_16x16x32_bf16 v[40:43], a[108:111], a[88:91], v[40:43]
  s_add_u32 m0, s31, 151552
  s_add_u32 s34, s36, 36992
  buffer_load_dwordx4 v3, s[12:15], s34 offen  lds
  v_mfma_f32_16x16x32_bf16 v[44:47], a[108:111], a[92:95], v[44:47]
  ds_read_b128 a[108:111], v6 offset:14336
  s_waitcnt lgkmcnt(3)
  v_mfma_f32_16x16x32_bf16 a[16:19], a[80:83], a[96:99], a[16:19]
  v_mfma_f32_16x16x32_bf16 a[48:51], a[84:87], a[96:99], a[48:51]
  v_mfma_f32_16x16x32_bf16 v[48:51], a[96:99], a[88:91], v[48:51]
  s_add_u32 m0, s31, 155648
  s_add_u32 s34, s36, 73856
  buffer_load_dwordx4 v3, s[12:15], s34 offen  lds
  v_mfma_f32_16x16x32_bf16 v[52:55], a[96:99], a[92:95], v[52:55]
  s_waitcnt lgkmcnt(2)
  v_mfma_f32_16x16x32_bf16 a[20:23], a[80:83], a[100:103], a[20:23]
  v_mfma_f32_16x16x32_bf16 a[52:55], a[84:87], a[100:103], a[52:55]
  v_mfma_f32_16x16x32_bf16 v[56:59], a[100:103], a[88:91], v[56:59]
  s_add_u32 m0, s31, 159744
  s_add_u32 s34, s36, 110720
  buffer_load_dwordx4 v3, s[12:15], s34 offen  lds
  v_mfma_f32_16x16x32_bf16 v[60:63], a[100:103], a[92:95], v[60:63]
  v_xor_b32 v5, 0x10000, v5
  v_xor_b32 v6, 0x10000, v6
  v_xor_b32 v7, 0x10000, v7
  v_xor_b32 v8, 0x10000, v8
  s_branch F1_KVDONE
F1_KVLOOP1:
  s_waitcnt lgkmcnt(0)
F1_KVENTRY1:
  s_barrier
  v_mfma_f32_16x16x32_bf16 a[24:27], a[80:83], a[104:107], a[24:27]
  ds_read_b64_tr_b16 a[64:65], v7 offset:32768
  ds_read_b64_tr_b16 a[66:67], v7 offset:33792
  v_mfma_f32_16x16x32_bf16 a[56:59], a[84:87], a[104:107], a[56:59]
  ds_read_b64_tr_b16 a[68:69], v8 offset:32768
  ds_read_b64_tr_b16 a[70:71], v8 offset:33792
  v_mfma_f32_16x16x32_bf16 v[64:67], a[104:107], a[88:91], v[64:67]
  ds_read_b128 a[96:99], v5 offset:0
  v_mfma_f32_16x16x32_bf16 v[68:71], a[104:107], a[92:95], v[68:71]
  ds_read_b64_tr_b16 a[72:73], v7 offset:49152
  ds_read_b128 a[104:107], v5 offset:4096
  v_mfma_f32_16x16x32_bf16 a[28:31], a[80:83], a[108:111], a[28:31]
  ds_read_b64_tr_b16 a[74:75], v7 offset:50176
  v_mfma_f32_16x16x32_bf16 a[60:63], a[84:87], a[108:111], a[60:63]
  ds_read_b64_tr_b16 a[76:77], v8 offset:49152
  v_mfma_f32_16x16x32_bf16 v[72:75], a[108:111], a[88:91], v[72:75]
  ds_read_b64_tr_b16 a[78:79], v8 offset:50176
  v_mfma_f32_16x16x32_bf16 v[76:79], a[108:111], a[92:95], v[76:79]
  ds_read_b128 a[100:103], v5 offset:2048
  ds_read_b128 a[108:111], v5 offset:6144
  s_waitcnt lgkmcnt(2)
  v_mfma_f32_16x16x32_bf16 a[0:3], a[64:67], a[96:99], a[0:3]
  ds_read_b64_tr_b16 a[80:81], v7 offset:40960
  v_mfma_f32_16x16x32_bf16 a[32:35], a[68:71], a[96:99], a[32:35]
  ds_read_b64_tr_b16 a[82:83], v7 offset:41984
  v_mfma_f32_16x16x32_bf16 v[16:19], a[96:99], a[72:75], v[16:19]
  s_sub_u32 s34, s37, 1
  s_cmp_gt_u32 s34, 1
  s_cbranch_scc1 F1_TX
  buffer_load_dword v15, v9, s[92:95], s96 offen nt
  s_branch F1_TY
F1_TX:
  buffer_load_dword v15, v9, s[92:95], s96 offen sc1
F1_TY:
  s_add_u32 s96, s96, s97
  v_mfma_f32_16x16x32_bf16 v[20:23], a[96:99], a[76:79], v[20:23]
  ds_read_b128 a[96:99], v5 offset:8192
  s_waitcnt lgkmcnt(4)
  v_mfma_f32_16x16x32_bf16 a[4:7], a[64:67], a[100:103], a[4:7]
  ds_read_b64_tr_b16 a[84:85], v8 offset:40960
  v_mfma_f32_16x16x32_bf16 a[36:39], a[68:71], a[100:103], a[36:39]
  ds_read_b64_tr_b16 a[86:87], v8 offset:41984
  v_mfma_f32_16x16x32_bf16 v[24:27], a[100:103], a[72:75], v[24:27]
  v_mfma_f32_16x16x32_bf16 v[28:31], a[100:103], a[76:79], v[28:31]
  ds_read_b128 a[100:103], v5 offset:10240
  s_waitcnt lgkmcnt(8)
  v_mfma_f32_16x16x32_bf16 a[8:11], a[64:67], a[104:107], a[8:11]
  ds_read_b64_tr_b16 a[88:89], v7 offset:57344
  v_mfma_f32_16x16x32_bf16 a[40:43], a[68:71], a[104:107], a[40:43]
  ds_read_b64_tr_b16 a[90:91], v7 offset:58368
  v_mfma_f32_16x16x32_bf16 v[32:35], a[104:107], a[72:75], v[32:35]
  v_mfma_f32_16x16x32_bf16 v[36:39], a[104:107], a[76:79], v[36:39]
  ds_read_b128 a[104:107], v5 offset:12288
  s_waitcnt lgkmcnt(9)
  v_mfma_f32_16x16x32_bf16 a[12:15], a[64:67], a[108:111], a[12:15]
  ds_read_b64_tr_b16 a[92:93], v8 offset:57344
  v_mfma_f32_16x16x32_bf16 a[44:47], a[68:71], a[108:111], a[44:47]
  ds_read_b64_tr_b16 a[94:95], v8 offset:58368
  v_mfma_f32_16x16x32_bf16 v[40:43], a[108:111], a[72:75], v[40:43]
  v_mfma_f32_16x16x32_bf16 v[44:47], a[108:111], a[76:79], v[44:47]
  ds_read_b128 a[108:111], v5 offset:14336
  s_waitcnt lgkmcnt(9)
  v_mfma_f32_16x16x32_bf16 a[16:19], a[64:67], a[96:99], a[16:19]
  v_mfma_f32_16x16x32_bf16 a[48:51], a[68:71], a[96:99], a[48:51]
  v_mfma_f32_16x16x32_bf16 v[48:51], a[96:99], a[72:75], v[48:51]
  v_mfma_f32_16x16x32_bf16 v[52:55], a[96:99], a[76:79], v[52:55]
  ds_read_b128 a[96:99], v6 offset:0
  s_waitcnt lgkmcnt(7)
  v_mfma_f32_16x16x32_bf16 a[20:23], a[64:67], a[100:103], a[20:23]
  v_mfma_f32_16x16x32_bf16 a[52:55], a[68:71], a[100:103], a[52:55]
  v_mfma_f32_16x16x32_bf16 v[56:59], a[100:103], a[72:75], v[56:59]
  v_mfma_f32_16x16x32_bf16 v[60:63], a[100:103], a[76:79], v[60:63]
  ds_read_b128 a[100:103], v6 offset:2048
  s_waitcnt lgkmcnt(5)
  v_mfma_f32_16x16x32_bf16 a[24:27], a[64:67], a[104:107], a[24:27]
  v_mfma_f32_16x16x32_bf16 a[56:59], a[68:71], a[104:107], a[56:59]
  v_mfma_f32_16x16x32_bf16 v[64:67], a[104:107], a[72:75], v[64:67]
  v_mfma_f32_16x16x32_bf16 v[68:71], a[104:107], a[76:79], v[68:71]
  ds_read_b128 a[104:107], v6 offset:4096
  s_waitcnt lgkmcnt(3)
  v_mfma_f32_16x16x32_bf16 a[28:31], a[64:67], a[108:111], a[28:31]
  v_mfma_f32_16x16x32_bf16 a[60:63], a[68:71], a[108:111], a[60:63]
  v_mfma_f32_16x16x32_bf16 v[72:75], a[108:111], a[72:75], v[72:75]
  v_mfma_f32_16x16x32_bf16 v[76:79], a[108:111], a[76:79], v[76:79]
  ds_read_b128 a[108:111], v6 offset:6144
  s_waitcnt lgkmcnt(3)
  v_mfma_f32_16x16x32_bf16 a[0:3], a[80:83], a[96:99], a[0:3]
  v_mfma_f32_16x16x32_bf16 a[32:35], a[84:87], a[96:99], a[32:35]
  v_mfma_f32_16x16x32_bf16 v[16:19], a[96:99], a[88:91], v[16:19]
  v_mfma_f32_16x16x32_bf16 v[20:23], a[96:99], a[92:95], v[20:23]
  ds_read_b128 a[96:99], v6 offset:8192
  s_waitcnt lgkmcnt(3)
  v_mfma_f32_16x16x32_bf16 a[4:7], a[80:83], a[100:103], a[4:7]
  v_mfma_f32_16x16x32_bf16 a[36:39], a[84:87], a[100:103], a[36:39]
  v_mfma_f32_16x16x32_bf16 v[24:27], a[100:103], a[88:91], v[24:27]
  v_mfma_f32_16x16x32_bf16 v[28:31], a[100:103], a[92:95], v[28:31]
  ds_read_b128 a[100:103], v6 offset:10240
  s_waitcnt lgkmcnt(3)
  v_mfma_f32_16x16x32_bf16 a[8:11], a[80:83], a[104:107], a[8:11]
  v_mfma_f32_16x16x32_bf16 a[40:43], a[84:87], a[104:107], a[40:43]
  v_mfma_f32_16x16x32_bf16 v[32:35], a[104:107], a[88:91], v[32:35]
  v_mfma_f32_16x16x32_bf16 v[36:39], a[104:107], a[92:95], v[36:39]
  ds_read_b128 a[104:107], v6 offset:12288
  s_waitcnt lgkmcnt(3)
  v_mfma_f32_16x16x32_bf16 a[12:15], a[80:83], a[108:111], a[12:15]
  v_mfma_f32_16x16x32_bf16 a[44:47], a[84:87], a[108:111], a[44:47]
  v_mfma_f32_16x16x32_bf16 v[40:43], a[108:111], a[88:91], v[40:43]
  v_mfma_f32_16x16x32_bf16 v[44:47], a[108:111], a[92:95], v[44:47]
  ds_read_b128 a[108:111], v6 offset:14336
  s_waitcnt lgkmcnt(3)
  v_mfma_f32_16x16x32_bf16 a[16:19], a[80:83], a[96:99], a[16:19]
  v_mfma_f32_16x16x32_bf16 a[48:51], a[84:87], a[96:99], a[48:51]
  v_mfma_f32_16x16x32_bf16 v[48:51], a[96:99], a[88:91], v[48:51]
  v_mfma_f32_16x16x32_bf16 v[52:55], a[96:99], a[92:95], v[52:55]
  s_waitcnt lgkmcnt(2)
  v_mfma_f32_16x16x32_bf16 a[20:23], a[80:83], a[100:103], a[20:23]
  v_mfma_f32_16x16x32_bf16 a[52:55], a[84:87], a[100:103], a[52:55]
  v_mfma_f32_16x16x32_bf16 v[56:59], a[100:103], a[88:91], v[56:59]
  v_mfma_f32_16x16x32_bf16 v[60:63], a[100:103], a[92:95], v[60:63]
  v_xor_b32 v5, 0x10000, v5
  v_xor_b32 v6, 0x10000, v6
  v_xor_b32 v7, 0x10000, v7
  v_xor_b32 v8, 0x10000, v8
  s_add_u32 s41, s41, 1
  s_cmp_lt_u32 s41, 7
  s_cbranch_scc1 F1_KVLOOP1
  s_mul_i32 s32, s29, 147456
  s_sub_u32 s36, 2211840, s32
  s_lshl_b32 s31, s37, 10
  s_waitcnt lgkmcnt(0)
  s_barrier
  v_mfma_f32_16x16x32_bf16 a[24:27], a[80:83], a[104:107], a[24:27]
  ds_read_b64_tr_b16 a[64:65], v7 offset:32768
  ds_read_b64_tr_b16 a[66:67], v7 offset:33792
  v_mfma_f32_16x16x32_bf16 a[56:59], a[84:87], a[104:107], a[56:59]
  ds_read_b64_tr_b16 a[68:69], v8 offset:32768
  ds_read_b64_tr_b16 a[70:71], v8 offset:33792
  v_mfma_f32_16x16x32_bf16 v[64:67], a[104:107], a[88:91], v[64:67]
  ds_read_b128 a[96:99], v5 offset:0
  v_mfma_f32_16x16x32_bf16 v[68:71], a[104:107], a[92:95], v[68:71]
  ds_read_b64_tr_b16 a[72:73], v7 offset:49152
  ds_read_b128 a[104:107], v5 offset:4096
  v_mfma_f32_16x16x32_bf16 a[28:31], a[80:83], a[108:111], a[28:31]
  ds_read_b64_tr_b16 a[74:75], v7 offset:50176
  v_mfma_f32_16x16x32_bf16 a[60:63], a[84:87], a[108:111], a[60:63]
  ds_read_b64_tr_b16 a[76:77], v8 offset:49152
  v_mfma_f32_16x16x32_bf16 v[72:75], a[108:111], a[88:91], v[72:75]
  ds_read_b64_tr_b16 a[78:79], v8 offset:50176
  v_mfma_f32_16x16x32_bf16 v[76:79], a[108:111], a[92:95], v[76:79]
  ds_read_b128 a[100:103], v5 offset:2048
  ds_read_b128 a[108:111], v5 offset:6144
  s_waitcnt lgkmcnt(2)
  v_mfma_f32_16x16x32_bf16 a[0:3], a[64:67], a[96:99], a[0:3]
  ds_read_b64_tr_b16 a[80:81], v7 offset:40960
  v_mfma_f32_16x16x32_bf16 a[32:35], a[68:71], a[96:99], a[32:35]
  ds_read_b64_tr_b16 a[82:83], v7 offset:41984
  v_mfma_f32_16x16x32_bf16 v[16:19], a[96:99], a[72:75], v[16:19]
  v_lshlrev_b32 v9, 7, v1
  s_mul_i32 s34, s2, 9216
  s_cmp_eq_u32 s37, 3
  s_cbranch_scc1 F1_T3
  s_cmp_eq_u32 s37, 1
  s_cbranch_scc1 F1_T1
  s_cmp_eq_u32 s37, 2
  s_cbranch_scc1 F1_T2
  buffer_load_dword v15, v9, s[44:47], s34 offen sc1
  s_branch F1_T4
F1_T1:
  buffer_load_dword v15, v9, s[48:51], s34 offen sc1
  s_branch F1_T4
F1_T2:
  s_branch F1_T4
F1_T3:
  v_min_u32 v9, 896, v9
  s_add_u32 s34, s34, 8192
  buffer_load_dword v15, v9, s[44:47], s34 offen sc1
  buffer_load_dword v15, v9, s[48:51], s34 offen sc1
F1_T4:
  v_mfma_f32_16x16x32_bf16 v[20:23], a[96:99], a[76:79], v[20:23]
  ds_read_b128 a[96:99], v5 offset:8192
  s_waitcnt lgkmcnt(4)
  v_mfma_f32_16x16x32_bf16 a[4:7], a[64:67], a[100:103], a[4:7]
  ds_read_b64_tr_b16 a[84:85], v8 offset:40960
  v_mfma_f32_16x16x32_bf16 a[36:39], a[68:71], a[100:103], a[36:39]
  ds_read_b64_tr_b16 a[86:87], v8 offset:41984
  v_mfma_f32_16x16x32_bf16 v[24:27], a[100:103], a[72:75], v[24:27]
  v_mfma_f32_16x16x32_bf16 v[28:31], a[100:103], a[76:79], v[28:31]
  ds_read_b128 a[100:103], v5 offset:10240
  s_waitcnt lgkmcnt(8)
  v_mfma_f32_16x16x32_bf16 a[8:11], a[64:67], a[104:107], a[8:11]
  ds_read_b64_tr_b16 a[88:89], v7 offset:57344
  v_mfma_f32_16x16x32_bf16 a[40:43], a[68:71], a[104:107], a[40:43]
  ds_read_b64_tr_b16 a[90:91], v7 offset:58368
  v_mfma_f32_16x16x32_bf16 v[32:35], a[104:107], a[72:75], v[32:35]
  v_mfma_f32_16x16x32_bf16 v[36:39], a[104:107], a[76:79], v[36:39]
  ds_read_b128 a[104:107], v5 offset:12288
  s_waitcnt lgkmcnt(9)
  v_mfma_f32_16x16x32_bf16 a[12:15], a[64:67], a[108:111], a[12:15]
  ds_read_b64_tr_b16 a[92:93], v8 offset:57344
  v_mfma_f32_16x16x32_bf16 a[44:47], a[68:71], a[108:111], a[44:47]
  ds_read_b64_tr_b16 a[94:95], v8 offset:58368
  v_mfma_f32_16x16x32_bf16 v[40:43], a[108:111], a[72:75], v[40:43]
  v_mfma_f32_16x16x32_bf16 v[44:47], a[108:111], a[76:79], v[44:47]
  ds_read_b128 a[108:111], v5 offset:14336
  s_waitcnt lgkmcnt(9)
  v_mfma_f32_16x16x32_bf16 a[16:19], a[64:67], a[96:99], a[16:19]
  v_mfma_f32_16x16x32_bf16 a[48:51], a[68:71], a[96:99], a[48:51]
  v_mfma_f32_16x16x32_bf16 v[48:51], a[96:99], a[72:75], v[48:51]
  v_mfma_f32_16x16x32_bf16 v[52:55], a[96:99], a[76:79], v[52:55]
  ds_read_b128 a[96:99], v6 offset:0
  s_waitcnt lgkmcnt(7)
  v_mfma_f32_16x16x32_bf16 a[20:23], a[64:67], a[100:103], a[20:23]
  v_mfma_f32_16x16x32_bf16 a[52:55], a[68:71], a[100:103], a[52:55]
  v_mfma_f32_16x16x32_bf16 v[56:59], a[100:103], a[72:75], v[56:59]
  v_mfma_f32_16x16x32_bf16 v[60:63], a[100:103], a[76:79], v[60:63]
  ds_read_b128 a[100:103], v6 offset:2048
  s_waitcnt lgkmcnt(5)
  v_mfma_f32_16x16x32_bf16 a[24:27], a[64:67], a[104:107], a[24:27]
  v_mfma_f32_16x16x32_bf16 a[56:59], a[68:71], a[104:107], a[56:59]
  v_mfma_f32_16x16x32_bf16 v[64:67], a[104:107], a[72:75], v[64:67]
  v_mfma_f32_16x16x32_bf16 v[68:71], a[104:107], a[76:79], v[68:71]
  ds_read_b128 a[104:107], v6 offset:4096
  s_waitcnt lgkmcnt(3)
  v_mfma_f32_16x16x32_bf16 a[28:31], a[64:67], a[108:111], a[28:31]
  v_mfma_f32_16x16x32_bf16 a[60:63], a[68:71], a[108:111], a[60:63]
  v_mfma_f32_16x16x32_bf16 v[72:75], a[108:111], a[72:75], v[72:75]
  v_mfma_f32_16x16x32_bf16 v[76:79], a[108:111], a[76:79], v[76:79]
  ds_read_b128 a[108:111], v6 offset:6144
  s_waitcnt lgkmcnt(3)
  v_mfma_f32_16x16x32_bf16 a[0:3], a[80:83], a[96:99], a[0:3]
  v_mfma_f32_16x16x32_bf16 a[32:35], a[84:87], a[96:99], a[32:35]
  v_mfma_f32_16x16x32_bf16 v[16:19], a[96:99], a[88:91], v[16:19]
  v_mfma_f32_16x16x32_bf16 v[20:23], a[96:99], a[92:95], v[20:23]
  ds_read_b128 a[96:99], v6 offset:8192
  s_waitcnt lgkmcnt(3)
  v_mfma_f32_16x16x32_bf16 a[4:7], a[80:83], a[100:103], a[4:7]
  v_mfma_f32_16x16x32_bf16 a[36:39], a[84:87], a[100:103], a[36:39]
  v_mfma_f32_16x16x32_bf16 v[24:27], a[100:103], a[88:91], v[24:27]
  v_mfma_f32_16x16x32_bf16 v[28:31], a[100:103], a[92:95], v[28:31]
  ds_read_b128 a[100:103], v6 offset:10240
  s_waitcnt lgkmcnt(3)
  v_mfma_f32_16x16x32_bf16 a[8:11], a[80:83], a[104:107], a[8:11]
  v_mfma_f32_16x16x32_bf16 a[40:43], a[84:87], a[104:107], a[40:43]
  v_mfma_f32_16x16x32_bf16 v[32:35], a[104:107], a[88:91], v[32:35]
  v_mfma_f32_16x16x32_bf16 v[36:39], a[104:107], a[92:95], v[36:39]
  ds_read_b128 a[104:107], v6 offset:12288
  s_waitcnt lgkmcnt(3)
  v_mfma_f32_16x16x32_bf16 a[12:15], a[80:83], a[108:111], a[12:15]
  v_mfma_f32_16x16x32_bf16 a[44:47], a[84:87], a[108:111], a[44:47]
  v_mfma_f32_16x16x32_bf16 v[40:43], a[108:111], a[88:91], v[40:43]
  v_mfma_f32_16x16x32_bf16 v[44:47], a[108:111], a[92:95], v[44:47]
  ds_read_b128 a[108:111], v6 offset:14336
  s_waitcnt lgkmcnt(3)
  v_mfma_f32_16x16x32_bf16 a[16:19], a[80:83], a[96:99], a[16:19]
  v_mfma_f32_16x16x32_bf16 a[48:51], a[84:87], a[96:99], a[48:51]
  v_mfma_f32_16x16x32_bf16 v[48:51], a[96:99], a[88:91], v[48:51]
  v_mfma_f32_16x16x32_bf16 v[52:55], a[96:99], a[92:95], v[52:55]
  s_waitcnt lgkmcnt(2)
  v_mfma_f32_16x16x32_bf16 a[20:23], a[80:83], a[100:103], a[20:23]
  v_mfma_f32_16x16x32_bf16 a[52:55], a[84:87], a[100:103], a[52:55]
  v_mfma_f32_16x16x32_bf16 v[56:59], a[100:103], a[88:91], v[56:59]
  v_mfma_f32_16x16x32_bf16 v[60:63], a[100:103], a[92:95], v[60:63]
  v_xor_b32 v5, 0x10000, v5
  v_xor_b32 v6, 0x10000, v6
  v_xor_b32 v7, 0x10000, v7
  v_xor_b32 v8, 0x10000, v8
F1_KVDONE:
  s_load_dwordx2 s[16:17], s[90:91], 88
  s_load_dwordx2 s[20:21], s[90:91], 32
  s_mov_b32 s18, 4718592
  s_mov_b32 s22, 2359296
  s_load_dwordx2 s[92:93], s[90:91], 24
  s_mov_b32 s94, 4608
  s_mov_b32 s95, 0x20000
  s_lshl_b32 s96, s2, 1
  s_add_u32 s96, s96, s28
  s_sub_u32 s96, s96, 1
  s_add_u32 s34, s2, 512
  s_cmp_eq_u32 s28, 3
  s_cselect_b32 s96, s34, s96
  s_sub_u32 s34, s28, 1
  s_cmp_lt_u32 s34, 3
  s_cselect_b32 s96, s96, 999
  s_mov_b32 s8, s56
  s_mov_b32 s9, s57
  s_mov_b32 s10, 256
  s_lshr_b32 s34, s28, 1
  s_lshl_b32 s34, s34, 13
  s_lshr_b32 s35, s28, 2
  s_lshl_b32 s35, s35, 14
  s_sub_u32 s34, s34, s35
  v_add_u32 v5, s34, v5
  v_add_u32 v6, s34, v6
  s_and_b32 s39, s28, 1
  s_lshl_b32 s38, s39, 3
  v_lshrrev_b32 v13, 4, v1
  v_bfe_u32 v12, v1, 2, 2
  v_lshl_add_u32 v14, v13, 3, v12
  v_lshlrev_b32 v14, 8, v14
  v_and_b32 v8, 1, v13
  v_lshl_add_u32 v12, v8, 2, v12
  v_lshlrev_b32 v12, 1, v12
  v_xor_b32 v12, s38, v12
  v_lshl_add_u32 v14, v12, 4, v14
  v_and_b32 v12, 3, v1
  v_lshl_add_u32 v7, v12, 3, v14
  v_xor_b32 v8, 32, v7
  v_xor_b32 v9, 64, v7
  v_xor_b32 v10, 96, v7
  s_lshl_b32 s40, s30, 20
  s_lshl_b32 s34, s29, 16
  s_add_u32 s40, s40, s34
  s_lshr_b32 s34, s28, 2
  s_lshl_b32 s34, s34, 15
  s_add_u32 s40, s40, s34
  s_lshl_b32 s34, s37, 10
  s_add_u32 s42, s40, s34
  s_lshl_b32 s34, s37, 11
  s_add_u32 s43, s40, s34
  s_add_u32 s43, s43, 0x80000
  s_cmp_ge_u32 s28, 4
  s_cbranch_scc1 F1_Q1
  s_setprio 1
  s_waitcnt vmcnt(12) lgkmcnt(0)
  s_barrier
  v_mfma_f32_16x16x32_bf16 a[24:27], a[80:83], a[104:107], a[24:27]
  ds_read_b64_tr_b16 a[64:65], v7 offset:32768
  ds_read_b64_tr_b16 a[66:67], v7 offset:33792
  v_mfma_f32_16x16x32_bf16 a[56:59], a[84:87], a[104:107], a[56:59]
  ds_read_b64_tr_b16 a[68:69], v8 offset:32768
  ds_read_b64_tr_b16 a[70:71], v8 offset:33792
  v_mfma_f32_16x16x32_bf16 v[64:67], a[104:107], a[88:91], v[64:67]
  ds_read_b128 a[96:99], v5 offset:0
  v_mfma_f32_16x16x32_bf16 v[68:71], a[104:107], a[92:95], v[68:71]
  ds_read_b64_tr_b16 a[72:73], v9 offset:32768
  ds_read_b128 a[104:107], v5 offset:4096
  v_mfma_f32_16x16x32_bf16 a[28:31], a[80:83], a[108:111], a[28:31]
  ds_read_b64_tr_b16 a[74:75], v9 offset:33792
  v_mfma_f32_16x16x32_bf16 a[60:63], a[84:87], a[108:111], a[60:63]
  ds_read_b64_tr_b16 a[76:77], v10 offset:32768
  v_mfma_f32_16x16x32_bf16 v[72:75], a[108:111], a[88:91], v[72:75]
  ds_read_b64_tr_b16 a[78:79], v10 offset:33792
  v_mfma_f32_16x16x32_bf16 v[76:79], a[108:111], a[92:95], v[76:79]
  ds_read_b128 a[100:103], v5 offset:2048
  ds_read_b128 a[108:111], v5 offset:6144
  s_waitcnt lgkmcnt(2)
  v_mfma_f32_16x16x32_bf16 v[80:83], a[64:67], a[96:99], v[80:83]
  ds_read_b64_tr_b16 a[80:81], v7 offset:40960
  ds_read_b64_tr_b16 a[82:83], v7 offset:41984
  v_mfma_f32_16x16x32_bf16 v[84:87], a[68:71], a[96:99], v[84:87]
  ds_read_b64_tr_b16 a[84:85], v8 offset:40960
  ds_read_b64_tr_b16 a[86:87], v8 offset:41984
  v_mfma_f32_16x16x32_bf16 v[88:91], a[72:75], a[96:99], v[88:91]
  s_add_u32 m0, s31, 98304
  s_mov_b32 s34, 1048576
  buffer_load_dwordx4 v4, s[24:27], s34 offen  lds
  v_mfma_f32_16x16x32_bf16 v[92:95], a[76:79], a[96:99], v[92:95]
  ds_read_b128 a[96:99], v6 offset:0
  s_add_u32 m0, s31, 102400
  s_mov_b32 s34, 1179648
  buffer_load_dwordx4 v4, s[24:27], s34 offen  lds
  s_waitcnt lgkmcnt(6)
  v_mfma_f32_16x16x32_bf16 v[96:99], a[64:67], a[100:103], v[96:99]
  ds_read_b64_tr_b16 a[88:89], v9 offset:40960
  ds_read_b64_tr_b16 a[90:91], v9 offset:41984
  v_mfma_f32_16x16x32_bf16 v[100:103], a[68:71], a[100:103], v[100:103]
  ds_read_b64_tr_b16 a[92:93], v10 offset:40960
  ds_read_b64_tr_b16 a[94:95], v10 offset:41984
  v_mfma_f32_16x16x32_bf16 v[104:107], a[72:75], a[100:103], v[104:107]
  s_add_u32 m0, s31, 106496
  s_mov_b32 s34, 1310720
  buffer_load_dwordx4 v4, s[24:27], s34 offen  lds
  v_mfma_f32_16x16x32_bf16 v[108:111], a[76:79], a[100:103], v[108:111]
  ds_read_b128 a[100:103], v6 offset:2048
  s_add_u32 m0, s31, 110592
  s_mov_b32 s34, 1441792
  buffer_load_dwordx4 v4, s[24:27], s34 offen  lds
  s_waitcnt lgkmcnt(12)
  v_mfma_f32_16x16x32_bf16 v[112:115], a[64:67], a[104:107], v[112:115]
  v_mfma_f32_16x16x32_bf16 v[116:119], a[68:71], a[104:107], v[116:119]
  v_mfma_f32_16x16x32_bf16 v[120:123], a[72:75], a[104:107], v[120:123]
  s_add_u32 m0, s31, 65536
  s_add_u32 s34, s32, 256
  buffer_load_dwordx4 v3, s[12:15], s34 offen  lds
  v_mfma_f32_16x16x32_bf16 v[124:127], a[76:79], a[104:107], v[124:127]
  ds_read_b128 a[104:107], v6 offset:4096
  s_add_u32 m0, s31, 69632
  s_add_u32 s34, s32, 37120
  buffer_load_dwordx4 v3, s[12:15], s34 offen  lds
  s_waitcnt lgkmcnt(11)
  v_mfma_f32_16x16x32_bf16 v[128:131], a[64:67], a[108:111], v[128:131]
  v_mfma_f32_16x16x32_bf16 v[132:135], a[68:71], a[108:111], v[132:135]
  v_mfma_f32_16x16x32_bf16 v[136:139], a[72:75], a[108:111], v[136:139]
  s_add_u32 m0, s31, 73728
  s_add_u32 s34, s32, 73984
  buffer_load_dwordx4 v3, s[12:15], s34 offen  lds
  v_mfma_f32_16x16x32_bf16 v[140:143], a[76:79], a[108:111], v[140:143]
  ds_read_b128 a[108:111], v6 offset:6144
  s_add_u32 m0, s31, 77824
  s_add_u32 s34, s32, 110848
  buffer_load_dwordx4 v3, s[12:15], s34 offen  lds
  s_waitcnt lgkmcnt(3)
  v_mfma_f32_16x16x32_bf16 v[80:83], a[80:83], a[96:99], v[80:83]
  v_mfma_f32_16x16x32_bf16 v[84:87], a[84:87], a[96:99], v[84:87]
  v_mfma_f32_16x16x32_bf16 v[88:91], a[88:91], a[96:99], v[88:91]
  s_add_u32 m0, s31, 81920
  s_add_u32 s34, s36, 256
  buffer_load_dwordx4 v3, s[12:15], s34 offen  lds
  v_mfma_f32_16x16x32_bf16 v[92:95], a[92:95], a[96:99], v[92:95]
  s_add_u32 m0, s31, 86016
  s_add_u32 s34, s36, 37120
  buffer_load_dwordx4 v3, s[12:15], s34 offen  lds
  s_waitcnt lgkmcnt(2)
  v_mfma_f32_16x16x32_bf16 v[96:99], a[80:83], a[100:103], v[96:99]
  v_mfma_f32_16x16x32_bf16 v[100:103], a[84:87], a[100:103], v[100:103]
  v_mfma_f32_16x16x32_bf16 v[104:107], a[88:91], a[100:103], v[104:107]
  s_add_u32 m0, s31, 90112
  s_add_u32 s34, s36, 73984
  buffer_load_dwordx4 v3, s[12:15], s34 offen  lds
  v_mfma_f32_16x16x32_bf16 v[108:111], a[92:95], a[100:103], v[108:111]
  s_add_u32 m0, s31, 94208
  s_add_u32 s34, s36, 110848
  buffer_load_dwordx4 v3, s[12:15], s34 offen  lds
  v_add_u32 v5, 131072, v5
  v_add_u32 v6, 131072, v6
  v_add_u32 v7, 16384, v7
  v_add_u32 v8, 16384, v8
  v_add_u32 v9, 16384, v9
  v_add_u32 v10, 16384, v10
  s_waitcnt vmcnt(12) lgkmcnt(0)
  s_barrier
  v_mfma_f32_16x16x32_bf16 v[112:115], a[80:83], a[104:107], v[112:115]
  ds_read_b64_tr_b16 a[64:65], v7 offset:32768
  ds_read_b64_tr_b16 a[66:67], v7 offset:33792
  v_mfma_f32_16x16x32_bf16 v[116:119], a[84:87], a[104:107], v[116:119]
  ds_read_b64_tr_b16 a[68:69], v8 offset:32768
  ds_read_b64_tr_b16 a[70:71], v8 offset:33792
  v_mfma_f32_16x16x32_bf16 v[120:123], a[88:91], a[104:107], v[120:123]
  ds_read_b128 a[96:99], v5 offset:0
  v_mfma_f32_16x16x32_bf16 v[124:127], a[92:95], a[104:107], v[124:127]
  ds_read_b64_tr_b16 a[72:73], v9 offset:32768
  ds_read_b128 a[104:107], v5 offset:4096
  v_mfma_f32_16x16x32_bf16 v[128:131], a[80:83], a[108:111], v[128:131]
  ds_read_b64_tr_b16 a[74:75], v9 offset:33792
  v_mfma_f32_16x16x32_bf16 v[132:135], a[84:87], a[108:111], v[132:135]
  ds_read_b64_tr_b16 a[76:77], v10 offset:32768
  v_mfma_f32_16x16x32_bf16 v[136:139], a[88:91], a[108:111], v[136:139]
  ds_read_b64_tr_b16 a[78:79], v10 offset:33792
  v_mfma_f32_16x16x32_bf16 v[140:143], a[92:95], a[108:111], v[140:143]
  ds_read_b128 a[100:103], v5 offset:2048
  ds_read_b128 a[108:111], v5 offset:6144
  s_waitcnt lgkmcnt(2)
  v_mfma_f32_16x16x32_bf16 v[80:83], a[64:67], a[96:99], v[80:83]
  ds_read_b64_tr_b16 a[80:81], v7 offset:40960
  ds_read_b64_tr_b16 a[82:83], v7 offset:41984
  v_mfma_f32_16x16x32_bf16 v[84:87], a[68:71], a[96:99], v[84:87]
  ds_read_b64_tr_b16 a[84:85], v8 offset:40960
  ds_read_b64_tr_b16 a[86:87], v8 offset:41984
  v_mfma_f32_16x16x32_bf16 v[88:91], a[72:75], a[96:99], v[88:91]
  s_add_u32 m0, s31, 32768
  s_mov_b32 s34, 1572864
  buffer_load_dwordx4 v4, s[24:27], s34 offen  lds
  v_mfma_f32_16x16x32_bf16 v[92:95], a[76:79], a[96:99], v[92:95]
  ds_read_b128 a[96:99], v6 offset:0
  s_add_u32 m0, s31, 36864
  s_mov_b32 s34, 1703936
  buffer_load_dwordx4 v4, s[24:27], s34 offen  lds
  s_waitcnt lgkmcnt(6)
  v_mfma_f32_16x16x32_bf16 v[96:99], a[64:67], a[100:103], v[96:99]
  ds_read_b64_tr_b16 a[88:89], v9 offset:40960
  ds_read_b64_tr_b16 a[90:91], v9 offset:41984
  v_mfma_f32_16x16x32_bf16 v[100:103], a[68:71], a[100:103], v[100:103]
  ds_read_b64_tr_b16 a[92:93], v10 offset:40960
  ds_read_b64_tr_b16 a[94:95], v10 offset:41984
  v_mfma_f32_16x16x32_bf16 v[104:107], a[72:75], a[100:103], v[104:107]
  s_add_u32 m0, s31, 40960
  s_mov_b32 s34, 1835008
  buffer_load_dwordx4 v4, s[24:27], s34 offen  lds
  v_mfma_f32_16x16x32_bf16 v[108:111], a[76:79], a[100:103], v[108:111]
  ds_read_b128 a[100:103], v6 offset:2048
  s_add_u32 m0, s31, 45056
  s_mov_b32 s34, 1966080
  buffer_load_dwordx4 v4, s[24:27], s34 offen  lds
  s_waitcnt lgkmcnt(12)
  v_mfma_f32_16x16x32_bf16 v[112:115], a[64:67], a[104:107], v[112:115]
  v_mfma_f32_16x16x32_bf16 v[116:119], a[68:71], a[104:107], v[116:119]
  v_mfma_f32_16x16x32_bf16 v[120:123], a[72:75], a[104:107], v[120:123]
  s_add_u32 m0, s31, 0
  s_add_u32 s34, s32, 384
  buffer_load_dwordx4 v3, s[12:15], s34 offen  lds
  v_mfma_f32_16x16x32_bf16 v[124:127], a[76:79], a[104:107], v[124:127]
  ds_read_b128 a[104:107], v6 offset:4096
  s_add_u32 m0, s31, 4096
  s_add_u32 s34, s32, 37248
  buffer_load_dwordx4 v3, s[12:15], s34 offen  lds
  s_waitcnt lgkmcnt(11)
  v_mfma_f32_16x16x32_bf16 v[128:131], a[64:67], a[108:111], v[128:131]
  v_mfma_f32_16x16x32_bf16 v[132:135], a[68:71], a[108:111], v[132:135]
  v_mfma_f32_16x16x32_bf16 v[136:139], a[72:75], a[108:111], v[136:139]
  s_add_u32 m0, s31, 8192
  s_add_u32 s34, s32, 74112
  buffer_load_dwordx4 v3, s[12:15], s34 offen  lds
  v_mfma_f32_16x16x32_bf16 v[140:143], a[76:79], a[108:111], v[140:143]
  ds_read_b128 a[108:111], v6 offset:6144
  s_add_u32 m0, s31, 12288
  s_add_u32 s34, s32, 110976
  buffer_load_dwordx4 v3, s[12:15], s34 offen  lds
  s_waitcnt lgkmcnt(3)
  v_mfma_f32_16x16x32_bf16 v[80:83], a[80:83], a[96:99], v[80:83]
  v_mfma_f32_16x16x32_bf16 v[84:87], a[84:87], a[96:99], v[84:87]
  v_mfma_f32_16x16x32_bf16 v[88:91], a[88:91], a[96:99], v[88:91]
  s_add_u32 m0, s31, 16384
  s_add_u32 s34, s36, 384
  buffer_load_dwordx4 v3, s[12:15], s34 offen  lds
  v_mfma_f32_16x16x32_bf16 v[92:95], a[92:95], a[96:99], v[92:95]
  s_add_u32 m0, s31, 20480
  s_add_u32 s34, s36, 37248
  buffer_load_dwordx4 v3, s[12:15], s34 offen  lds
  s_waitcnt lgkmcnt(2)
  v_mfma_f32_16x16x32_bf16 v[96:99], a[80:83], a[100:103], v[96:99]
  v_mfma_f32_16x16x32_bf16 v[100:103], a[84:87], a[100:103], v[100:103]
  v_mfma_f32_16x16x32_bf16 v[104:107], a[88:91], a[100:103], v[104:107]
  s_add_u32 m0, s31, 24576
  s_add_u32 s34, s36, 74112
  buffer_load_dwordx4 v3, s[12:15], s34 offen  lds
  v_mfma_f32_16x16x32_bf16 v[108:111], a[92:95], a[100:103], v[108:111]
  s_add_u32 m0, s31, 28672
  s_add_u32 s34, s36, 110976
  buffer_load_dwordx4 v3, s[12:15], s34 offen  lds
  v_add_u32 v5, 4294901760, v5
  v_add_u32 v6, 4294901760, v6
  v_add_u32 v7, 49152, v7
  v_add_u32 v8, 49152, v8
  v_add_u32 v9, 49152, v9
  v_add_u32 v10, 49152, v10
  s_waitcnt vmcnt(12) lgkmcnt(0)
  s_barrier
  v_mfma_f32_16x16x32_bf16 v[112:115], a[80:83], a[104:107], v[112:115]
  ds_read_b64_tr_b16 a[64:65], v7 offset:32768
  ds_read_b64_tr_b16 a[66:67], v7 offset:33792
  v_mfma_f32_16x16x32_bf16 v[116:119], a[84:87], a[104:107], v[116:119]
  ds_read_b64_tr_b16 a[68:69], v8 offset:32768
  ds_read_b64_tr_b16 a[70:71], v8 offset:33792
  v_mfma_f32_16x16x32_bf16 v[120:123], a[88:91], a[104:107], v[120:123]
  ds_read_b128 a[96:99], v5 offset:0
  v_mfma_f32_16x16x32_bf16 v[124:127], a[92:95], a[104:107], v[124:127]
  ds_read_b64_tr_b16 a[72:73], v9 offset:32768
  ds_read_b128 a[104:107], v5 offset:4096
  v_mfma_f32_16x16x32_bf16 v[128:131], a[80:83], a[108:111], v[128:131]
  ds_read_b64_tr_b16 a[74:75], v9 offset:33792
  v_mfma_f32_16x16x32_bf16 v[132:135], a[84:87], a[108:111], v[132:135]
  ds_read_b64_tr_b16 a[76:77], v10 offset:32768
  v_mfma_f32_16x16x32_bf16 v[136:139], a[88:91], a[108:111], v[136:139]
  ds_read_b64_tr_b16 a[78:79], v10 offset:33792
  v_mfma_f32_16x16x32_bf16 v[140:143], a[92:95], a[108:111], v[140:143]
  ds_read_b128 a[100:103], v5 offset:2048
  ds_read_b128 a[108:111], v5 offset:6144
  s_waitcnt lgkmcnt(2)
  v_mfma_f32_16x16x32_bf16 v[80:83], a[64:67], a[96:99], v[80:83]
  ds_read_b64_tr_b16 a[80:81], v7 offset:40960
  ds_read_b64_tr_b16 a[82:83], v7 offset:41984
  v_mfma_f32_16x16x32_bf16 v[84:87], a[68:71], a[96:99], v[84:87]
  ds_read_b64_tr_b16 a[84:85], v8 offset:40960
  ds_read_b64_tr_b16 a[86:87], v8 offset:41984
  v_mfma_f32_16x16x32_bf16 v[88:91], a[72:75], a[96:99], v[88:91]
  s_add_u32 m0, s31, 49152
  s_mov_b32 s34, 2097152
  buffer_load_dwordx4 v4, s[24:27], s34 offen  lds
  v_mfma_f32_16x16x32_bf16 v[92:95], a[76:79], a[96:99], v[92:95]
  ds_read_b128 a[96:99], v6 offset:0
  s_add_u32 m0, s31, 53248
  s_mov_b32 s34, 2228224
  buffer_load_dwordx4 v4, s[24:27], s34 offen  lds
  s_waitcnt lgkmcnt(6)
  v_mfma_f32_16x16x32_bf16 v[96:99], a[64:67], a[100:103], v[96:99]
  ds_read_b64_tr_b16 a[88:89], v9 offset:40960
  ds_read_b64_tr_b16 a[90:91], v9 offset:41984
  v_mfma_f32_16x16x32_bf16 v[100:103], a[68:71], a[100:103], v[100:103]
  ds_read_b64_tr_b16 a[92:93], v10 offset:40960
  ds_read_b64_tr_b16 a[94:95], v10 offset:41984
  v_mfma_f32_16x16x32_bf16 v[104:107], a[72:75], a[100:103], v[104:107]
  s_add_u32 m0, s31, 57344
  s_mov_b32 s34, 2359296
  buffer_load_dwordx4 v4, s[24:27], s34 offen  lds
  v_mfma_f32_16x16x32_bf16 v[108:111], a[76:79], a[100:103], v[108:111]
  ds_read_b128 a[100:103], v6 offset:2048
  s_add_u32 m0, s31, 61440
  s_mov_b32 s34, 2490368
  buffer_load_dwordx4 v4, s[24:27], s34 offen  lds
  s_waitcnt lgkmcnt(12)
  v_mfma_f32_16x16x32_bf16 v[112:115], a[64:67], a[104:107], v[112:115]
  v_mfma_f32_16x16x32_bf16 v[116:119], a[68:71], a[104:107], v[116:119]
  v_mfma_f32_16x16x32_bf16 v[120:123], a[72:75], a[104:107], v[120:123]
  s_add_u32 m0, s31, 131072
  s_add_u32 s34, s32, 512
  buffer_load_dwordx4 v3, s[12:15], s34 offen  lds
  v_mfma_f32_16x16x32_bf16 v[124:127], a[76:79], a[104:107], v[124:127]
  ds_read_b128 a[104:107], v6 offset:4096
  s_add_u32 m0, s31, 135168
  s_add_u32 s34, s32, 37376
  buffer_load_dwordx4 v3, s[12:15], s34 offen  lds
  s_waitcnt lgkmcnt(11)
  v_mfma_f32_16x16x32_bf16 v[128:131], a[64:67], a[108:111], v[128:131]
  v_mfma_f32_16x16x32_bf16 v[132:135], a[68:71], a[108:111], v[132:135]
  v_mfma_f32_16x16x32_bf16 v[136:139], a[72:75], a[108:111], v[136:139]
  s_add_u32 m0, s31, 139264
  s_add_u32 s34, s32, 74240
  buffer_load_dwordx4 v3, s[12:15], s34 offen  lds
  v_mfma_f32_16x16x32_bf16 v[140:143], a[76:79], a[108:111], v[140:143]
  ds_read_b128 a[108:111], v6 offset:6144
  s_add_u32 m0, s31, 143360
  s_add_u32 s34, s32, 111104
  buffer_load_dwordx4 v3, s[12:15], s34 offen  lds
  s_waitcnt lgkmcnt(3)
  v_mfma_f32_16x16x32_bf16 v[80:83], a[80:83], a[96:99], v[80:83]
  v_mfma_f32_16x16x32_bf16 v[84:87], a[84:87], a[96:99], v[84:87]
  v_mfma_f32_16x16x32_bf16 v[88:91], a[88:91], a[96:99], v[88:91]
  s_add_u32 m0, s31, 147456
  s_add_u32 s34, s36, 512
  buffer_load_dwordx4 v3, s[12:15], s34 offen  lds
  v_mfma_f32_16x16x32_bf16 v[92:95], a[92:95], a[96:99], v[92:95]
  s_add_u32 m0, s31, 151552
  s_add_u32 s34, s36, 37376
  buffer_load_dwordx4 v3, s[12:15], s34 offen  lds
  s_waitcnt lgkmcnt(2)
  v_mfma_f32_16x16x32_bf16 v[96:99], a[80:83], a[100:103], v[96:99]
  v_mfma_f32_16x16x32_bf16 v[100:103], a[84:87], a[100:103], v[100:103]
  v_mfma_f32_16x16x32_bf16 v[104:107], a[88:91], a[100:103], v[104:107]
  s_add_u32 m0, s31, 155648
  s_add_u32 s34, s36, 74240
  buffer_load_dwordx4 v3, s[12:15], s34 offen  lds
  v_mfma_f32_16x16x32_bf16 v[108:111], a[92:95], a[100:103], v[108:111]
  s_add_u32 m0, s31, 159744
  s_add_u32 s34, s36, 111104
  buffer_load_dwordx4 v3, s[12:15], s34 offen  lds
  v_add_u32 v5, 4294901760, v5
  v_add_u32 v6, 4294901760, v6
  v_add_u32 v7, 4294901760, v7
  v_add_u32 v8, 4294901760, v8
  v_add_u32 v9, 4294901760, v9
  v_add_u32 v10, 4294901760, v10
  s_waitcnt vmcnt(12) lgkmcnt(0)
  s_barrier
  v_mfma_f32_16x16x32_bf16 v[112:115], a[80:83], a[104:107], v[112:115]
  ds_read_b64_tr_b16 a[64:65], v7 offset:32768
  ds_read_b64_tr_b16 a[66:67], v7 offset:33792
  v_mfma_f32_16x16x32_bf16 v[116:119], a[84:87], a[104:107], v[116:119]
  ds_read_b64_tr_b16 a[68:69], v8 offset:32768
  ds_read_b64_tr_b16 a[70:71], v8 offset:33792
  v_mfma_f32_16x16x32_bf16 v[120:123], a[88:91], a[104:107], v[120:123]
  ds_read_b128 a[96:99], v5 offset:0
  v_mfma_f32_16x16x32_bf16 v[124:127], a[92:95], a[104:107], v[124:127]
  ds_read_b64_tr_b16 a[72:73], v9 offset:32768
  ds_read_b128 a[104:107], v5 offset:4096
  v_mfma_f32_16x16x32_bf16 v[128:131], a[80:83], a[108:111], v[128:131]
  ds_read_b64_tr_b16 a[74:75], v9 offset:33792
  v_mfma_f32_16x16x32_bf16 v[132:135], a[84:87], a[108:111], v[132:135]
  ds_read_b64_tr_b16 a[76:77], v10 offset:32768
  v_mfma_f32_16x16x32_bf16 v[136:139], a[88:91], a[108:111], v[136:139]
  ds_read_b64_tr_b16 a[78:79], v10 offset:33792
  v_mfma_f32_16x16x32_bf16 v[140:143], a[92:95], a[108:111], v[140:143]
  ds_read_b128 a[100:103], v5 offset:2048
  ds_read_b128 a[108:111], v5 offset:6144
  s_waitcnt lgkmcnt(2)
  v_mfma_f32_16x16x32_bf16 v[80:83], a[64:67], a[96:99], v[80:83]
  ds_read_b64_tr_b16 a[80:81], v7 offset:40960
  ds_read_b64_tr_b16 a[82:83], v7 offset:41984
  v_mfma_f32_16x16x32_bf16 v[84:87], a[68:71], a[96:99], v[84:87]
  ds_read_b64_tr_b16 a[84:85], v8 offset:40960
  ds_read_b64_tr_b16 a[86:87], v8 offset:41984
  v_mfma_f32_16x16x32_bf16 v[88:91], a[72:75], a[96:99], v[88:91]
  s_add_u32 m0, s31, 98304
  s_mov_b32 s34, 2621440
  buffer_load_dwordx4 v4, s[24:27], s34 offen  lds
  v_mfma_f32_16x16x32_bf16 v[92:95], a[76:79], a[96:99], v[92:95]
  ds_read_b128 a[96:99], v6 offset:0
  s_add_u32 m0, s31, 102400
  s_mov_b32 s34, 2752512
  buffer_load_dwordx4 v4, s[24:27], s34 offen  lds
  s_waitcnt lgkmcnt(6)
  v_mfma_f32_16x16x32_bf16 v[96:99], a[64:67], a[100:103], v[96:99]
  ds_read_b64_tr_b16 a[88:89], v9 offset:40960
  ds_read_b64_tr_b16 a[90:91], v9 offset:41984
  v_mfma_f32_16x16x32_bf16 v[100:103], a[68:71], a[100:103], v[100:103]
  ds_read_b64_tr_b16 a[92:93], v10 offset:40960
  ds_read_b64_tr_b16 a[94:95], v10 offset:41984
  v_mfma_f32_16x16x32_bf16 v[104:107], a[72:75], a[100:103], v[104:107]
  s_add_u32 m0, s31, 106496
  s_mov_b32 s34, 2883584
  buffer_load_dwordx4 v4, s[24:27], s34 offen  lds
  v_mfma_f32_16x16x32_bf16 v[108:111], a[76:79], a[100:103], v[108:111]
  ds_read_b128 a[100:103], v6 offset:2048
  s_add_u32 m0, s31, 110592
  s_mov_b32 s34, 3014656
  buffer_load_dwordx4 v4, s[24:27], s34 offen  lds
  s_waitcnt lgkmcnt(12)
  v_mfma_f32_16x16x32_bf16 v[112:115], a[64:67], a[104:107], v[112:115]
  v_mfma_f32_16x16x32_bf16 v[116:119], a[68:71], a[104:107], v[116:119]
  v_mfma_f32_16x16x32_bf16 v[120:123], a[72:75], a[104:107], v[120:123]
  s_add_u32 m0, s31, 65536
  s_add_u32 s34, s32, 640
  buffer_load_dwordx4 v3, s[12:15], s34 offen  lds
  v_mfma_f32_16x16x32_bf16 v[124:127], a[76:79], a[104:107], v[124:127]
  ds_read_b128 a[104:107], v6 offset:4096
  s_add_u32 m0, s31, 69632
  s_add_u32 s34, s32, 37504
  buffer_load_dwordx4 v3, s[12:15], s34 offen  lds
  s_waitcnt lgkmcnt(11)
  v_mfma_f32_16x16x32_bf16 v[128:131], a[64:67], a[108:111], v[128:131]
  v_mfma_f32_16x16x32_bf16 v[132:135], a[68:71], a[108:111], v[132:135]
  v_mfma_f32_16x16x32_bf16 v[136:139], a[72:75], a[108:111], v[136:139]
  s_add_u32 m0, s31, 73728
  s_add_u32 s34, s32, 74368
  buffer_load_dwordx4 v3, s[12:15], s34 offen  lds
  v_mfma_f32_16x16x32_bf16 v[140:143], a[76:79], a[108:111], v[140:143]
  ds_read_b128 a[108:111], v6 offset:6144
  s_add_u32 m0, s31, 77824
  s_add_u32 s34, s32, 111232
  buffer_load_dwordx4 v3, s[12:15], s34 offen  lds
  s_waitcnt lgkmcnt(3)
  v_mfma_f32_16x16x32_bf16 v[80:83], a[80:83], a[96:99], v[80:83]
  v_mfma_f32_16x16x32_bf16 v[84:87], a[84:87], a[96:99], v[84:87]
  v_mfma_f32_16x16x32_bf16 v[88:91], a[88:91], a[96:99], v[88:91]
  s_add_u32 m0, s31, 81920
  s_add_u32 s34, s36, 640
  buffer_load_dwordx4 v3, s[12:15], s34 offen  lds
  v_mfma_f32_16x16x32_bf16 v[92:95], a[92:95], a[96:99], v[92:95]
  s_add_u32 m0, s31, 86016
  s_add_u32 s34, s36, 37504
  buffer_load_dwordx4 v3, s[12:15], s34 offen  lds
  s_waitcnt lgkmcnt(2)
  v_mfma_f32_16x16x32_bf16 v[96:99], a[80:83], a[100:103], v[96:99]
  v_mfma_f32_16x16x32_bf16 v[100:103], a[84:87], a[100:103], v[100:103]
  v_mfma_f32_16x16x32_bf16 v[104:107], a[88:91], a[100:103], v[104:107]
  s_add_u32 m0, s31, 90112
  s_add_u32 s34, s36, 74368
  buffer_load_dwordx4 v3, s[12:15], s34 offen  lds
  v_mfma_f32_16x16x32_bf16 v[108:111], a[92:95], a[100:103], v[108:111]
  s_add_u32 m0, s31, 94208
  s_add_u32 s34, s36, 111232
  buffer_load_dwordx4 v3, s[12:15], s34 offen  lds
  v_add_u32 v5, 131072, v5
  v_add_u32 v6, 131072, v6
  v_add_u32 v7, 16384, v7
  v_add_u32 v8, 16384, v8
  v_add_u32 v9, 16384, v9
  v_add_u32 v10, 16384, v10
  s_setprio 0
  s_waitcnt vmcnt(12) lgkmcnt(0)
  s_barrier
  v_mfma_f32_16x16x32_bf16 v[112:115], a[80:83], a[104:107], v[112:115]
  ds_read_b64_tr_b16 a[64:65], v7 offset:32768
  ds_read_b64_tr_b16 a[66:67], v7 offset:33792
  v_mfma_f32_16x16x32_bf16 v[116:119], a[84:87], a[104:107], v[116:119]
  ds_read_b64_tr_b16 a[68:69], v8 offset:32768
  ds_read_b64_tr_b16 a[70:71], v8 offset:33792
  v_mfma_f32_16x16x32_bf16 v[120:123], a[88:91], a[104:107], v[120:123]
  ds_read_b128 a[96:99], v5 offset:0
  v_mfma_f32_16x16x32_bf16 v[124:127], a[92:95], a[104:107], v[124:127]
  ds_read_b64_tr_b16 a[72:73], v9 offset:32768
  ds_read_b128 a[104:107], v5 offset:4096
  v_mfma_f32_16x16x32_bf16 v[128:131], a[80:83], a[108:111], v[128:131]
  ds_read_b64_tr_b16 a[74:75], v9 offset:33792
  v_mfma_f32_16x16x32_bf16 v[132:135], a[84:87], a[108:111], v[132:135]
  ds_read_b64_tr_b16 a[76:77], v10 offset:32768
  v_mfma_f32_16x16x32_bf16 v[136:139], a[88:91], a[108:111], v[136:139]
  ds_read_b64_tr_b16 a[78:79], v10 offset:33792
  v_mfma_f32_16x16x32_bf16 v[140:143], a[92:95], a[108:111], v[140:143]
  ds_read_b128 a[100:103], v5 offset:2048
  ds_read_b128 a[108:111], v5 offset:6144
  s_waitcnt lgkmcnt(2)
  v_mfma_f32_16x16x32_bf16 v[80:83], a[64:67], a[96:99], v[80:83]
  ds_read_b64_tr_b16 a[80:81], v7 offset:40960
  ds_read_b64_tr_b16 a[82:83], v7 offset:41984
  v_mfma_f32_16x16x32_bf16 v[84:87], a[68:71], a[96:99], v[84:87]
  ds_read_b64_tr_b16 a[84:85], v8 offset:40960
  ds_read_b64_tr_b16 a[86:87], v8 offset:41984
  v_mfma_f32_16x16x32_bf16 v[88:91], a[72:75], a[96:99], v[88:91]
  v_cvt_pk_bf16_f32 v16, v16, v17
  v_cvt_pk_bf16_f32 v17, v18, v19
  v_cvt_pk_bf16_f32 v18, v24, v25
  v_cvt_pk_bf16_f32 v19, v26, v27
  s_add_u32 s34, s43, 0
  buffer_store_dwordx4 v[16:19], v11, s[4:7], s34 offen sc1
  v_mfma_f32_16x16x32_bf16 v[92:95], a[76:79], a[96:99], v[92:95]
  ds_read_b128 a[96:99], v6 offset:0
  s_waitcnt lgkmcnt(6)
  v_mfma_f32_16x16x32_bf16 v[96:99], a[64:67], a[100:103], v[96:99]
  ds_read_b64_tr_b16 a[88:89], v9 offset:40960
  ds_read_b64_tr_b16 a[90:91], v9 offset:41984
  v_mfma_f32_16x16x32_bf16 v[100:103], a[68:71], a[100:103], v[100:103]
  ds_read_b64_tr_b16 a[92:93], v10 offset:40960
  ds_read_b64_tr_b16 a[94:95], v10 offset:41984
  v_mfma_f32_16x16x32_bf16 v[104:107], a[72:75], a[100:103], v[104:107]
  v_cvt_pk_bf16_f32 v20, v20, v21
  v_cvt_pk_bf16_f32 v21, v22, v23
  v_cvt_pk_bf16_f32 v22, v28, v29
  v_cvt_pk_bf16_f32 v23, v30, v31
  s_add_u32 s34, s43, 1024
  buffer_store_dwordx4 v[20:23], v11, s[4:7], s34 offen sc1
  v_mfma_f32_16x16x32_bf16 v[108:111], a[76:79], a[100:103], v[108:111]
  ds_read_b128 a[100:103], v6 offset:2048
  s_waitcnt lgkmcnt(12)
  v_mfma_f32_16x16x32_bf16 v[112:115], a[64:67], a[104:107], v[112:115]
  v_mfma_f32_16x16x32_bf16 v[116:119], a[68:71], a[104:107], v[116:119]
  v_mfma_f32_16x16x32_bf16 v[120:123], a[72:75], a[104:107], v[120:123]
  v_cvt_pk_bf16_f32 v32, v32, v33
  v_cvt_pk_bf16_f32 v33, v34, v35
  v_cvt_pk_bf16_f32 v34, v40, v41
  v_cvt_pk_bf16_f32 v35, v42, v43
  s_add_u32 s34, s43, 8192
  buffer_store_dwordx4 v[32:35], v11, s[4:7], s34 offen sc1
  v_mfma_f32_16x16x32_bf16 v[124:127], a[76:79], a[104:107], v[124:127]
  ds_read_b128 a[104:107], v6 offset:4096
  s_waitcnt lgkmcnt(11)
  v_mfma_f32_16x16x32_bf16 v[128:131], a[64:67], a[108:111], v[128:131]
  v_mfma_f32_16x16x32_bf16 v[132:135], a[68:71], a[108:111], v[132:135]
  v_mfma_f32_16x16x32_bf16 v[136:139], a[72:75], a[108:111], v[136:139]
  v_cvt_pk_bf16_f32 v36, v36, v37
  v_cvt_pk_bf16_f32 v37, v38, v39
  v_cvt_pk_bf16_f32 v38, v44, v45
  v_cvt_pk_bf16_f32 v39, v46, v47
  s_add_u32 s34, s43, 9216
  buffer_store_dwordx4 v[36:39], v11, s[4:7], s34 offen sc1
  v_mfma_f32_16x16x32_bf16 v[140:143], a[76:79], a[108:111], v[140:143]
  ds_read_b128 a[108:111], v6 offset:6144
  s_waitcnt lgkmcnt(3)
  v_mfma_f32_16x16x32_bf16 v[80:83], a[80:83], a[96:99], v[80:83]
  v_mfma_f32_16x16x32_bf16 v[84:87], a[84:87], a[96:99], v[84:87]
  v_mfma_f32_16x16x32_bf16 v[88:91], a[88:91], a[96:99], v[88:91]
  v_mfma_f32_16x16x32_bf16 v[92:95], a[92:95], a[96:99], v[92:95]
  s_waitcnt lgkmcnt(2)
  v_mfma_f32_16x16x32_bf16 v[96:99], a[80:83], a[100:103], v[96:99]
  v_mfma_f32_16x16x32_bf16 v[100:103], a[84:87], a[100:103], v[100:103]
  v_mfma_f32_16x16x32_bf16 v[104:107], a[88:91], a[100:103], v[104:107]
  v_mfma_f32_16x16x32_bf16 v[108:111], a[92:95], a[100:103], v[108:111]
  v_add_u32 v5, 4294901760, v5
  v_add_u32 v6, 4294901760, v6
  v_add_u32 v7, 49152, v7
  v_add_u32 v8, 49152, v8
  v_add_u32 v9, 49152, v9
  v_add_u32 v10, 49152, v10
  s_waitcnt vmcnt(4) lgkmcnt(0)
  s_barrier
  v_mfma_f32_16x16x32_bf16 v[112:115], a[80:83], a[104:107], v[112:115]
  ds_read_b64_tr_b16 a[64:65], v7 offset:32768
  ds_read_b64_tr_b16 a[66:67], v7 offset:33792
  v_mfma_f32_16x16x32_bf16 v[116:119], a[84:87], a[104:107], v[116:119]
  ds_read_b64_tr_b16 a[68:69], v8 offset:32768
  ds_read_b64_tr_b16 a[70:71], v8 offset:33792
  v_mfma_f32_16x16x32_bf16 v[120:123], a[88:91], a[104:107], v[120:123]
  ds_read_b128 a[96:99], v5 offset:0
  v_mfma_f32_16x16x32_bf16 v[124:127], a[92:95], a[104:107], v[124:127]
  ds_read_b64_tr_b16 a[72:73], v9 offset:32768
  ds_read_b128 a[104:107], v5 offset:4096
  v_mfma_f32_16x16x32_bf16 v[128:131], a[80:83], a[108:111], v[128:131]
  ds_read_b64_tr_b16 a[74:75], v9 offset:33792
  v_mfma_f32_16x16x32_bf16 v[132:135], a[84:87], a[108:111], v[132:135]
  ds_read_b64_tr_b16 a[76:77], v10 offset:32768
  v_mfma_f32_16x16x32_bf16 v[136:139], a[88:91], a[108:111], v[136:139]
  ds_read_b64_tr_b16 a[78:79], v10 offset:33792
  v_mfma_f32_16x16x32_bf16 v[140:143], a[92:95], a[108:111], v[140:143]
  ds_read_b128 a[100:103], v5 offset:2048
  ds_read_b128 a[108:111], v5 offset:6144
  s_waitcnt lgkmcnt(2)
  v_mfma_f32_16x16x32_bf16 v[80:83], a[64:67], a[96:99], v[80:83]
  ds_read_b64_tr_b16 a[80:81], v7 offset:40960
  ds_read_b64_tr_b16 a[82:83], v7 offset:41984
  v_mfma_f32_16x16x32_bf16 v[84:87], a[68:71], a[96:99], v[84:87]
  ds_read_b64_tr_b16 a[84:85], v8 offset:40960
  ds_read_b64_tr_b16 a[86:87], v8 offset:41984
  v_mfma_f32_16x16x32_bf16 v[88:91], a[72:75], a[96:99], v[88:91]
  v_cvt_pk_bf16_f32 v48, v48, v49
  v_cvt_pk_bf16_f32 v49, v50, v51
  v_cvt_pk_bf16_f32 v50, v56, v57
  v_cvt_pk_bf16_f32 v51, v58, v59
  s_add_u32 s34, s43, 16384
  buffer_store_dwordx4 v[48:51], v11, s[4:7], s34 offen sc1
  v_mfma_f32_16x16x32_bf16 v[92:95], a[76:79], a[96:99], v[92:95]
  ds_read_b128 a[96:99], v6 offset:0
  s_waitcnt lgkmcnt(6)
  v_mfma_f32_16x16x32_bf16 v[96:99], a[64:67], a[100:103], v[96:99]
  ds_read_b64_tr_b16 a[88:89], v9 offset:40960
  ds_read_b64_tr_b16 a[90:91], v9 offset:41984
  v_mfma_f32_16x16x32_bf16 v[100:103], a[68:71], a[100:103], v[100:103]
  ds_read_b64_tr_b16 a[92:93], v10 offset:40960
  ds_read_b64_tr_b16 a[94:95], v10 offset:41984
  v_mfma_f32_16x16x32_bf16 v[104:107], a[72:75], a[100:103], v[104:107]
  v_cvt_pk_bf16_f32 v52, v52, v53
  v_cvt_pk_bf16_f32 v53, v54, v55
  v_cvt_pk_bf16_f32 v54, v60, v61
  v_cvt_pk_bf16_f32 v55, v62, v63
  s_add_u32 s34, s43, 17408
  buffer_store_dwordx4 v[52:55], v11, s[4:7], s34 offen sc1
  v_mfma_f32_16x16x32_bf16 v[108:111], a[76:79], a[100:103], v[108:111]
  ds_read_b128 a[100:103], v6 offset:2048
  s_waitcnt lgkmcnt(12)
  v_mfma_f32_16x16x32_bf16 v[112:115], a[64:67], a[104:107], v[112:115]
  v_mfma_f32_16x16x32_bf16 v[116:119], a[68:71], a[104:107], v[116:119]
  v_mfma_f32_16x16x32_bf16 v[120:123], a[72:75], a[104:107], v[120:123]
  v_cvt_pk_bf16_f32 v64, v64, v65
  v_cvt_pk_bf16_f32 v65, v66, v67
  v_cvt_pk_bf16_f32 v66, v72, v73
  v_cvt_pk_bf16_f32 v67, v74, v75
  s_add_u32 s34, s43, 24576
  buffer_store_dwordx4 v[64:67], v11, s[4:7], s34 offen sc1
  v_mfma_f32_16x16x32_bf16 v[124:127], a[76:79], a[104:107], v[124:127]
  ds_read_b128 a[104:107], v6 offset:4096
  s_waitcnt lgkmcnt(11)
  v_mfma_f32_16x16x32_bf16 v[128:131], a[64:67], a[108:111], v[128:131]
  v_mfma_f32_16x16x32_bf16 v[132:135], a[68:71], a[108:111], v[132:135]
  v_mfma_f32_16x16x32_bf16 v[136:139], a[72:75], a[108:111], v[136:139]
  v_cvt_pk_bf16_f32 v68, v68, v69
  v_cvt_pk_bf16_f32 v69, v70, v71
  v_cvt_pk_bf16_f32 v70, v76, v77
  v_cvt_pk_bf16_f32 v71, v78, v79
  s_add_u32 s34, s43, 25600
  buffer_store_dwordx4 v[68:71], v11, s[4:7], s34 offen sc1
  v_mfma_f32_16x16x32_bf16 v[140:143], a[76:79], a[108:111], v[140:143]
  ds_read_b128 a[108:111], v6 offset:6144
  s_waitcnt lgkmcnt(3)
  v_mfma_f32_16x16x32_bf16 v[80:83], a[80:83], a[96:99], v[80:83]
  v_mfma_f32_16x16x32_bf16 v[84:87], a[84:87], a[96:99], v[84:87]
  v_mfma_f32_16x16x32_bf16 v[88:91], a[88:91], a[96:99], v[88:91]
  v_mfma_f32_16x16x32_bf16 v[92:95], a[92:95], a[96:99], v[92:95]
  s_waitcnt lgkmcnt(2)
  v_mfma_f32_16x16x32_bf16 v[96:99], a[80:83], a[100:103], v[96:99]
  v_mfma_f32_16x16x32_bf16 v[100:103], a[84:87], a[100:103], v[100:103]
  v_mfma_f32_16x16x32_bf16 v[104:107], a[88:91], a[100:103], v[104:107]
  v_mfma_f32_16x16x32_bf16 v[108:111], a[92:95], a[100:103], v[108:111]
  v_add_u32 v5, 4294901760, v5
  v_add_u32 v6, 4294901760, v6
  v_add_u32 v7, 4294901760, v7
  v_add_u32 v8, 4294901760, v8
  v_add_u32 v9, 4294901760, v9
  v_add_u32 v10, 4294901760, v10
  s_waitcnt lgkmcnt(0)
  s_barrier
  v_mfma_f32_16x16x32_bf16 v[112:115], a[80:83], a[104:107], v[112:115]
  ds_read_b64_tr_b16 a[64:65], v7 offset:32768
  ds_read_b64_tr_b16 a[66:67], v7 offset:33792
  v_mfma_f32_16x16x32_bf16 v[116:119], a[84:87], a[104:107], v[116:119]
  ds_read_b64_tr_b16 a[68:69], v8 offset:32768
  ds_read_b64_tr_b16 a[70:71], v8 offset:33792
  v_mfma_f32_16x16x32_bf16 v[120:123], a[88:91], a[104:107], v[120:123]
  ds_read_b128 a[96:99], v5 offset:0
  v_mfma_f32_16x16x32_bf16 v[124:127], a[92:95], a[104:107], v[124:127]
  ds_read_b64_tr_b16 a[72:73], v9 offset:32768
  ds_read_b128 a[104:107], v5 offset:4096
  v_mfma_f32_16x16x32_bf16 v[128:131], a[80:83], a[108:111], v[128:131]
  ds_read_b64_tr_b16 a[74:75], v9 offset:33792
  v_mfma_f32_16x16x32_bf16 v[132:135], a[84:87], a[108:111], v[132:135]
  ds_read_b64_tr_b16 a[76:77], v10 offset:32768
  v_mfma_f32_16x16x32_bf16 v[136:139], a[88:91], a[108:111], v[136:139]
  ds_read_b64_tr_b16 a[78:79], v10 offset:33792
  v_mfma_f32_16x16x32_bf16 v[140:143], a[92:95], a[108:111], v[140:143]
  ds_read_b128 a[100:103], v5 offset:2048
  ds_read_b128 a[108:111], v5 offset:6144
  s_waitcnt lgkmcnt(2)
  v_mfma_f32_16x16x32_bf16 v[80:83], a[64:67], a[96:99], v[80:83]
  ds_read_b64_tr_b16 a[80:81], v7 offset:40960
  ds_read_b64_tr_b16 a[82:83], v7 offset:41984
  v_mfma_f32_16x16x32_bf16 v[84:87], a[68:71], a[96:99], v[84:87]
  ds_read_b64_tr_b16 a[84:85], v8 offset:40960
  ds_read_b64_tr_b16 a[86:87], v8 offset:41984
  v_mfma_f32_16x16x32_bf16 v[88:91], a[72:75], a[96:99], v[88:91]
  v_accvgpr_read_b32 v16, a0
  v_accvgpr_read_b32 v17, a1
  v_accvgpr_read_b32 v18, a2
  v_accvgpr_read_b32 v19, a3
  v_accvgpr_read_b32 v20, a32
  v_accvgpr_read_b32 v21, a33
  v_accvgpr_read_b32 v22, a34
  v_accvgpr_read_b32 v23, a35
  v_cvt_pk_bf16_f32 v16, v16, v17
  v_cvt_pk_bf16_f32 v17, v18, v19
  v_cvt_pk_bf16_f32 v18, v20, v21
  v_cvt_pk_bf16_f32 v19, v22, v23
  s_add_u32 s34, s42, 0
  buffer_store_dwordx4 v[16:19], v11, s[4:7], s34 offen sc1
  v_mfma_f32_16x16x32_bf16 v[92:95], a[76:79], a[96:99], v[92:95]
  ds_read_b128 a[96:99], v6 offset:0
  s_waitcnt lgkmcnt(6)
  v_mfma_f32_16x16x32_bf16 v[96:99], a[64:67], a[100:103], v[96:99]
  ds_read_b64_tr_b16 a[88:89], v9 offset:40960
  ds_read_b64_tr_b16 a[90:91], v9 offset:41984
  v_mfma_f32_16x16x32_bf16 v[100:103], a[68:71], a[100:103], v[100:103]
  ds_read_b64_tr_b16 a[92:93], v10 offset:40960
  ds_read_b64_tr_b16 a[94:95], v10 offset:41984
  v_mfma_f32_16x16x32_bf16 v[104:107], a[72:75], a[100:103], v[104:107]
  v_accvgpr_read_b32 v24, a4
  v_accvgpr_read_b32 v25, a5
  v_accvgpr_read_b32 v26, a6
  v_accvgpr_read_b32 v27, a7
  v_accvgpr_read_b32 v28, a36
  v_accvgpr_read_b32 v29, a37
  v_accvgpr_read_b32 v30, a38
  v_accvgpr_read_b32 v31, a39
  v_cvt_pk_bf16_f32 v24, v24, v25
  v_cvt_pk_bf16_f32 v25, v26, v27
  v_cvt_pk_bf16_f32 v26, v28, v29
  v_cvt_pk_bf16_f32 v27, v30, v31
  s_add_u32 s34, s42, 4096
  buffer_store_dwordx4 v[24:27], v11, s[4:7], s34 offen sc1
  v_mfma_f32_16x16x32_bf16 v[108:111], a[76:79], a[100:103], v[108:111]
  ds_read_b128 a[100:103], v6 offset:2048
  s_waitcnt lgkmcnt(12)
  v_mfma_f32_16x16x32_bf16 v[112:115], a[64:67], a[104:107], v[112:115]
  v_mfma_f32_16x16x32_bf16 v[116:119], a[68:71], a[104:107], v[116:119]
  v_mfma_f32_16x16x32_bf16 v[120:123], a[72:75], a[104:107], v[120:123]
  v_accvgpr_read_b32 v32, a8
  v_accvgpr_read_b32 v33, a9
  v_accvgpr_read_b32 v34, a10
  v_accvgpr_read_b32 v35, a11
  v_accvgpr_read_b32 v36, a40
  v_accvgpr_read_b32 v37, a41
  v_accvgpr_read_b32 v38, a42
  v_accvgpr_read_b32 v39, a43
  v_cvt_pk_bf16_f32 v32, v32, v33
  v_cvt_pk_bf16_f32 v33, v34, v35
  v_cvt_pk_bf16_f32 v34, v36, v37
  v_cvt_pk_bf16_f32 v35, v38, v39
  s_add_u32 s34, s42, 8192
  buffer_store_dwordx4 v[32:35], v11, s[4:7], s34 offen sc1
  v_mfma_f32_16x16x32_bf16 v[124:127], a[76:79], a[104:107], v[124:127]
  ds_read_b128 a[104:107], v6 offset:4096
  s_waitcnt lgkmcnt(11)
  v_mfma_f32_16x16x32_bf16 v[128:131], a[64:67], a[108:111], v[128:131]
  v_mfma_f32_16x16x32_bf16 v[132:135], a[68:71], a[108:111], v[132:135]
  v_mfma_f32_16x16x32_bf16 v[136:139], a[72:75], a[108:111], v[136:139]
  v_accvgpr_read_b32 v40, a12
  v_accvgpr_read_b32 v41, a13
  v_accvgpr_read_b32 v42, a14
  v_accvgpr_read_b32 v43, a15
  v_accvgpr_read_b32 v44, a44
  v_accvgpr_read_b32 v45, a45
  v_accvgpr_read_b32 v46, a46
  v_accvgpr_read_b32 v47, a47
  v_cvt_pk_bf16_f32 v40, v40, v41
  v_cvt_pk_bf16_f32 v41, v42, v43
  v_cvt_pk_bf16_f32 v42, v44, v45
  v_cvt_pk_bf16_f32 v43, v46, v47
  s_add_u32 s34, s42, 12288
  buffer_store_dwordx4 v[40:43], v11, s[4:7], s34 offen sc1
  v_mfma_f32_16x16x32_bf16 v[140:143], a[76:79], a[108:111], v[140:143]
  ds_read_b128 a[108:111], v6 offset:6144
  s_waitcnt lgkmcnt(3)
  v_mfma_f32_16x16x32_bf16 v[80:83], a[80:83], a[96:99], v[80:83]
  v_mfma_f32_16x16x32_bf16 v[84:87], a[84:87], a[96:99], v[84:87]
  v_mfma_f32_16x16x32_bf16 v[88:91], a[88:91], a[96:99], v[88:91]
  v_mfma_f32_16x16x32_bf16 v[92:95], a[92:95], a[96:99], v[92:95]
  s_waitcnt lgkmcnt(2)
  v_mfma_f32_16x16x32_bf16 v[96:99], a[80:83], a[100:103], v[96:99]
  v_mfma_f32_16x16x32_bf16 v[100:103], a[84:87], a[100:103], v[100:103]
  v_mfma_f32_16x16x32_bf16 v[104:107], a[88:91], a[100:103], v[104:107]
  v_mfma_f32_16x16x32_bf16 v[108:111], a[92:95], a[100:103], v[108:111]
  v_add_u32 v5, 131072, v5
  v_add_u32 v6, 131072, v6
  v_add_u32 v7, 16384, v7
  v_add_u32 v8, 16384, v8
  v_add_u32 v9, 16384, v9
  v_add_u32 v10, 16384, v10
  s_waitcnt lgkmcnt(0)
  s_barrier
  v_mfma_f32_16x16x32_bf16 v[112:115], a[80:83], a[104:107], v[112:115]
  ds_read_b64_tr_b16 a[64:65], v7 offset:32768
  ds_read_b64_tr_b16 a[66:67], v7 offset:33792
  v_mfma_f32_16x16x32_bf16 v[116:119], a[84:87], a[104:107], v[116:119]
  ds_read_b64_tr_b16 a[68:69], v8 offset:32768
  ds_read_b64_tr_b16 a[70:71], v8 offset:33792
  v_mfma_f32_16x16x32_bf16 v[120:123], a[88:91], a[104:107], v[120:123]
  ds_read_b128 a[96:99], v5 offset:0
  v_mfma_f32_16x16x32_bf16 v[124:127], a[92:95], a[104:107], v[124:127]
  ds_read_b64_tr_b16 a[72:73], v9 offset:32768
  ds_read_b128 a[104:107], v5 offset:4096
  v_mfma_f32_16x16x32_bf16 v[128:131], a[80:83], a[108:111], v[128:131]
  ds_read_b64_tr_b16 a[74:75], v9 offset:33792
  v_mfma_f32_16x16x32_bf16 v[132:135], a[84:87], a[108:111], v[132:135]
  ds_read_b64_tr_b16 a[76:77], v10 offset:32768
  v_mfma_f32_16x16x32_bf16 v[136:139], a[88:91], a[108:111], v[136:139]
  ds_read_b64_tr_b16 a[78:79], v10 offset:33792
  v_mfma_f32_16x16x32_bf16 v[140:143], a[92:95], a[108:111], v[140:143]
  ds_read_b128 a[100:103], v5 offset:2048
  ds_read_b128 a[108:111], v5 offset:6144
  s_waitcnt lgkmcnt(2)
  v_mfma_f32_16x16x32_bf16 v[80:83], a[64:67], a[96:99], v[80:83]
  ds_read_b64_tr_b16 a[80:81], v7 offset:40960
  ds_read_b64_tr_b16 a[82:83], v7 offset:41984
  v_mfma_f32_16x16x32_bf16 v[84:87], a[68:71], a[96:99], v[84:87]
  ds_read_b64_tr_b16 a[84:85], v8 offset:40960
  ds_read_b64_tr_b16 a[86:87], v8 offset:41984
  v_mfma_f32_16x16x32_bf16 v[88:91], a[72:75], a[96:99], v[88:91]
  v_accvgpr_read_b32 v16, a16
  v_accvgpr_read_b32 v17, a17
  v_accvgpr_read_b32 v18, a18
  v_accvgpr_read_b32 v19, a19
  v_accvgpr_read_b32 v20, a48
  v_accvgpr_read_b32 v21, a49
  v_accvgpr_read_b32 v22, a50
  v_accvgpr_read_b32 v23, a51
  v_cvt_pk_bf16_f32 v16, v16, v17
  v_cvt_pk_bf16_f32 v17, v18, v19
  v_cvt_pk_bf16_f32 v18, v20, v21
  v_cvt_pk_bf16_f32 v19, v22, v23
  s_add_u32 s34, s42, 16384
  buffer_store_dwordx4 v[16:19], v11, s[4:7], s34 offen sc1
  v_mfma_f32_16x16x32_bf16 v[92:95], a[76:79], a[96:99], v[92:95]
  ds_read_b128 a[96:99], v6 offset:0
  s_waitcnt lgkmcnt(6)
  v_mfma_f32_16x16x32_bf16 v[96:99], a[64:67], a[100:103], v[96:99]
  ds_read_b64_tr_b16 a[88:89], v9 offset:40960
  ds_read_b64_tr_b16 a[90:91], v9 offset:41984
  v_mfma_f32_16x16x32_bf16 v[100:103], a[68:71], a[100:103], v[100:103]
  ds_read_b64_tr_b16 a[92:93], v10 offset:40960
  ds_read_b64_tr_b16 a[94:95], v10 offset:41984
  v_mfma_f32_16x16x32_bf16 v[104:107], a[72:75], a[100:103], v[104:107]
  v_accvgpr_read_b32 v24, a20
  v_accvgpr_read_b32 v25, a21
  v_accvgpr_read_b32 v26, a22
  v_accvgpr_read_b32 v27, a23
  v_accvgpr_read_b32 v28, a52
  v_accvgpr_read_b32 v29, a53
  v_accvgpr_read_b32 v30, a54
  v_accvgpr_read_b32 v31, a55
  v_cvt_pk_bf16_f32 v24, v24, v25
  v_cvt_pk_bf16_f32 v25, v26, v27
  v_cvt_pk_bf16_f32 v26, v28, v29
  v_cvt_pk_bf16_f32 v27, v30, v31
  s_add_u32 s34, s42, 20480
  buffer_store_dwordx4 v[24:27], v11, s[4:7], s34 offen sc1
  v_mfma_f32_16x16x32_bf16 v[108:111], a[76:79], a[100:103], v[108:111]
  ds_read_b128 a[100:103], v6 offset:2048
  s_waitcnt lgkmcnt(12)
  v_mfma_f32_16x16x32_bf16 v[112:115], a[64:67], a[104:107], v[112:115]
  v_mfma_f32_16x16x32_bf16 v[116:119], a[68:71], a[104:107], v[116:119]
  v_mfma_f32_16x16x32_bf16 v[120:123], a[72:75], a[104:107], v[120:123]
  v_accvgpr_read_b32 v32, a24
  v_accvgpr_read_b32 v33, a25
  v_accvgpr_read_b32 v34, a26
  v_accvgpr_read_b32 v35, a27
  v_accvgpr_read_b32 v36, a56
  v_accvgpr_read_b32 v37, a57
  v_accvgpr_read_b32 v38, a58
  v_accvgpr_read_b32 v39, a59
  v_cvt_pk_bf16_f32 v32, v32, v33
  v_cvt_pk_bf16_f32 v33, v34, v35
  v_cvt_pk_bf16_f32 v34, v36, v37
  v_cvt_pk_bf16_f32 v35, v38, v39
  s_add_u32 s34, s42, 24576
  buffer_store_dwordx4 v[32:35], v11, s[4:7], s34 offen sc1
  v_mfma_f32_16x16x32_bf16 v[124:127], a[76:79], a[104:107], v[124:127]
  ds_read_b128 a[104:107], v6 offset:4096
  s_waitcnt lgkmcnt(11)
  v_mfma_f32_16x16x32_bf16 v[128:131], a[64:67], a[108:111], v[128:131]
  v_mfma_f32_16x16x32_bf16 v[132:135], a[68:71], a[108:111], v[132:135]
  v_mfma_f32_16x16x32_bf16 v[136:139], a[72:75], a[108:111], v[136:139]
  v_accvgpr_read_b32 v40, a28
  v_accvgpr_read_b32 v41, a29
  v_accvgpr_read_b32 v42, a30
  v_accvgpr_read_b32 v43, a31
  v_accvgpr_read_b32 v44, a60
  v_accvgpr_read_b32 v45, a61
  v_accvgpr_read_b32 v46, a62
  v_accvgpr_read_b32 v47, a63
  v_cvt_pk_bf16_f32 v40, v40, v41
  v_cvt_pk_bf16_f32 v41, v42, v43
  v_cvt_pk_bf16_f32 v42, v44, v45
  v_cvt_pk_bf16_f32 v43, v46, v47
  s_add_u32 s34, s42, 28672
  buffer_store_dwordx4 v[40:43], v11, s[4:7], s34 offen sc1
  v_mfma_f32_16x16x32_bf16 v[140:143], a[76:79], a[108:111], v[140:143]
  ds_read_b128 a[108:111], v6 offset:6144
  s_waitcnt lgkmcnt(3)
  v_mfma_f32_16x16x32_bf16 v[80:83], a[80:83], a[96:99], v[80:83]
  v_mfma_f32_16x16x32_bf16 v[84:87], a[84:87], a[96:99], v[84:87]
  v_mfma_f32_16x16x32_bf16 v[88:91], a[88:91], a[96:99], v[88:91]
  v_mov_b32 v14, 0
  s_cmp_lg_u32 s28, 0
  s_cbranch_scc1 F1_NOEL
  buffer_load_dwordx2 v[2:3], v14, s[8:11], 0 offen sc0 sc1
F1_NOEL:
  v_mfma_f32_16x16x32_bf16 v[92:95], a[92:95], a[96:99], v[92:95]
  s_waitcnt lgkmcnt(2)
  v_mfma_f32_16x16x32_bf16 v[96:99], a[80:83], a[100:103], v[96:99]
  v_mfma_f32_16x16x32_bf16 v[100:103], a[84:87], a[100:103], v[100:103]
  v_mfma_f32_16x16x32_bf16 v[104:107], a[88:91], a[100:103], v[104:107]
  v_mfma_f32_16x16x32_bf16 v[108:111], a[92:95], a[100:103], v[108:111]
  v_add_u32 v5, 4294901760, v5
  v_add_u32 v6, 4294901760, v6
  v_add_u32 v7, 49152, v7
  v_add_u32 v8, 49152, v8
  v_add_u32 v9, 49152, v9
  v_add_u32 v10, 49152, v10
  s_waitcnt lgkmcnt(0)
  s_barrier
  v_mfma_f32_16x16x32_bf16 v[112:115], a[80:83], a[104:107], v[112:115]
  ds_read_b64_tr_b16 a[64:65], v7 offset:32768
  ds_read_b64_tr_b16 a[66:67], v7 offset:33792
  v_mfma_f32_16x16x32_bf16 v[116:119], a[84:87], a[104:107], v[116:119]
  ds_read_b64_tr_b16 a[68:69], v8 offset:32768
  ds_read_b64_tr_b16 a[70:71], v8 offset:33792
  v_mfma_f32_16x16x32_bf16 v[120:123], a[88:91], a[104:107], v[120:123]
  ds_read_b128 a[96:99], v5 offset:0
  v_mfma_f32_16x16x32_bf16 v[124:127], a[92:95], a[104:107], v[124:127]
  ds_read_b64_tr_b16 a[72:73], v9 offset:32768
  ds_read_b128 a[104:107], v5 offset:4096
  v_mfma_f32_16x16x32_bf16 v[128:131], a[80:83], a[108:111], v[128:131]
  ds_read_b64_tr_b16 a[74:75], v9 offset:33792
  v_mfma_f32_16x16x32_bf16 v[132:135], a[84:87], a[108:111], v[132:135]
  ds_read_b64_tr_b16 a[76:77], v10 offset:32768
  v_mfma_f32_16x16x32_bf16 v[136:139], a[88:91], a[108:111], v[136:139]
  ds_read_b64_tr_b16 a[78:79], v10 offset:33792
  v_mfma_f32_16x16x32_bf16 v[140:143], a[92:95], a[108:111], v[140:143]
  ds_read_b128 a[100:103], v5 offset:2048
  ds_read_b128 a[108:111], v5 offset:6144
  s_waitcnt lgkmcnt(2)
  v_mfma_f32_16x16x32_bf16 v[80:83], a[64:67], a[96:99], v[80:83]
  ds_read_b64_tr_b16 a[80:81], v7 offset:40960
  ds_read_b64_tr_b16 a[82:83], v7 offset:41984
  v_mfma_f32_16x16x32_bf16 v[84:87], a[68:71], a[96:99], v[84:87]
  ds_read_b64_tr_b16 a[84:85], v8 offset:40960
  ds_read_b64_tr_b16 a[86:87], v8 offset:41984
  v_mfma_f32_16x16x32_bf16 v[88:91], a[72:75], a[96:99], v[88:91]
  s_cmp_ge_u32 s96, 576
  s_cbranch_scc1 F1_NOS1L
  s_mul_i32 s34, s96, 3641
  s_lshr_b32 s34, s34, 16
  s_mul_i32 s35, s34, 18
  s_sub_u32 s35, s96, s35
  v_and_b32 v76, 3, v1
  s_lshl_b32 s35, s35, 2
  v_add_u32 v76, s35, v76
  v_lshrrev_b32 v77, 2, v1
  s_lshl_b32 s34, s34, 4
  v_add_u32 v77, s34, v77
  v_mul_u32_u24 v78, 4608, v77
  v_lshl_add_u32 v78, v76, 4, v78
  v_subrev_u32 v79, 3456, v78
  v_lshlrev_b32 v4, 6, v76
  buffer_load_dwordx4 a[48:51], v4, s[92:95], 0 offen offset:0
  buffer_load_dwordx4 a[52:55], v4, s[92:95], 0 offen offset:16
  buffer_load_dwordx4 a[56:59], v4, s[92:95], 0 offen offset:32
  buffer_load_dwordx4 a[60:63], v4, s[92:95], 0 offen offset:48
  buffer_load_dwordx4 v[16:19], v79, s[44:47], 0 offen offset:0
  buffer_load_dwordx4 v[20:23], v79, s[44:47], 0 offen offset:1152
  buffer_load_dwordx4 v[24:27], v79, s[44:47], 0 offen offset:2304
  buffer_load_dwordx4 v[28:31], v78, s[44:47], 0 offen offset:0
  buffer_load_dwordx4 v[32:35], v78, s[44:47], 0 offen offset:1152
  buffer_load_dwordx4 v[36:39], v78, s[44:47], 0 offen offset:2304
  buffer_load_dwordx4 v[40:43], v78, s[44:47], 0 offen offset:3456
  buffer_load_dwordx4 v[44:47], v78, s[48:51], 0 offen offset:0
  buffer_load_dwordx4 v[48:51], v78, s[48:51], 0 offen offset:1152
  buffer_load_dwordx4 v[52:55], v78, s[48:51], 0 offen offset:2304
  buffer_load_dwordx4 v[56:59], v78, s[48:51], 0 offen offset:3456
F1_NOS1L:
  v_mfma_f32_16x16x32_bf16 v[92:95], a[76:79], a[96:99], v[92:95]
  ds_read_b128 a[96:99], v6 offset:0
  s_waitcnt lgkmcnt(6)
  v_mfma_f32_16x16x32_bf16 v[96:99], a[64:67], a[100:103], v[96:99]
  ds_read_b64_tr_b16 a[88:89], v9 offset:40960
  ds_read_b64_tr_b16 a[90:91], v9 offset:41984
  v_mfma_f32_16x16x32_bf16 v[100:103], a[68:71], a[100:103], v[100:103]
  ds_read_b64_tr_b16 a[92:93], v10 offset:40960
  ds_read_b64_tr_b16 a[94:95], v10 offset:41984
  v_mfma_f32_16x16x32_bf16 v[104:107], a[72:75], a[100:103], v[104:107]
  v_mfma_f32_16x16x32_bf16 v[108:111], a[76:79], a[100:103], v[108:111]
  ds_read_b128 a[100:103], v6 offset:2048
  s_waitcnt lgkmcnt(12)
  v_mfma_f32_16x16x32_bf16 v[112:115], a[64:67], a[104:107], v[112:115]
  v_mfma_f32_16x16x32_bf16 v[116:119], a[68:71], a[104:107], v[116:119]
  v_mfma_f32_16x16x32_bf16 v[120:123], a[72:75], a[104:107], v[120:123]
  v_mfma_f32_16x16x32_bf16 v[124:127], a[76:79], a[104:107], v[124:127]
  ds_read_b128 a[104:107], v6 offset:4096
  s_waitcnt lgkmcnt(11)
  v_mfma_f32_16x16x32_bf16 v[128:131], a[64:67], a[108:111], v[128:131]
  v_mfma_f32_16x16x32_bf16 v[132:135], a[68:71], a[108:111], v[132:135]
  v_mfma_f32_16x16x32_bf16 v[136:139], a[72:75], a[108:111], v[136:139]
  v_mfma_f32_16x16x32_bf16 v[140:143], a[76:79], a[108:111], v[140:143]
  ds_read_b128 a[108:111], v6 offset:6144
  s_waitcnt lgkmcnt(3)
  v_mfma_f32_16x16x32_bf16 v[80:83], a[80:83], a[96:99], v[80:83]
  v_mfma_f32_16x16x32_bf16 v[84:87], a[84:87], a[96:99], v[84:87]
  v_mfma_f32_16x16x32_bf16 v[88:91], a[88:91], a[96:99], v[88:91]
  v_mfma_f32_16x16x32_bf16 v[92:95], a[92:95], a[96:99], v[92:95]
  s_waitcnt lgkmcnt(2)
  v_mfma_f32_16x16x32_bf16 v[96:99], a[80:83], a[100:103], v[96:99]
  v_mfma_f32_16x16x32_bf16 v[100:103], a[84:87], a[100:103], v[100:103]
  v_mfma_f32_16x16x32_bf16 v[104:107], a[88:91], a[100:103], v[104:107]
  v_mfma_f32_16x16x32_bf16 v[108:111], a[92:95], a[100:103], v[108:111]
  s_waitcnt lgkmcnt(0)
  v_mfma_f32_16x16x32_bf16 v[112:115], a[80:83], a[104:107], v[112:115]
  v_mfma_f32_16x16x32_bf16 v[116:119], a[84:87], a[104:107], v[116:119]
  v_mfma_f32_16x16x32_bf16 v[120:123], a[88:91], a[104:107], v[120:123]
  v_mfma_f32_16x16x32_bf16 v[124:127], a[92:95], a[104:107], v[124:127]
  v_mfma_f32_16x16x32_bf16 v[128:131], a[80:83], a[108:111], v[128:131]
  v_mfma_f32_16x16x32_bf16 v[132:135], a[84:87], a[108:111], v[132:135]
  v_mfma_f32_16x16x32_bf16 v[136:139], a[88:91], a[108:111], v[136:139]
  v_mfma_f32_16x16x32_bf16 v[140:143], a[92:95], a[108:111], v[140:143]
  s_branch F1_QDONE
F1_Q1:
  s_setprio 0
  s_waitcnt lgkmcnt(0)
  s_barrier
  v_mfma_f32_16x16x32_bf16 a[24:27], a[80:83], a[104:107], a[24:27]
  ds_read_b64_tr_b16 a[64:65], v7 offset:32768
  ds_read_b64_tr_b16 a[66:67], v7 offset:33792
  v_mfma_f32_16x16x32_bf16 a[56:59], a[84:87], a[104:107], a[56:59]
  ds_read_b64_tr_b16 a[68:69], v8 offset:32768
  ds_read_b64_tr_b16 a[70:71], v8 offset:33792
  v_mfma_f32_16x16x32_bf16 v[64:67], a[104:107], a[88:91], v[64:67]
  ds_read_b128 a[96:99], v5 offset:0
  v_mfma_f32_16x16x32_bf16 v[68:71], a[104:107], a[92:95], v[68:71]
  ds_read_b64_tr_b16 a[72:73], v9 offset:32768
  ds_read_b128 a[104:107], v5 offset:4096
  v_mfma_f32_16x16x32_bf16 a[28:31], a[80:83], a[108:111], a[28:31]
  ds_read_b64_tr_b16 a[74:75], v9 offset:33792
  v_mfma_f32_16x16x32_bf16 a[60:63], a[84:87], a[108:111], a[60:63]
  ds_read_b64_tr_b16 a[76:77], v10 offset:32768
  v_mfma_f32_16x16x32_bf16 v[72:75], a[108:111], a[88:91], v[72:75]
  ds_read_b64_tr_b16 a[78:79], v10 offset:33792
  v_mfma_f32_16x16x32_bf16 v[76:79], a[108:111], a[92:95], v[76:79]
  ds_read_b128 a[100:103], v5 offset:2048
  ds_read_b128 a[108:111], v5 offset:6144
  s_waitcnt lgkmcnt(2)
  v_mfma_f32_16x16x32_bf16 v[80:83], a[64:67], a[96:99], v[80:83]
  ds_read_b64_tr_b16 a[80:81], v7 offset:40960
  ds_read_b64_tr_b16 a[82:83], v7 offset:41984
  v_mfma_f32_16x16x32_bf16 v[84:87], a[68:71], a[96:99], v[84:87]
  ds_read_b64_tr_b16 a[84:85], v8 offset:40960
  ds_read_b64_tr_b16 a[86:87], v8 offset:41984
  v_mfma_f32_16x16x32_bf16 v[88:91], a[72:75], a[96:99], v[88:91]
  v_cvt_pk_bf16_f32 v16, v16, v17
  v_cvt_pk_bf16_f32 v17, v18, v19
  v_cvt_pk_bf16_f32 v18, v24, v25
  v_cvt_pk_bf16_f32 v19, v26, v27
  s_add_u32 s34, s43, 0
  buffer_store_dwordx4 v[16:19], v11, s[4:7], s34 offen sc1
  v_mfma_f32_16x16x32_bf16 v[92:95], a[76:79], a[96:99], v[92:95]
  ds_read_b128 a[96:99], v6 offset:0
  s_waitcnt lgkmcnt(6)
  v_mfma_f32_16x16x32_bf16 v[96:99], a[64:67], a[100:103], v[96:99]
  ds_read_b64_tr_b16 a[88:89], v9 offset:40960
  ds_read_b64_tr_b16 a[90:91], v9 offset:41984
  v_mfma_f32_16x16x32_bf16 v[100:103], a[68:71], a[100:103], v[100:103]
  ds_read_b64_tr_b16 a[92:93], v10 offset:40960
  ds_read_b64_tr_b16 a[94:95], v10 offset:41984
  v_mfma_f32_16x16x32_bf16 v[104:107], a[72:75], a[100:103], v[104:107]
  v_cvt_pk_bf16_f32 v20, v20, v21
  v_cvt_pk_bf16_f32 v21, v22, v23
  v_cvt_pk_bf16_f32 v22, v28, v29
  v_cvt_pk_bf16_f32 v23, v30, v31
  s_add_u32 s34, s43, 1024
  buffer_store_dwordx4 v[20:23], v11, s[4:7], s34 offen sc1
  v_mfma_f32_16x16x32_bf16 v[108:111], a[76:79], a[100:103], v[108:111]
  ds_read_b128 a[100:103], v6 offset:2048
  s_waitcnt lgkmcnt(12)
  v_mfma_f32_16x16x32_bf16 v[112:115], a[64:67], a[104:107], v[112:115]
  v_mfma_f32_16x16x32_bf16 v[116:119], a[68:71], a[104:107], v[116:119]
  v_mfma_f32_16x16x32_bf16 v[120:123], a[72:75], a[104:107], v[120:123]
  v_cvt_pk_bf16_f32 v32, v32, v33
  v_cvt_pk_bf16_f32 v33, v34, v35
  v_cvt_pk_bf16_f32 v34, v40, v41
  v_cvt_pk_bf16_f32 v35, v42, v43
  s_add_u32 s34, s43, 8192
  buffer_store_dwordx4 v[32:35], v11, s[4:7], s34 offen sc1
  v_mfma_f32_16x16x32_bf16 v[124:127], a[76:79], a[104:107], v[124:127]
  ds_read_b128 a[104:107], v6 offset:4096
  s_waitcnt lgkmcnt(11)
  v_mfma_f32_16x16x32_bf16 v[128:131], a[64:67], a[108:111], v[128:131]
  v_mfma_f32_16x16x32_bf16 v[132:135], a[68:71], a[108:111], v[132:135]
  v_mfma_f32_16x16x32_bf16 v[136:139], a[72:75], a[108:111], v[136:139]
  v_cvt_pk_bf16_f32 v36, v36, v37
  v_cvt_pk_bf16_f32 v37, v38, v39
  v_cvt_pk_bf16_f32 v38, v44, v45
  v_cvt_pk_bf16_f32 v39, v46, v47
  s_add_u32 s34, s43, 9216
  buffer_store_dwordx4 v[36:39], v11, s[4:7], s34 offen sc1
  v_mfma_f32_16x16x32_bf16 v[140:143], a[76:79], a[108:111], v[140:143]
  ds_read_b128 a[108:111], v6 offset:6144
  s_waitcnt lgkmcnt(3)
  v_mfma_f32_16x16x32_bf16 v[80:83], a[80:83], a[96:99], v[80:83]
  v_mfma_f32_16x16x32_bf16 v[84:87], a[84:87], a[96:99], v[84:87]
  v_mfma_f32_16x16x32_bf16 v[88:91], a[88:91], a[96:99], v[88:91]
  v_mfma_f32_16x16x32_bf16 v[92:95], a[92:95], a[96:99], v[92:95]
  s_waitcnt lgkmcnt(2)
  v_mfma_f32_16x16x32_bf16 v[96:99], a[80:83], a[100:103], v[96:99]
  v_mfma_f32_16x16x32_bf16 v[100:103], a[84:87], a[100:103], v[100:103]
  v_mfma_f32_16x16x32_bf16 v[104:107], a[88:91], a[100:103], v[104:107]
  v_mfma_f32_16x16x32_bf16 v[108:111], a[92:95], a[100:103], v[108:111]
  v_add_u32 v5, 131072, v5
  v_add_u32 v6, 131072, v6
  v_add_u32 v7, 16384, v7
  v_add_u32 v8, 16384, v8
  v_add_u32 v9, 16384, v9
  v_add_u32 v10, 16384, v10
  s_waitcnt lgkmcnt(0)
  s_barrier
  v_mfma_f32_16x16x32_bf16 v[112:115], a[80:83], a[104:107], v[112:115]
  ds_read_b64_tr_b16 a[64:65], v7 offset:32768
  ds_read_b64_tr_b16 a[66:67], v7 offset:33792
  v_mfma_f32_16x16x32_bf16 v[116:119], a[84:87], a[104:107], v[116:119]
  ds_read_b64_tr_b16 a[68:69], v8 offset:32768
  ds_read_b64_tr_b16 a[70:71], v8 offset:33792
  v_mfma_f32_16x16x32_bf16 v[120:123], a[88:91], a[104:107], v[120:123]
  ds_read_b128 a[96:99], v5 offset:0
  v_mfma_f32_16x16x32_bf16 v[124:127], a[92:95], a[104:107], v[124:127]
  ds_read_b64_tr_b16 a[72:73], v9 offset:32768
  ds_read_b128 a[104:107], v5 offset:4096
  v_mfma_f32_16x16x32_bf16 v[128:131], a[80:83], a[108:111], v[128:131]
  ds_read_b64_tr_b16 a[74:75], v9 offset:33792
  v_mfma_f32_16x16x32_bf16 v[132:135], a[84:87], a[108:111], v[132:135]
  ds_read_b64_tr_b16 a[76:77], v10 offset:32768
  v_mfma_f32_16x16x32_bf16 v[136:139], a[88:91], a[108:111], v[136:139]
  ds_read_b64_tr_b16 a[78:79], v10 offset:33792
  v_mfma_f32_16x16x32_bf16 v[140:143], a[92:95], a[108:111], v[140:143]
  ds_read_b128 a[100:103], v5 offset:2048
  ds_read_b128 a[108:111], v5 offset:6144
  s_waitcnt lgkmcnt(2)
  v_mfma_f32_16x16x32_bf16 v[80:83], a[64:67], a[96:99], v[80:83]
  ds_read_b64_tr_b16 a[80:81], v7 offset:40960
  ds_read_b64_tr_b16 a[82:83], v7 offset:41984
  v_mfma_f32_16x16x32_bf16 v[84:87], a[68:71], a[96:99], v[84:87]
  ds_read_b64_tr_b16 a[84:85], v8 offset:40960
  ds_read_b64_tr_b16 a[86:87], v8 offset:41984
  v_mfma_f32_16x16x32_bf16 v[88:91], a[72:75], a[96:99], v[88:91]
  v_cvt_pk_bf16_f32 v48, v48, v49
  v_cvt_pk_bf16_f32 v49, v50, v51
  v_cvt_pk_bf16_f32 v50, v56, v57
  v_cvt_pk_bf16_f32 v51, v58, v59
  s_add_u32 s34, s43, 16384
  buffer_store_dwordx4 v[48:51], v11, s[4:7], s34 offen sc1
  v_mfma_f32_16x16x32_bf16 v[92:95], a[76:79], a[96:99], v[92:95]
  ds_read_b128 a[96:99], v6 offset:0
  s_waitcnt lgkmcnt(6)
  v_mfma_f32_16x16x32_bf16 v[96:99], a[64:67], a[100:103], v[96:99]
  ds_read_b64_tr_b16 a[88:89], v9 offset:40960
  ds_read_b64_tr_b16 a[90:91], v9 offset:41984
  v_mfma_f32_16x16x32_bf16 v[100:103], a[68:71], a[100:103], v[100:103]
  ds_read_b64_tr_b16 a[92:93], v10 offset:40960
  ds_read_b64_tr_b16 a[94:95], v10 offset:41984
  v_mfma_f32_16x16x32_bf16 v[104:107], a[72:75], a[100:103], v[104:107]
  v_cvt_pk_bf16_f32 v52, v52, v53
  v_cvt_pk_bf16_f32 v53, v54, v55
  v_cvt_pk_bf16_f32 v54, v60, v61
  v_cvt_pk_bf16_f32 v55, v62, v63
  s_add_u32 s34, s43, 17408
  buffer_store_dwordx4 v[52:55], v11, s[4:7], s34 offen sc1
  v_mfma_f32_16x16x32_bf16 v[108:111], a[76:79], a[100:103], v[108:111]
  ds_read_b128 a[100:103], v6 offset:2048
  s_waitcnt lgkmcnt(12)
  v_mfma_f32_16x16x32_bf16 v[112:115], a[64:67], a[104:107], v[112:115]
  v_mfma_f32_16x16x32_bf16 v[116:119], a[68:71], a[104:107], v[116:119]
  v_mfma_f32_16x16x32_bf16 v[120:123], a[72:75], a[104:107], v[120:123]
  v_cvt_pk_bf16_f32 v64, v64, v65
  v_cvt_pk_bf16_f32 v65, v66, v67
  v_cvt_pk_bf16_f32 v66, v72, v73
  v_cvt_pk_bf16_f32 v67, v74, v75
  s_add_u32 s34, s43, 24576
  buffer_store_dwordx4 v[64:67], v11, s[4:7], s34 offen sc1
  v_mfma_f32_16x16x32_bf16 v[124:127], a[76:79], a[104:107], v[124:127]
  ds_read_b128 a[104:107], v6 offset:4096
  s_waitcnt lgkmcnt(11)
  v_mfma_f32_16x16x32_bf16 v[128:131], a[64:67], a[108:111], v[128:131]
  v_mfma_f32_16x16x32_bf16 v[132:135], a[68:71], a[108:111], v[132:135]
  v_mfma_f32_16x16x32_bf16 v[136:139], a[72:75], a[108:111], v[136:139]
  v_cvt_pk_bf16_f32 v68, v68, v69
  v_cvt_pk_bf16_f32 v69, v70, v71
  v_cvt_pk_bf16_f32 v70, v76, v77
  v_cvt_pk_bf16_f32 v71, v78, v79
  s_add_u32 s34, s43, 25600
  buffer_store_dwordx4 v[68:71], v11, s[4:7], s34 offen sc1
  v_mfma_f32_16x16x32_bf16 v[140:143], a[76:79], a[108:111], v[140:143]
  ds_read_b128 a[108:111], v6 offset:6144
  s_waitcnt lgkmcnt(3)
  v_mfma_f32_16x16x32_bf16 v[80:83], a[80:83], a[96:99], v[80:83]
  v_mfma_f32_16x16x32_bf16 v[84:87], a[84:87], a[96:99], v[84:87]
  v_mfma_f32_16x16x32_bf16 v[88:91], a[88:91], a[96:99], v[88:91]
  v_mfma_f32_16x16x32_bf16 v[92:95], a[92:95], a[96:99], v[92:95]
  s_waitcnt lgkmcnt(2)
  v_mfma_f32_16x16x32_bf16 v[96:99], a[80:83], a[100:103], v[96:99]
  v_mfma_f32_16x16x32_bf16 v[100:103], a[84:87], a[100:103], v[100:103]
  v_mfma_f32_16x16x32_bf16 v[104:107], a[88:91], a[100:103], v[104:107]
  v_mfma_f32_16x16x32_bf16 v[108:111], a[92:95], a[100:103], v[108:111]
  v_add_u32 v5, 4294901760, v5
  v_add_u32 v6, 4294901760, v6
  v_add_u32 v7, 49152, v7
  v_add_u32 v8, 49152, v8
  v_add_u32 v9, 49152, v9
  v_add_u32 v10, 49152, v10
  s_waitcnt lgkmcnt(0)
  s_barrier
  v_mfma_f32_16x16x32_bf16 v[112:115], a[80:83], a[104:107], v[112:115]
  ds_read_b64_tr_b16 a[64:65], v7 offset:32768
  ds_read_b64_tr_b16 a[66:67], v7 offset:33792
  v_mfma_f32_16x16x32_bf16 v[116:119], a[84:87], a[104:107], v[116:119]
  ds_read_b64_tr_b16 a[68:69], v8 offset:32768
  ds_read_b64_tr_b16 a[70:71], v8 offset:33792
  v_mfma_f32_16x16x32_bf16 v[120:123], a[88:91], a[104:107], v[120:123]
  ds_read_b128 a[96:99], v5 offset:0
  v_mfma_f32_16x16x32_bf16 v[124:127], a[92:95], a[104:107], v[124:127]
  ds_read_b64_tr_b16 a[72:73], v9 offset:32768
  ds_read_b128 a[104:107], v5 offset:4096
  v_mfma_f32_16x16x32_bf16 v[128:131], a[80:83], a[108:111], v[128:131]
  ds_read_b64_tr_b16 a[74:75], v9 offset:33792
  v_mfma_f32_16x16x32_bf16 v[132:135], a[84:87], a[108:111], v[132:135]
  ds_read_b64_tr_b16 a[76:77], v10 offset:32768
  v_mfma_f32_16x16x32_bf16 v[136:139], a[88:91], a[108:111], v[136:139]
  ds_read_b64_tr_b16 a[78:79], v10 offset:33792
  v_mfma_f32_16x16x32_bf16 v[140:143], a[92:95], a[108:111], v[140:143]
  ds_read_b128 a[100:103], v5 offset:2048
  ds_read_b128 a[108:111], v5 offset:6144
  s_waitcnt lgkmcnt(2)
  v_mfma_f32_16x16x32_bf16 v[80:83], a[64:67], a[96:99], v[80:83]
  ds_read_b64_tr_b16 a[80:81], v7 offset:40960
  ds_read_b64_tr_b16 a[82:83], v7 offset:41984
  v_mfma_f32_16x16x32_bf16 v[84:87], a[68:71], a[96:99], v[84:87]
  ds_read_b64_tr_b16 a[84:85], v8 offset:40960
  ds_read_b64_tr_b16 a[86:87], v8 offset:41984
  v_mfma_f32_16x16x32_bf16 v[88:91], a[72:75], a[96:99], v[88:91]
  v_accvgpr_read_b32 v16, a0
  v_accvgpr_read_b32 v17, a1
  v_accvgpr_read_b32 v18, a2
  v_accvgpr_read_b32 v19, a3
  v_accvgpr_read_b32 v20, a32
  v_accvgpr_read_b32 v21, a33
  v_accvgpr_read_b32 v22, a34
  v_accvgpr_read_b32 v23, a35
  v_cvt_pk_bf16_f32 v16, v16, v17
  v_cvt_pk_bf16_f32 v17, v18, v19
  v_cvt_pk_bf16_f32 v18, v20, v21
  v_cvt_pk_bf16_f32 v19, v22, v23
  s_add_u32 s34, s42, 0
  buffer_store_dwordx4 v[16:19], v11, s[4:7], s34 offen sc1
  v_mfma_f32_16x16x32_bf16 v[92:95], a[76:79], a[96:99], v[92:95]
  ds_read_b128 a[96:99], v6 offset:0
  s_waitcnt lgkmcnt(6)
  v_mfma_f32_16x16x32_bf16 v[96:99], a[64:67], a[100:103], v[96:99]
  ds_read_b64_tr_b16 a[88:89], v9 offset:40960
  ds_read_b64_tr_b16 a[90:91], v9 offset:41984
  v_mfma_f32_16x16x32_bf16 v[100:103], a[68:71], a[100:103], v[100:103]
  ds_read_b64_tr_b16 a[92:93], v10 offset:40960
  ds_read_b64_tr_b16 a[94:95], v10 offset:41984
  v_mfma_f32_16x16x32_bf16 v[104:107], a[72:75], a[100:103], v[104:107]
  v_accvgpr_read_b32 v24, a4
  v_accvgpr_read_b32 v25, a5
  v_accvgpr_read_b32 v26, a6
  v_accvgpr_read_b32 v27, a7
  v_accvgpr_read_b32 v28, a36
  v_accvgpr_read_b32 v29, a37
  v_accvgpr_read_b32 v30, a38
  v_accvgpr_read_b32 v31, a39
  v_cvt_pk_bf16_f32 v24, v24, v25
  v_cvt_pk_bf16_f32 v25, v26, v27
  v_cvt_pk_bf16_f32 v26, v28, v29
  v_cvt_pk_bf16_f32 v27, v30, v31
  s_add_u32 s34, s42, 4096
  buffer_store_dwordx4 v[24:27], v11, s[4:7], s34 offen sc1
  v_mfma_f32_16x16x32_bf16 v[108:111], a[76:79], a[100:103], v[108:111]
  ds_read_b128 a[100:103], v6 offset:2048
  s_waitcnt lgkmcnt(12)
  v_mfma_f32_16x16x32_bf16 v[112:115], a[64:67], a[104:107], v[112:115]
  v_mfma_f32_16x16x32_bf16 v[116:119], a[68:71], a[104:107], v[116:119]
  v_mfma_f32_16x16x32_bf16 v[120:123], a[72:75], a[104:107], v[120:123]
  v_accvgpr_read_b32 v32, a8
  v_accvgpr_read_b32 v33, a9
  v_accvgpr_read_b32 v34, a10
  v_accvgpr_read_b32 v35, a11
  v_accvgpr_read_b32 v36, a40
  v_accvgpr_read_b32 v37, a41
  v_accvgpr_read_b32 v38, a42
  v_accvgpr_read_b32 v39, a43
  v_cvt_pk_bf16_f32 v32, v32, v33
  v_cvt_pk_bf16_f32 v33, v34, v35
  v_cvt_pk_bf16_f32 v34, v36, v37
  v_cvt_pk_bf16_f32 v35, v38, v39
  s_add_u32 s34, s42, 8192
  buffer_store_dwordx4 v[32:35], v11, s[4:7], s34 offen sc1
  v_mfma_f32_16x16x32_bf16 v[124:127], a[76:79], a[104:107], v[124:127]
  ds_read_b128 a[104:107], v6 offset:4096
  s_waitcnt lgkmcnt(11)
  v_mfma_f32_16x16x32_bf16 v[128:131], a[64:67], a[108:111], v[128:131]
  v_mfma_f32_16x16x32_bf16 v[132:135], a[68:71], a[108:111], v[132:135]
  v_mfma_f32_16x16x32_bf16 v[136:139], a[72:75], a[108:111], v[136:139]
  v_accvgpr_read_b32 v40, a12
  v_accvgpr_read_b32 v41, a13
  v_accvgpr_read_b32 v42, a14
  v_accvgpr_read_b32 v43, a15
  v_accvgpr_read_b32 v44, a44
  v_accvgpr_read_b32 v45, a45
  v_accvgpr_read_b32 v46, a46
  v_accvgpr_read_b32 v47, a47
  v_cvt_pk_bf16_f32 v40, v40, v41
  v_cvt_pk_bf16_f32 v41, v42, v43
  v_cvt_pk_bf16_f32 v42, v44, v45
  v_cvt_pk_bf16_f32 v43, v46, v47
  s_add_u32 s34, s42, 12288
  buffer_store_dwordx4 v[40:43], v11, s[4:7], s34 offen sc1
  v_mfma_f32_16x16x32_bf16 v[140:143], a[76:79], a[108:111], v[140:143]
  ds_read_b128 a[108:111], v6 offset:6144
  s_waitcnt lgkmcnt(3)
  v_mfma_f32_16x16x32_bf16 v[80:83], a[80:83], a[96:99], v[80:83]
  v_mfma_f32_16x16x32_bf16 v[84:87], a[84:87], a[96:99], v[84:87]
  v_mfma_f32_16x16x32_bf16 v[88:91], a[88:91], a[96:99], v[88:91]
  v_mfma_f32_16x16x32_bf16 v[92:95], a[92:95], a[96:99], v[92:95]
  s_waitcnt lgkmcnt(2)
  v_mfma_f32_16x16x32_bf16 v[96:99], a[80:83], a[100:103], v[96:99]
  v_mfma_f32_16x16x32_bf16 v[100:103], a[84:87], a[100:103], v[100:103]
  v_mfma_f32_16x16x32_bf16 v[104:107], a[88:91], a[100:103], v[104:107]
  v_mfma_f32_16x16x32_bf16 v[108:111], a[92:95], a[100:103], v[108:111]
  v_add_u32 v5, 4294901760, v5
  v_add_u32 v6, 4294901760, v6
  v_add_u32 v7, 4294901760, v7
  v_add_u32 v8, 4294901760, v8
  v_add_u32 v9, 4294901760, v9
  v_add_u32 v10, 4294901760, v10
  s_waitcnt lgkmcnt(0)
  s_barrier
  v_mfma_f32_16x16x32_bf16 v[112:115], a[80:83], a[104:107], v[112:115]
  ds_read_b64_tr_b16 a[64:65], v7 offset:32768
  ds_read_b64_tr_b16 a[66:67], v7 offset:33792
  v_mfma_f32_16x16x32_bf16 v[116:119], a[84:87], a[104:107], v[116:119]
  ds_read_b64_tr_b16 a[68:69], v8 offset:32768
  ds_read_b64_tr_b16 a[70:71], v8 offset:33792
  v_mfma_f32_16x16x32_bf16 v[120:123], a[88:91], a[104:107], v[120:123]
  ds_read_b128 a[96:99], v5 offset:0
  v_mfma_f32_16x16x32_bf16 v[124:127], a[92:95], a[104:107], v[124:127]
  ds_read_b64_tr_b16 a[72:73], v9 offset:32768
  ds_read_b128 a[104:107], v5 offset:4096
  v_mfma_f32_16x16x32_bf16 v[128:131], a[80:83], a[108:111], v[128:131]
  ds_read_b64_tr_b16 a[74:75], v9 offset:33792
  v_mfma_f32_16x16x32_bf16 v[132:135], a[84:87], a[108:111], v[132:135]
  ds_read_b64_tr_b16 a[76:77], v10 offset:32768
  v_mfma_f32_16x16x32_bf16 v[136:139], a[88:91], a[108:111], v[136:139]
  ds_read_b64_tr_b16 a[78:79], v10 offset:33792
  v_mfma_f32_16x16x32_bf16 v[140:143], a[92:95], a[108:111], v[140:143]
  ds_read_b128 a[100:103], v5 offset:2048
  ds_read_b128 a[108:111], v5 offset:6144
  s_waitcnt lgkmcnt(2)
  v_mfma_f32_16x16x32_bf16 v[80:83], a[64:67], a[96:99], v[80:83]
  ds_read_b64_tr_b16 a[80:81], v7 offset:40960
  ds_read_b64_tr_b16 a[82:83], v7 offset:41984
  v_mfma_f32_16x16x32_bf16 v[84:87], a[68:71], a[96:99], v[84:87]
  ds_read_b64_tr_b16 a[84:85], v8 offset:40960
  ds_read_b64_tr_b16 a[86:87], v8 offset:41984
  v_mfma_f32_16x16x32_bf16 v[88:91], a[72:75], a[96:99], v[88:91]
  v_accvgpr_read_b32 v16, a16
  v_accvgpr_read_b32 v17, a17
  v_accvgpr_read_b32 v18, a18
  v_accvgpr_read_b32 v19, a19
  v_accvgpr_read_b32 v20, a48
  v_accvgpr_read_b32 v21, a49
  v_accvgpr_read_b32 v22, a50
  v_accvgpr_read_b32 v23, a51
  v_cvt_pk_bf16_f32 v16, v16, v17
  v_cvt_pk_bf16_f32 v17, v18, v19
  v_cvt_pk_bf16_f32 v18, v20, v21
  v_cvt_pk_bf16_f32 v19, v22, v23
  s_add_u32 s34, s42, 16384
  buffer_store_dwordx4 v[16:19], v11, s[4:7], s34 offen sc1
  v_mfma_f32_16x16x32_bf16 v[92:95], a[76:79], a[96:99], v[92:95]
  ds_read_b128 a[96:99], v6 offset:0
  s_waitcnt lgkmcnt(6)
  v_mfma_f32_16x16x32_bf16 v[96:99], a[64:67], a[100:103], v[96:99]
  ds_read_b64_tr_b16 a[88:89], v9 offset:40960
  ds_read_b64_tr_b16 a[90:91], v9 offset:41984
  v_mfma_f32_16x16x32_bf16 v[100:103], a[68:71], a[100:103], v[100:103]
  ds_read_b64_tr_b16 a[92:93], v10 offset:40960
  ds_read_b64_tr_b16 a[94:95], v10 offset:41984
  v_mfma_f32_16x16x32_bf16 v[104:107], a[72:75], a[100:103], v[104:107]
  v_accvgpr_read_b32 v24, a20
  v_accvgpr_read_b32 v25, a21
  v_accvgpr_read_b32 v26, a22
  v_accvgpr_read_b32 v27, a23
  v_accvgpr_read_b32 v28, a52
  v_accvgpr_read_b32 v29, a53
  v_accvgpr_read_b32 v30, a54
  v_accvgpr_read_b32 v31, a55
  v_cvt_pk_bf16_f32 v24, v24, v25
  v_cvt_pk_bf16_f32 v25, v26, v27
  v_cvt_pk_bf16_f32 v26, v28, v29
  v_cvt_pk_bf16_f32 v27, v30, v31
  s_add_u32 s34, s42, 20480
  buffer_store_dwordx4 v[24:27], v11, s[4:7], s34 offen sc1
  v_mfma_f32_16x16x32_bf16 v[108:111], a[76:79], a[100:103], v[108:111]
  ds_read_b128 a[100:103], v6 offset:2048
  s_waitcnt lgkmcnt(12)
  v_mfma_f32_16x16x32_bf16 v[112:115], a[64:67], a[104:107], v[112:115]
  v_mfma_f32_16x16x32_bf16 v[116:119], a[68:71], a[104:107], v[116:119]
  v_mfma_f32_16x16x32_bf16 v[120:123], a[72:75], a[104:107], v[120:123]
  v_accvgpr_read_b32 v32, a24
  v_accvgpr_read_b32 v33, a25
  v_accvgpr_read_b32 v34, a26
  v_accvgpr_read_b32 v35, a27
  v_accvgpr_read_b32 v36, a56
  v_accvgpr_read_b32 v37, a57
  v_accvgpr_read_b32 v38, a58
  v_accvgpr_read_b32 v39, a59
  v_cvt_pk_bf16_f32 v32, v32, v33
  v_cvt_pk_bf16_f32 v33, v34, v35
  v_cvt_pk_bf16_f32 v34, v36, v37
  v_cvt_pk_bf16_f32 v35, v38, v39
  s_add_u32 s34, s42, 24576
  buffer_store_dwordx4 v[32:35], v11, s[4:7], s34 offen sc1
  v_mfma_f32_16x16x32_bf16 v[124:127], a[76:79], a[104:107], v[124:127]
  ds_read_b128 a[104:107], v6 offset:4096
  s_waitcnt lgkmcnt(11)
  v_mfma_f32_16x16x32_bf16 v[128:131], a[64:67], a[108:111], v[128:131]
  v_mfma_f32_16x16x32_bf16 v[132:135], a[68:71], a[108:111], v[132:135]
  v_mfma_f32_16x16x32_bf16 v[136:139], a[72:75], a[108:111], v[136:139]
  v_accvgpr_read_b32 v40, a28
  v_accvgpr_read_b32 v41, a29
  v_accvgpr_read_b32 v42, a30
  v_accvgpr_read_b32 v43, a31
  v_accvgpr_read_b32 v44, a60
  v_accvgpr_read_b32 v45, a61
  v_accvgpr_read_b32 v46, a62
  v_accvgpr_read_b32 v47, a63
  v_cvt_pk_bf16_f32 v40, v40, v41
  v_cvt_pk_bf16_f32 v41, v42, v43
  v_cvt_pk_bf16_f32 v42, v44, v45
  v_cvt_pk_bf16_f32 v43, v46, v47
  s_add_u32 s34, s42, 28672
  buffer_store_dwordx4 v[40:43], v11, s[4:7], s34 offen sc1
  v_mfma_f32_16x16x32_bf16 v[140:143], a[76:79], a[108:111], v[140:143]
  ds_read_b128 a[108:111], v6 offset:6144
  s_waitcnt lgkmcnt(3)
  v_mfma_f32_16x16x32_bf16 v[80:83], a[80:83], a[96:99], v[80:83]
  v_mfma_f32_16x16x32_bf16 v[84:87], a[84:87], a[96:99], v[84:87]
  v_mfma_f32_16x16x32_bf16 v[88:91], a[88:91], a[96:99], v[88:91]
  v_mfma_f32_16x16x32_bf16 v[92:95], a[92:95], a[96:99], v[92:95]
  s_waitcnt lgkmcnt(2)
  v_mfma_f32_16x16x32_bf16 v[96:99], a[80:83], a[100:103], v[96:99]
  v_mfma_f32_16x16x32_bf16 v[100:103], a[84:87], a[100:103], v[100:103]
  v_mfma_f32_16x16x32_bf16 v[104:107], a[88:91], a[100:103], v[104:107]
  v_mfma_f32_16x16x32_bf16 v[108:111], a[92:95], a[100:103], v[108:111]
  v_add_u32 v5, 131072, v5
  v_add_u32 v6, 131072, v6
  v_add_u32 v7, 16384, v7
  v_add_u32 v8, 16384, v8
  v_add_u32 v9, 16384, v9
  v_add_u32 v10, 16384, v10
  s_setprio 1
  s_waitcnt lgkmcnt(0)
  s_barrier
  v_mfma_f32_16x16x32_bf16 v[112:115], a[80:83], a[104:107], v[112:115]
  ds_read_b64_tr_b16 a[64:65], v7 offset:32768
  ds_read_b64_tr_b16 a[66:67], v7 offset:33792
  v_mfma_f32_16x16x32_bf16 v[116:119], a[84:87], a[104:107], v[116:119]
  ds_read_b64_tr_b16 a[68:69], v8 offset:32768
  ds_read_b64_tr_b16 a[70:71], v8 offset:33792
  v_mfma_f32_16x16x32_bf16 v[120:123], a[88:91], a[104:107], v[120:123]
  ds_read_b128 a[96:99], v5 offset:0
  v_mfma_f32_16x16x32_bf16 v[124:127], a[92:95], a[104:107], v[124:127]
  ds_read_b64_tr_b16 a[72:73], v9 offset:32768
  ds_read_b128 a[104:107], v5 offset:4096
  v_mfma_f32_16x16x32_bf16 v[128:131], a[80:83], a[108:111], v[128:131]
  ds_read_b64_tr_b16 a[74:75], v9 offset:33792
  v_mfma_f32_16x16x32_bf16 v[132:135], a[84:87], a[108:111], v[132:135]
  ds_read_b64_tr_b16 a[76:77], v10 offset:32768
  v_mfma_f32_16x16x32_bf16 v[136:139], a[88:91], a[108:111], v[136:139]
  ds_read_b64_tr_b16 a[78:79], v10 offset:33792
  v_mfma_f32_16x16x32_bf16 v[140:143], a[92:95], a[108:111], v[140:143]
  ds_read_b128 a[100:103], v5 offset:2048
  ds_read_b128 a[108:111], v5 offset:6144
  s_waitcnt lgkmcnt(2)
  v_mfma_f32_16x16x32_bf16 v[80:83], a[64:67], a[96:99], v[80:83]
  ds_read_b64_tr_b16 a[80:81], v7 offset:40960
  ds_read_b64_tr_b16 a[82:83], v7 offset:41984
  v_mfma_f32_16x16x32_bf16 v[84:87], a[68:71], a[96:99], v[84:87]
  ds_read_b64_tr_b16 a[84:85], v8 offset:40960
  ds_read_b64_tr_b16 a[86:87], v8 offset:41984
  v_mfma_f32_16x16x32_bf16 v[88:91], a[72:75], a[96:99], v[88:91]
  s_add_u32 m0, s31, 32768
  s_mov_b32 s34, 3145728
  buffer_load_dwordx4 v4, s[24:27], s34 offen  lds
  v_mfma_f32_16x16x32_bf16 v[92:95], a[76:79], a[96:99], v[92:95]
  ds_read_b128 a[96:99], v6 offset:0
  s_add_u32 m0, s31, 36864
  s_mov_b32 s34, 3276800
  buffer_load_dwordx4 v4, s[24:27], s34 offen  lds
  s_waitcnt lgkmcnt(6)
  v_mfma_f32_16x16x32_bf16 v[96:99], a[64:67], a[100:103], v[96:99]
  ds_read_b64_tr_b16 a[88:89], v9 offset:40960
  ds_read_b64_tr_b16 a[90:91], v9 offset:41984
  v_mfma_f32_16x16x32_bf16 v[100:103], a[68:71], a[100:103], v[100:103]
  ds_read_b64_tr_b16 a[92:93], v10 offset:40960
  ds_read_b64_tr_b16 a[94:95], v10 offset:41984
  v_mfma_f32_16x16x32_bf16 v[104:107], a[72:75], a[100:103], v[104:107]
  s_add_u32 m0, s31, 40960
  s_mov_b32 s34, 3407872
  buffer_load_dwordx4 v4, s[24:27], s34 offen  lds
  v_mfma_f32_16x16x32_bf16 v[108:111], a[76:79], a[100:103], v[108:111]
  ds_read_b128 a[100:103], v6 offset:2048
  s_add_u32 m0, s31, 45056
  s_mov_b32 s34, 3538944
  buffer_load_dwordx4 v4, s[24:27], s34 offen  lds
  s_waitcnt lgkmcnt(12)
  v_mfma_f32_16x16x32_bf16 v[112:115], a[64:67], a[104:107], v[112:115]
  v_mfma_f32_16x16x32_bf16 v[116:119], a[68:71], a[104:107], v[116:119]
  v_mfma_f32_16x16x32_bf16 v[120:123], a[72:75], a[104:107], v[120:123]
  s_add_u32 m0, s31, 0
  s_add_u32 s34, s32, 768
  buffer_load_dwordx4 v3, s[12:15], s34 offen  lds
  v_mfma_f32_16x16x32_bf16 v[124:127], a[76:79], a[104:107], v[124:127]
  ds_read_b128 a[104:107], v6 offset:4096
  s_add_u32 m0, s31, 4096
  s_add_u32 s34, s32, 37632
  buffer_load_dwordx4 v3, s[12:15], s34 offen  lds
  s_waitcnt lgkmcnt(11)
  v_mfma_f32_16x16x32_bf16 v[128:131], a[64:67], a[108:111], v[128:131]
  v_mfma_f32_16x16x32_bf16 v[132:135], a[68:71], a[108:111], v[132:135]
  v_mfma_f32_16x16x32_bf16 v[136:139], a[72:75], a[108:111], v[136:139]
  s_add_u32 m0, s31, 8192
  s_add_u32 s34, s32, 74496
  buffer_load_dwordx4 v3, s[12:15], s34 offen  lds
  v_mfma_f32_16x16x32_bf16 v[140:143], a[76:79], a[108:111], v[140:143]
  ds_read_b128 a[108:111], v6 offset:6144
  s_add_u32 m0, s31, 12288
  s_add_u32 s34, s32, 111360
  buffer_load_dwordx4 v3, s[12:15], s34 offen  lds
  s_waitcnt lgkmcnt(3)
  v_mfma_f32_16x16x32_bf16 v[80:83], a[80:83], a[96:99], v[80:83]
  v_mfma_f32_16x16x32_bf16 v[84:87], a[84:87], a[96:99], v[84:87]
  v_mfma_f32_16x16x32_bf16 v[88:91], a[88:91], a[96:99], v[88:91]
  s_add_u32 m0, s31, 16384
  s_add_u32 s34, s36, 768
  buffer_load_dwordx4 v3, s[12:15], s34 offen  lds
  v_mfma_f32_16x16x32_bf16 v[92:95], a[92:95], a[96:99], v[92:95]
  s_add_u32 m0, s31, 20480
  s_add_u32 s34, s36, 37632
  buffer_load_dwordx4 v3, s[12:15], s34 offen  lds
  s_waitcnt lgkmcnt(2)
  v_mfma_f32_16x16x32_bf16 v[96:99], a[80:83], a[100:103], v[96:99]
  v_mfma_f32_16x16x32_bf16 v[100:103], a[84:87], a[100:103], v[100:103]
  v_mfma_f32_16x16x32_bf16 v[104:107], a[88:91], a[100:103], v[104:107]
  s_add_u32 m0, s31, 24576
  s_add_u32 s34, s36, 74496
  buffer_load_dwordx4 v3, s[12:15], s34 offen  lds
  v_mfma_f32_16x16x32_bf16 v[108:111], a[92:95], a[100:103], v[108:111]
  s_add_u32 m0, s31, 28672
  s_add_u32 s34, s36, 111360
  buffer_load_dwordx4 v3, s[12:15], s34 offen  lds
  v_add_u32 v5, 4294901760, v5
  v_add_u32 v6, 4294901760, v6
  v_add_u32 v7, 49152, v7
  v_add_u32 v8, 49152, v8
  v_add_u32 v9, 49152, v9
  v_add_u32 v10, 49152, v10
  s_waitcnt lgkmcnt(0)
  s_barrier
  v_mfma_f32_16x16x32_bf16 v[112:115], a[80:83], a[104:107], v[112:115]
  ds_read_b64_tr_b16 a[64:65], v7 offset:32768
  ds_read_b64_tr_b16 a[66:67], v7 offset:33792
  v_mfma_f32_16x16x32_bf16 v[116:119], a[84:87], a[104:107], v[116:119]
  ds_read_b64_tr_b16 a[68:69], v8 offset:32768
  ds_read_b64_tr_b16 a[70:71], v8 offset:33792
  v_mfma_f32_16x16x32_bf16 v[120:123], a[88:91], a[104:107], v[120:123]
  ds_read_b128 a[96:99], v5 offset:0
  v_mfma_f32_16x16x32_bf16 v[124:127], a[92:95], a[104:107], v[124:127]
  ds_read_b64_tr_b16 a[72:73], v9 offset:32768
  ds_read_b128 a[104:107], v5 offset:4096
  v_mfma_f32_16x16x32_bf16 v[128:131], a[80:83], a[108:111], v[128:131]
  ds_read_b64_tr_b16 a[74:75], v9 offset:33792
  v_mfma_f32_16x16x32_bf16 v[132:135], a[84:87], a[108:111], v[132:135]
  ds_read_b64_tr_b16 a[76:77], v10 offset:32768
  v_mfma_f32_16x16x32_bf16 v[136:139], a[88:91], a[108:111], v[136:139]
  ds_read_b64_tr_b16 a[78:79], v10 offset:33792
  v_mfma_f32_16x16x32_bf16 v[140:143], a[92:95], a[108:111], v[140:143]
  ds_read_b128 a[100:103], v5 offset:2048
  ds_read_b128 a[108:111], v5 offset:6144
  s_waitcnt lgkmcnt(2)
  v_mfma_f32_16x16x32_bf16 v[80:83], a[64:67], a[96:99], v[80:83]
  ds_read_b64_tr_b16 a[80:81], v7 offset:40960
  ds_read_b64_tr_b16 a[82:83], v7 offset:41984
  v_mfma_f32_16x16x32_bf16 v[84:87], a[68:71], a[96:99], v[84:87]
  ds_read_b64_tr_b16 a[84:85], v8 offset:40960
  ds_read_b64_tr_b16 a[86:87], v8 offset:41984
  v_mfma_f32_16x16x32_bf16 v[88:91], a[72:75], a[96:99], v[88:91]
  s_add_u32 m0, s31, 49152
  s_mov_b32 s34, 3670016
  buffer_load_dwordx4 v4, s[24:27], s34 offen  lds
  v_mfma_f32_16x16x32_bf16 v[92:95], a[76:79], a[96:99], v[92:95]
  ds_read_b128 a[96:99], v6 offset:0
  s_add_u32 m0, s31, 53248
  s_mov_b32 s34, 3801088
  buffer_load_dwordx4 v4, s[24:27], s34 offen  lds
  s_waitcnt lgkmcnt(6)
  v_mfma_f32_16x16x32_bf16 v[96:99], a[64:67], a[100:103], v[96:99]
  ds_read_b64_tr_b16 a[88:89], v9 offset:40960
  ds_read_b64_tr_b16 a[90:91], v9 offset:41984
  v_mfma_f32_16x16x32_bf16 v[100:103], a[68:71], a[100:103], v[100:103]
  ds_read_b64_tr_b16 a[92:93], v10 offset:40960
  ds_read_b64_tr_b16 a[94:95], v10 offset:41984
  v_mfma_f32_16x16x32_bf16 v[104:107], a[72:75], a[100:103], v[104:107]
  s_add_u32 m0, s31, 57344
  s_mov_b32 s34, 3932160
  buffer_load_dwordx4 v4, s[24:27], s34 offen  lds
  v_mfma_f32_16x16x32_bf16 v[108:111], a[76:79], a[100:103], v[108:111]
  ds_read_b128 a[100:103], v6 offset:2048
  s_add_u32 m0, s31, 61440
  s_mov_b32 s34, 4063232
  buffer_load_dwordx4 v4, s[24:27], s34 offen  lds
  s_waitcnt lgkmcnt(12)
  v_mfma_f32_16x16x32_bf16 v[112:115], a[64:67], a[104:107], v[112:115]
  v_mfma_f32_16x16x32_bf16 v[116:119], a[68:71], a[104:107], v[116:119]
  v_mfma_f32_16x16x32_bf16 v[120:123], a[72:75], a[104:107], v[120:123]
  s_add_u32 m0, s31, 131072
  s_add_u32 s34, s32, 896
  buffer_load_dwordx4 v3, s[12:15], s34 offen  lds
  v_mfma_f32_16x16x32_bf16 v[124:127], a[76:79], a[104:107], v[124:127]
  ds_read_b128 a[104:107], v6 offset:4096
  s_add_u32 m0, s31, 135168
  s_add_u32 s34, s32, 37760
  buffer_load_dwordx4 v3, s[12:15], s34 offen  lds
  s_waitcnt lgkmcnt(11)
  v_mfma_f32_16x16x32_bf16 v[128:131], a[64:67], a[108:111], v[128:131]
  v_mfma_f32_16x16x32_bf16 v[132:135], a[68:71], a[108:111], v[132:135]
  v_mfma_f32_16x16x32_bf16 v[136:139], a[72:75], a[108:111], v[136:139]
  s_add_u32 m0, s31, 139264
  s_add_u32 s34, s32, 74624
  buffer_load_dwordx4 v3, s[12:15], s34 offen  lds
  v_mfma_f32_16x16x32_bf16 v[140:143], a[76:79], a[108:111], v[140:143]
  ds_read_b128 a[108:111], v6 offset:6144
  s_add_u32 m0, s31, 143360
  s_add_u32 s34, s32, 111488
  buffer_load_dwordx4 v3, s[12:15], s34 offen  lds
  s_waitcnt lgkmcnt(3)
  v_mfma_f32_16x16x32_bf16 v[80:83], a[80:83], a[96:99], v[80:83]
  v_mfma_f32_16x16x32_bf16 v[84:87], a[84:87], a[96:99], v[84:87]
  v_mfma_f32_16x16x32_bf16 v[88:91], a[88:91], a[96:99], v[88:91]
  s_add_u32 m0, s31, 147456
  s_add_u32 s34, s36, 896
  buffer_load_dwordx4 v3, s[12:15], s34 offen  lds
  v_mfma_f32_16x16x32_bf16 v[92:95], a[92:95], a[96:99], v[92:95]
  s_add_u32 m0, s31, 151552
  s_add_u32 s34, s36, 37760
  buffer_load_dwordx4 v3, s[12:15], s34 offen  lds
  s_waitcnt lgkmcnt(2)
  v_mfma_f32_16x16x32_bf16 v[96:99], a[80:83], a[100:103], v[96:99]
  v_mfma_f32_16x16x32_bf16 v[100:103], a[84:87], a[100:103], v[100:103]
  v_mfma_f32_16x16x32_bf16 v[104:107], a[88:91], a[100:103], v[104:107]
  s_add_u32 m0, s31, 155648
  s_add_u32 s34, s36, 74624
  buffer_load_dwordx4 v3, s[12:15], s34 offen  lds
  v_mfma_f32_16x16x32_bf16 v[108:111], a[92:95], a[100:103], v[108:111]
  s_add_u32 m0, s31, 159744
  s_add_u32 s34, s36, 111488
  buffer_load_dwordx4 v3, s[12:15], s34 offen  lds
  v_add_u32 v5, 4294901760, v5
  v_add_u32 v6, 4294901760, v6
  v_add_u32 v7, 4294901760, v7
  v_add_u32 v8, 4294901760, v8
  v_add_u32 v9, 4294901760, v9
  v_add_u32 v10, 4294901760, v10
  s_waitcnt vmcnt(12) lgkmcnt(0)
  s_barrier
  v_mfma_f32_16x16x32_bf16 v[112:115], a[80:83], a[104:107], v[112:115]
  ds_read_b64_tr_b16 a[64:65], v7 offset:32768
  ds_read_b64_tr_b16 a[66:67], v7 offset:33792
  v_mfma_f32_16x16x32_bf16 v[116:119], a[84:87], a[104:107], v[116:119]
  ds_read_b64_tr_b16 a[68:69], v8 offset:32768
  ds_read_b64_tr_b16 a[70:71], v8 offset:33792
  v_mfma_f32_16x16x32_bf16 v[120:123], a[88:91], a[104:107], v[120:123]
  ds_read_b128 a[96:99], v5 offset:0
  v_mfma_f32_16x16x32_bf16 v[124:127], a[92:95], a[104:107], v[124:127]
  ds_read_b64_tr_b16 a[72:73], v9 offset:32768
  ds_read_b128 a[104:107], v5 offset:4096
  v_mfma_f32_16x16x32_bf16 v[128:131], a[80:83], a[108:111], v[128:131]
  ds_read_b64_tr_b16 a[74:75], v9 offset:33792
  v_mfma_f32_16x16x32_bf16 v[132:135], a[84:87], a[108:111], v[132:135]
  ds_read_b64_tr_b16 a[76:77], v10 offset:32768
  v_mfma_f32_16x16x32_bf16 v[136:139], a[88:91], a[108:111], v[136:139]
  ds_read_b64_tr_b16 a[78:79], v10 offset:33792
  v_mfma_f32_16x16x32_bf16 v[140:143], a[92:95], a[108:111], v[140:143]
  ds_read_b128 a[100:103], v5 offset:2048
  ds_read_b128 a[108:111], v5 offset:6144
  s_waitcnt lgkmcnt(2)
  v_mfma_f32_16x16x32_bf16 v[80:83], a[64:67], a[96:99], v[80:83]
  ds_read_b64_tr_b16 a[80:81], v7 offset:40960
  ds_read_b64_tr_b16 a[82:83], v7 offset:41984
  v_mfma_f32_16x16x32_bf16 v[84:87], a[68:71], a[96:99], v[84:87]
  ds_read_b64_tr_b16 a[84:85], v8 offset:40960
  ds_read_b64_tr_b16 a[86:87], v8 offset:41984
  v_mfma_f32_16x16x32_bf16 v[88:91], a[72:75], a[96:99], v[88:91]
  s_add_u32 m0, s31, 98304
  s_mov_b32 s34, 4194304
  buffer_load_dwordx4 v4, s[24:27], s34 offen  lds
  v_mfma_f32_16x16x32_bf16 v[92:95], a[76:79], a[96:99], v[92:95]
  ds_read_b128 a[96:99], v6 offset:0
  s_add_u32 m0, s31, 102400
  s_mov_b32 s34, 4325376
  buffer_load_dwordx4 v4, s[24:27], s34 offen  lds
  s_waitcnt lgkmcnt(6)
  v_mfma_f32_16x16x32_bf16 v[96:99], a[64:67], a[100:103], v[96:99]
  ds_read_b64_tr_b16 a[88:89], v9 offset:40960
  ds_read_b64_tr_b16 a[90:91], v9 offset:41984
  v_mfma_f32_16x16x32_bf16 v[100:103], a[68:71], a[100:103], v[100:103]
  ds_read_b64_tr_b16 a[92:93], v10 offset:40960
  ds_read_b64_tr_b16 a[94:95], v10 offset:41984
  v_mfma_f32_16x16x32_bf16 v[104:107], a[72:75], a[100:103], v[104:107]
  s_add_u32 m0, s31, 106496
  s_mov_b32 s34, 4456448
  buffer_load_dwordx4 v4, s[24:27], s34 offen  lds
  v_mfma_f32_16x16x32_bf16 v[108:111], a[76:79], a[100:103], v[108:111]
  ds_read_b128 a[100:103], v6 offset:2048
  s_add_u32 m0, s31, 110592
  s_mov_b32 s34, 4587520
  buffer_load_dwordx4 v4, s[24:27], s34 offen  lds
  s_waitcnt lgkmcnt(12)
  v_mfma_f32_16x16x32_bf16 v[112:115], a[64:67], a[104:107], v[112:115]
  v_mfma_f32_16x16x32_bf16 v[116:119], a[68:71], a[104:107], v[116:119]
  v_mfma_f32_16x16x32_bf16 v[120:123], a[72:75], a[104:107], v[120:123]
  s_add_u32 m0, s31, 65536
  s_add_u32 s34, s32, 1024
  buffer_load_dwordx4 v3, s[12:15], s34 offen  lds
  v_mfma_f32_16x16x32_bf16 v[124:127], a[76:79], a[104:107], v[124:127]
  ds_read_b128 a[104:107], v6 offset:4096
  s_add_u32 m0, s31, 69632
  s_add_u32 s34, s32, 37888
  buffer_load_dwordx4 v3, s[12:15], s34 offen  lds
  s_waitcnt lgkmcnt(11)
  v_mfma_f32_16x16x32_bf16 v[128:131], a[64:67], a[108:111], v[128:131]
  v_mfma_f32_16x16x32_bf16 v[132:135], a[68:71], a[108:111], v[132:135]
  v_mfma_f32_16x16x32_bf16 v[136:139], a[72:75], a[108:111], v[136:139]
  s_add_u32 m0, s31, 73728
  s_add_u32 s34, s32, 74752
  buffer_load_dwordx4 v3, s[12:15], s34 offen  lds
  v_mfma_f32_16x16x32_bf16 v[140:143], a[76:79], a[108:111], v[140:143]
  ds_read_b128 a[108:111], v6 offset:6144
  s_add_u32 m0, s31, 77824
  s_add_u32 s34, s32, 111616
  buffer_load_dwordx4 v3, s[12:15], s34 offen  lds
  s_waitcnt lgkmcnt(3)
  v_mfma_f32_16x16x32_bf16 v[80:83], a[80:83], a[96:99], v[80:83]
  v_mfma_f32_16x16x32_bf16 v[84:87], a[84:87], a[96:99], v[84:87]
  v_mfma_f32_16x16x32_bf16 v[88:91], a[88:91], a[96:99], v[88:91]
  s_add_u32 m0, s31, 81920
  s_add_u32 s34, s36, 1024
  buffer_load_dwordx4 v3, s[12:15], s34 offen  lds
  v_mfma_f32_16x16x32_bf16 v[92:95], a[92:95], a[96:99], v[92:95]
  s_add_u32 m0, s31, 86016
  s_add_u32 s34, s36, 37888
  buffer_load_dwordx4 v3, s[12:15], s34 offen  lds
  s_waitcnt lgkmcnt(2)
  v_mfma_f32_16x16x32_bf16 v[96:99], a[80:83], a[100:103], v[96:99]
  v_mfma_f32_16x16x32_bf16 v[100:103], a[84:87], a[100:103], v[100:103]
  v_mfma_f32_16x16x32_bf16 v[104:107], a[88:91], a[100:103], v[104:107]
  s_add_u32 m0, s31, 90112
  s_add_u32 s34, s36, 74752
  buffer_load_dwordx4 v3, s[12:15], s34 offen  lds
  v_mfma_f32_16x16x32_bf16 v[108:111], a[92:95], a[100:103], v[108:111]
  s_add_u32 m0, s31, 94208
  s_add_u32 s34, s36, 111616
  buffer_load_dwordx4 v3, s[12:15], s34 offen  lds
  v_add_u32 v5, 131072, v5
  v_add_u32 v6, 131072, v6
  v_add_u32 v7, 16384, v7
  v_add_u32 v8, 16384, v8
  v_add_u32 v9, 16384, v9
  v_add_u32 v10, 16384, v10
  s_waitcnt vmcnt(12) lgkmcnt(0)
  s_barrier
  v_mfma_f32_16x16x32_bf16 v[112:115], a[80:83], a[104:107], v[112:115]
  ds_read_b64_tr_b16 a[64:65], v7 offset:32768
  ds_read_b64_tr_b16 a[66:67], v7 offset:33792
  v_mfma_f32_16x16x32_bf16 v[116:119], a[84:87], a[104:107], v[116:119]
  ds_read_b64_tr_b16 a[68:69], v8 offset:32768
  ds_read_b64_tr_b16 a[70:71], v8 offset:33792
  v_mfma_f32_16x16x32_bf16 v[120:123], a[88:91], a[104:107], v[120:123]
  ds_read_b128 a[96:99], v5 offset:0
  v_mfma_f32_16x16x32_bf16 v[124:127], a[92:95], a[104:107], v[124:127]
  ds_read_b64_tr_b16 a[72:73], v9 offset:32768
  ds_read_b128 a[104:107], v5 offset:4096
  v_mfma_f32_16x16x32_bf16 v[128:131], a[80:83], a[108:111], v[128:131]
  ds_read_b64_tr_b16 a[74:75], v9 offset:33792
  v_mfma_f32_16x16x32_bf16 v[132:135], a[84:87], a[108:111], v[132:135]
  ds_read_b64_tr_b16 a[76:77], v10 offset:32768
  v_mfma_f32_16x16x32_bf16 v[136:139], a[88:91], a[108:111], v[136:139]
  ds_read_b64_tr_b16 a[78:79], v10 offset:33792
  v_mfma_f32_16x16x32_bf16 v[140:143], a[92:95], a[108:111], v[140:143]
  ds_read_b128 a[100:103], v5 offset:2048
  ds_read_b128 a[108:111], v5 offset:6144
  s_waitcnt lgkmcnt(2)
  v_mfma_f32_16x16x32_bf16 v[80:83], a[64:67], a[96:99], v[80:83]
  ds_read_b64_tr_b16 a[80:81], v7 offset:40960
  ds_read_b64_tr_b16 a[82:83], v7 offset:41984
  v_mfma_f32_16x16x32_bf16 v[84:87], a[68:71], a[96:99], v[84:87]
  ds_read_b64_tr_b16 a[84:85], v8 offset:40960
  ds_read_b64_tr_b16 a[86:87], v8 offset:41984
  v_mfma_f32_16x16x32_bf16 v[88:91], a[72:75], a[96:99], v[88:91]
  v_mfma_f32_16x16x32_bf16 v[92:95], a[76:79], a[96:99], v[92:95]
  ds_read_b128 a[96:99], v6 offset:0
  s_waitcnt lgkmcnt(6)
  v_mfma_f32_16x16x32_bf16 v[96:99], a[64:67], a[100:103], v[96:99]
  ds_read_b64_tr_b16 a[88:89], v9 offset:40960
  ds_read_b64_tr_b16 a[90:91], v9 offset:41984
  v_mfma_f32_16x16x32_bf16 v[100:103], a[68:71], a[100:103], v[100:103]
  ds_read_b64_tr_b16 a[92:93], v10 offset:40960
  ds_read_b64_tr_b16 a[94:95], v10 offset:41984
  v_mfma_f32_16x16x32_bf16 v[104:107], a[72:75], a[100:103], v[104:107]
  v_mfma_f32_16x16x32_bf16 v[108:111], a[76:79], a[100:103], v[108:111]
  ds_read_b128 a[100:103], v6 offset:2048
  s_waitcnt lgkmcnt(12)
  v_mfma_f32_16x16x32_bf16 v[112:115], a[64:67], a[104:107], v[112:115]
  v_mfma_f32_16x16x32_bf16 v[116:119], a[68:71], a[104:107], v[116:119]
  v_mfma_f32_16x16x32_bf16 v[120:123], a[72:75], a[104:107], v[120:123]
  v_mfma_f32_16x16x32_bf16 v[124:127], a[76:79], a[104:107], v[124:127]
  ds_read_b128 a[104:107], v6 offset:4096
  s_waitcnt lgkmcnt(11)
  v_mfma_f32_16x16x32_bf16 v[128:131], a[64:67], a[108:111], v[128:131]
  v_mfma_f32_16x16x32_bf16 v[132:135], a[68:71], a[108:111], v[132:135]
  v_mfma_f32_16x16x32_bf16 v[136:139], a[72:75], a[108:111], v[136:139]
  v_mfma_f32_16x16x32_bf16 v[140:143], a[76:79], a[108:111], v[140:143]
  ds_read_b128 a[108:111], v6 offset:6144
  s_waitcnt lgkmcnt(3)
  v_mfma_f32_16x16x32_bf16 v[80:83], a[80:83], a[96:99], v[80:83]
  v_mfma_f32_16x16x32_bf16 v[84:87], a[84:87], a[96:99], v[84:87]
  v_mfma_f32_16x16x32_bf16 v[88:91], a[88:91], a[96:99], v[88:91]
  v_mfma_f32_16x16x32_bf16 v[92:95], a[92:95], a[96:99], v[92:95]
  s_waitcnt lgkmcnt(2)
  v_mfma_f32_16x16x32_bf16 v[96:99], a[80:83], a[100:103], v[96:99]
  v_mfma_f32_16x16x32_bf16 v[100:103], a[84:87], a[100:103], v[100:103]
  v_mfma_f32_16x16x32_bf16 v[104:107], a[88:91], a[100:103], v[104:107]
  v_mfma_f32_16x16x32_bf16 v[108:111], a[92:95], a[100:103], v[108:111]
  v_add_u32 v5, 4294901760, v5
  v_add_u32 v6, 4294901760, v6
  v_add_u32 v7, 49152, v7
  v_add_u32 v8, 49152, v8
  v_add_u32 v9, 49152, v9
  v_add_u32 v10, 49152, v10
  s_waitcnt vmcnt(0) lgkmcnt(0)
  s_barrier
  v_mfma_f32_16x16x32_bf16 v[112:115], a[80:83], a[104:107], v[112:115]
  ds_read_b64_tr_b16 a[64:65], v7 offset:32768
  ds_read_b64_tr_b16 a[66:67], v7 offset:33792
  v_mfma_f32_16x16x32_bf16 v[116:119], a[84:87], a[104:107], v[116:119]
  ds_read_b64_tr_b16 a[68:69], v8 offset:32768
  ds_read_b64_tr_b16 a[70:71], v8 offset:33792
  v_mfma_f32_16x16x32_bf16 v[120:123], a[88:91], a[104:107], v[120:123]
  ds_read_b128 a[96:99], v5 offset:0
  v_mfma_f32_16x16x32_bf16 v[124:127], a[92:95], a[104:107], v[124:127]
  ds_read_b64_tr_b16 a[72:73], v9 offset:32768
  ds_read_b128 a[104:107], v5 offset:4096
  v_mfma_f32_16x16x32_bf16 v[128:131], a[80:83], a[108:111], v[128:131]
  ds_read_b64_tr_b16 a[74:75], v9 offset:33792
  v_mfma_f32_16x16x32_bf16 v[132:135], a[84:87], a[108:111], v[132:135]
  ds_read_b64_tr_b16 a[76:77], v10 offset:32768
  v_mfma_f32_16x16x32_bf16 v[136:139], a[88:91], a[108:111], v[136:139]
  ds_read_b64_tr_b16 a[78:79], v10 offset:33792
  v_mfma_f32_16x16x32_bf16 v[140:143], a[92:95], a[108:111], v[140:143]
  ds_read_b128 a[100:103], v5 offset:2048
  ds_read_b128 a[108:111], v5 offset:6144
  s_waitcnt lgkmcnt(2)
  v_mfma_f32_16x16x32_bf16 v[80:83], a[64:67], a[96:99], v[80:83]
  ds_read_b64_tr_b16 a[80:81], v7 offset:40960
  ds_read_b64_tr_b16 a[82:83], v7 offset:41984
  v_mfma_f32_16x16x32_bf16 v[84:87], a[68:71], a[96:99], v[84:87]
  ds_read_b64_tr_b16 a[84:85], v8 offset:40960
  ds_read_b64_tr_b16 a[86:87], v8 offset:41984
  v_mfma_f32_16x16x32_bf16 v[88:91], a[72:75], a[96:99], v[88:91]
  v_mfma_f32_16x16x32_bf16 v[92:95], a[76:79], a[96:99], v[92:95]
  ds_read_b128 a[96:99], v6 offset:0
  s_waitcnt lgkmcnt(6)
  v_mfma_f32_16x16x32_bf16 v[96:99], a[64:67], a[100:103], v[96:99]
  ds_read_b64_tr_b16 a[88:89], v9 offset:40960
  ds_read_b64_tr_b16 a[90:91], v9 offset:41984
  v_mfma_f32_16x16x32_bf16 v[100:103], a[68:71], a[100:103], v[100:103]
  ds_read_b64_tr_b16 a[92:93], v10 offset:40960
  ds_read_b64_tr_b16 a[94:95], v10 offset:41984
  v_mfma_f32_16x16x32_bf16 v[104:107], a[72:75], a[100:103], v[104:107]
  v_mfma_f32_16x16x32_bf16 v[108:111], a[76:79], a[100:103], v[108:111]
  ds_read_b128 a[100:103], v6 offset:2048
  s_waitcnt lgkmcnt(12)
  v_mfma_f32_16x16x32_bf16 v[112:115], a[64:67], a[104:107], v[112:115]
  v_mfma_f32_16x16x32_bf16 v[116:119], a[68:71], a[104:107], v[116:119]
  v_mfma_f32_16x16x32_bf16 v[120:123], a[72:75], a[104:107], v[120:123]
  v_mfma_f32_16x16x32_bf16 v[124:127], a[76:79], a[104:107], v[124:127]
  ds_read_b128 a[104:107], v6 offset:4096
  s_waitcnt lgkmcnt(11)
  v_mfma_f32_16x16x32_bf16 v[128:131], a[64:67], a[108:111], v[128:131]
  v_mfma_f32_16x16x32_bf16 v[132:135], a[68:71], a[108:111], v[132:135]
  v_mfma_f32_16x16x32_bf16 v[136:139], a[72:75], a[108:111], v[136:139]
  v_mfma_f32_16x16x32_bf16 v[140:143], a[76:79], a[108:111], v[140:143]
  ds_read_b128 a[108:111], v6 offset:6144
  s_waitcnt lgkmcnt(3)
  v_mfma_f32_16x16x32_bf16 v[80:83], a[80:83], a[96:99], v[80:83]
  v_mfma_f32_16x16x32_bf16 v[84:87], a[84:87], a[96:99], v[84:87]
  v_mfma_f32_16x16x32_bf16 v[88:91], a[88:91], a[96:99], v[88:91]
  v_mfma_f32_16x16x32_bf16 v[92:95], a[92:95], a[96:99], v[92:95]
  s_waitcnt lgkmcnt(2)
  v_mfma_f32_16x16x32_bf16 v[96:99], a[80:83], a[100:103], v[96:99]
  v_mfma_f32_16x16x32_bf16 v[100:103], a[84:87], a[100:103], v[100:103]
  v_mfma_f32_16x16x32_bf16 v[104:107], a[88:91], a[100:103], v[104:107]
  v_mfma_f32_16x16x32_bf16 v[108:111], a[92:95], a[100:103], v[108:111]
  s_waitcnt lgkmcnt(0)
  v_mfma_f32_16x16x32_bf16 v[112:115], a[80:83], a[104:107], v[112:115]
  v_mfma_f32_16x16x32_bf16 v[116:119], a[84:87], a[104:107], v[116:119]
  v_mfma_f32_16x16x32_bf16 v[120:123], a[88:91], a[104:107], v[120:123]
  v_mfma_f32_16x16x32_bf16 v[124:127], a[92:95], a[104:107], v[124:127]
  v_mfma_f32_16x16x32_bf16 v[128:131], a[80:83], a[108:111], v[128:131]
  v_mfma_f32_16x16x32_bf16 v[132:135], a[84:87], a[108:111], v[132:135]
  v_mfma_f32_16x16x32_bf16 v[136:139], a[88:91], a[108:111], v[136:139]
  v_mfma_f32_16x16x32_bf16 v[140:143], a[92:95], a[108:111], v[140:143]
F1_QDONE:
  s_setprio 0
  s_mov_b32 s36, 1040356334
  s_lshr_b32 s34, s28, 1
  s_and_b32 s35, s34, 1
  s_lshl_b32 s35, s35, 14
  s_lshr_b32 s34, s34, 1
  s_lshl_b32 s34, s34, 17
  s_add_u32 s34, s34, s35
  s_lshl_b32 s35, s39, 11
  s_add_u32 s34, s34, s35
  v_add_u32 v12, s34, v11
  s_getpc_b64 s[60:61]
F1_ATTN_ct8:
  s_add_u32 s60, s60, F1_ATTN-F1_ATTN_ct8
  s_addc_u32 s61, s61, 0
  v_lshlrev_b32 v8, 7, v0
  v_min_u32 v8, F1_END-F1_ATTN, v8
  v_mov_b32 v9, s61
  v_add_co_u32 v8, vcc, s60, v8
  s_nop 1
  v_addc_co_u32 v9, vcc, 0, v9, vcc
  global_load_dword v15, v[8:9], off
  v_mul_f32 v80, s36, v80
  v_mul_f32 v81, s36, v81
  v_mul_f32 v82, s36, v82
  v_mul_f32 v83, s36, v83
  v_mul_f32 v84, s36, v84
  v_mul_f32 v85, s36, v85
  v_mul_f32 v86, s36, v86
  v_mul_f32 v87, s36, v87
  v_cvt_pk_bf16_f32 v80, v80, v81
  v_cvt_pk_bf16_f32 v81, v82, v83
  v_cvt_pk_bf16_f32 v82, v84, v85
  v_cvt_pk_bf16_f32 v83, v86, v87
  ds_write_b128 v12, v[80:83] offset:0
  v_mul_f32 v88, s36, v88
  v_mul_f32 v89, s36, v89
  v_mul_f32 v90, s36, v90
  v_mul_f32 v91, s36, v91
  v_mul_f32 v92, s36, v92
  v_mul_f32 v93, s36, v93
  v_mul_f32 v94, s36, v94
  v_mul_f32 v95, s36, v95
  v_cvt_pk_bf16_f32 v88, v88, v89
  v_cvt_pk_bf16_f32 v89, v90, v91
  v_cvt_pk_bf16_f32 v90, v92, v93
  v_cvt_pk_bf16_f32 v91, v94, v95
  ds_write_b128 v12, v[88:91] offset:1024
  v_mul_f32 v96, s36, v96
  v_mul_f32 v97, s36, v97
  v_mul_f32 v98, s36, v98
  v_mul_f32 v99, s36, v99
  v_mul_f32 v100, s36, v100
  v_mul_f32 v101, s36, v101
  v_mul_f32 v102, s36, v102
  v_mul_f32 v103, s36, v103
  v_cvt_pk_bf16_f32 v96, v96, v97
  v_cvt_pk_bf16_f32 v97, v98, v99
  v_cvt_pk_bf16_f32 v98, v100, v101
  v_cvt_pk_bf16_f32 v99, v102, v103
  ds_write_b128 v12, v[96:99] offset:4096
  v_mul_f32 v104, s36, v104
  v_mul_f32 v105, s36, v105
  v_mul_f32 v106, s36, v106
  v_mul_f32 v107, s36, v107
  v_mul_f32 v108, s36, v108
  v_mul_f32 v109, s36, v109
  v_mul_f32 v110, s36, v110
  v_mul_f32 v111, s36, v111
  v_cvt_pk_bf16_f32 v104, v104, v105
  v_cvt_pk_bf16_f32 v105, v106, v107
  v_cvt_pk_bf16_f32 v106, v108, v109
  v_cvt_pk_bf16_f32 v107, v110, v111
  ds_write_b128 v12, v[104:107] offset:5120
  v_mul_f32 v112, s36, v112
  v_mul_f32 v113, s36, v113
  v_mul_f32 v114, s36, v114
  v_mul_f32 v115, s36, v115
  v_mul_f32 v116, s36, v116
  v_mul_f32 v117, s36, v117
  v_mul_f32 v118, s36, v118
  v_mul_f32 v119, s36, v119
  v_cvt_pk_bf16_f32 v112, v112, v113
  v_cvt_pk_bf16_f32 v113, v114, v115
  v_cvt_pk_bf16_f32 v114, v116, v117
  v_cvt_pk_bf16_f32 v115, v118, v119
  ds_write_b128 v12, v[112:115] offset:8192
  v_mul_f32 v120, s36, v120
  v_mul_f32 v121, s36, v121
  v_mul_f32 v122, s36, v122
  v_mul_f32 v123, s36, v123
  v_mul_f32 v124, s36, v124
  v_mul_f32 v125, s36, v125
  v_mul_f32 v126, s36, v126
  v_mul_f32 v127, s36, v127
  v_cvt_pk_bf16_f32 v120, v120, v121
  v_cvt_pk_bf16_f32 v121, v122, v123
  v_cvt_pk_bf16_f32 v122, v124, v125
  v_cvt_pk_bf16_f32 v123, v126, v127
  ds_write_b128 v12, v[120:123] offset:9216
  v_mul_f32 v128, s36, v128
  v_mul_f32 v129, s36, v129
  v_mul_f32 v130, s36, v130
  v_mul_f32 v131, s36, v131
  v_mul_f32 v132, s36, v132
  v_mul_f32 v133, s36, v133
  v_mul_f32 v134, s36, v134
  v_mul_f32 v135, s36, v135
  v_cvt_pk_bf16_f32 v128, v128, v129
  v_cvt_pk_bf16_f32 v129, v130, v131
  v_cvt_pk_bf16_f32 v130, v132, v133
  v_cvt_pk_bf16_f32 v131, v134, v135
  ds_write_b128 v12, v[128:131] offset:12288
  v_mul_f32 v136, s36, v136
  v_mul_f32 v137, s36, v137
  v_mul_f32 v138, s36, v138
  v_mul_f32 v139, s36, v139
  v_mul_f32 v140, s36, v140
  v_mul_f32 v141, s36, v141
  v_mul_f32 v142, s36, v142
  v_mul_f32 v143, s36, v143
  v_cvt_pk_bf16_f32 v136, v136, v137
  v_cvt_pk_bf16_f32 v137, v138, v139
  v_cvt_pk_bf16_f32 v138, v140, v141
  v_cvt_pk_bf16_f32 v139, v142, v143
  ds_write_b128 v12, v[136:139] offset:13312
  s_lshl_b32 s60, s30, 10
  s_add_u32 s60, s60, 125829120
  s_lshl_b32 s61, s29, 7
  s_add_u32 s61, s61, s60
  s_lshl_b32 s32, s29, 1
  s_sub_u32 s39, 31, s32
  s_add_u32 s32, s32, 2
  s_lshl_b32 s41, s28, 11
  s_lshl_b32 s40, s30, 20
  s_add_u32 s37, s40, s41
  s_add_u32 s38, s37, 0x80000
  s_lshl_b32 s34, s39, 14
  s_add_u32 s56, s37, s34
  s_add_u32 s57, s38, s34
  s_mov_b32 s58, s41
  s_add_u32 s59, s41, 16384
  s_and_b32 s47, s28, 3
  s_lshl_b32 s48, s29, 2
  s_add_u32 s49, s48, s47
  s_sub_u32 s50, 60, s48
  s_add_u32 s50, s50, s47
  s_lshl_b32 s51, s30, 19
  s_add_u32 s51, s51, 33554432
  s_lshl_b32 s46, s50, 13
  s_add_u32 s46, s46, s51
  s_cmp_lt_u32 s28, 4
  s_cselect_b32 s52, s49, s50
  s_lshl_b32 s33, s52, 5
  s_lshl_b32 s53, s52, 13
  s_add_u32 s53, s53, s51
  s_lshl_b32 s54, s30, 13
  s_add_u32 s54, s54, 50331648
  s_lshl_b32 s45, s49, 18
  s_add_u32 s45, s45, s54
  s_lshl_b32 s55, s50, 18
  s_add_u32 s55, s55, s54
  s_mov_b32 s44, 1266679808
  s_sub_u32 s34, s32, 2
  s_cmp_lt_u32 s28, 4
  s_cselect_b32 s36, 7, 2
  s_lshl_b32 s36, s36, s34
  s_or_b32 s36, s36, 0x18001
  s_waitcnt vmcnt(0) lgkmcnt(0)
  s_barrier
  v_readfirstlane_b32 s98, v2
  v_readfirstlane_b32 s99, v3
  v_mov_b32 v2, v11
  s_cmp_lg_u32 s28, 0
  s_cbranch_scc1 F1_NOSIG
  s_mov_b32 s63, 0x40000
  v_mov_b32 v14, 0
F1_EPL:
  s_cmp_lg_u32 s98, 0
  s_cbranch_scc1 F1_EPOK
  buffer_load_dwordx2 v[12:13], v14, s[8:11], 0 offen sc0 sc1
  s_waitcnt vmcnt(0)
  v_readfirstlane_b32 s98, v12
  v_readfirstlane_b32 s99, v13
  s_sub_u32 s63, s63, 1
  s_cmp_lg_u32 s63, 0
  s_cbranch_scc1 F1_EPL
F1_EPOK:
  v_mov_b32 v12, s98
  v_mov_b32 v13, s99
  s_mov_b64 exec, 1
  buffer_store_dwordx2 v[12:13], v14, s[4:7], s61 offen sc0 sc1
  s_mov_b64 exec, -1
F1_NOSIG:
  s_lshr_b32 s34, s28, 2
  s_lshl_b32 s34, s34, 17
  s_and_b32 s47, s28, 3
  s_lshl_b32 s47, s47, 13
  s_add_u32 s34, s34, s47
  v_add_u32 v14, s34, v2
  ds_read_b128 a[0:3], v14 offset:0
  ds_read_b128 a[4:7], v14 offset:1024
  ds_read_b128 a[8:11], v14 offset:2048
  ds_read_b128 a[12:15], v14 offset:3072
  ds_read_b128 a[16:19], v14 offset:4096
  ds_read_b128 a[20:23], v14 offset:5120
  ds_read_b128 a[24:27], v14 offset:6144
  ds_read_b128 a[28:31], v14 offset:7168
  s_cmp_ge_u32 s96, 576
  s_cbranch_scc1 F1_NOS1
  s_lshl_b32 s15, s28, 13
  s_add_u32 s15, s15, 0x8000
  v_and_b32 v78, 3, v1
  v_lshlrev_b32 v78, 10, v78
  v_add_u32 v78, s15, v78
  v_lshrrev_b32 v77, 2, v1
  v_lshlrev_b32 v77, 3, v77
  v_add_u32 v79, v78, v77
  v_sub_u32 v78, v78, v77
  v_add_u32 v78, 120, v78
  s_mov_b32 s12, 0xffff0000
  s_mov_b32 s13, 0x05040100
  s_mov_b32 s14, 0x07060302
  v_accvgpr_read_b32 v81, a48
  v_accvgpr_read_b32 v83, a49
  v_lshlrev_b32 v84, 16, v16
  v_lshlrev_b32 v85, 16, v20
  v_lshlrev_b32 v86, 16, v24
  v_lshlrev_b32 v87, 16, v28
  v_lshlrev_b32 v88, 16, v32
  v_lshlrev_b32 v89, 16, v36
  v_lshlrev_b32 v90, 16, v40
  v_lshlrev_b32 v80, 16, v81
  v_and_b32 v81, s12, v81
  v_lshlrev_b32 v82, 16, v83
  v_and_b32 v83, s12, v83
  v_mul_f32 v92, v87, v80
  v_fmac_f32 v92, v86, v81
  v_fmac_f32 v92, v85, v82
  v_fmac_f32 v92, v84, v83
  v_mul_f32 v93, v88, v80
  v_fmac_f32 v93, v87, v81
  v_fmac_f32 v93, v86, v82
  v_fmac_f32 v93, v85, v83
  v_mul_f32 v94, v89, v80
  v_fmac_f32 v94, v88, v81
  v_fmac_f32 v94, v87, v82
  v_fmac_f32 v94, v86, v83
  v_mul_f32 v95, v90, v80
  v_fmac_f32 v95, v89, v81
  v_fmac_f32 v95, v88, v82
  v_fmac_f32 v95, v87, v83
  v_lshlrev_b32 v84, 16, v44
  v_lshlrev_b32 v85, 16, v48
  v_lshlrev_b32 v86, 16, v52
  v_lshlrev_b32 v87, 16, v56
  v_mul_f32 v92, v92, v84
  v_mul_f32 v93, v93, v85
  v_mul_f32 v94, v94, v86
  v_mul_f32 v95, v95, v87
  v_cvt_pk_bf16_f32 v96, v95, v94
  v_cvt_pk_bf16_f32 v97, v93, v92
  ds_write_b64 v78, v[96:97] offset:0
  v_accvgpr_read_b32 v81, a50
  v_accvgpr_read_b32 v83, a51
  v_and_b32 v84, s12, v16
  v_and_b32 v85, s12, v20
  v_and_b32 v86, s12, v24
  v_and_b32 v87, s12, v28
  v_and_b32 v88, s12, v32
  v_and_b32 v89, s12, v36
  v_and_b32 v90, s12, v40
  v_lshlrev_b32 v80, 16, v81
  v_and_b32 v81, s12, v81
  v_lshlrev_b32 v82, 16, v83
  v_and_b32 v83, s12, v83
  v_mul_f32 v92, v87, v80
  v_fmac_f32 v92, v86, v81
  v_fmac_f32 v92, v85, v82
  v_fmac_f32 v92, v84, v83
  v_mul_f32 v93, v88, v80
  v_fmac_f32 v93, v87, v81
  v_fmac_f32 v93, v86, v82
  v_fmac_f32 v93, v85, v83
  v_mul_f32 v94, v89, v80
  v_fmac_f32 v94, v88, v81
  v_fmac_f32 v94, v87, v82
  v_fmac_f32 v94, v86, v83
  v_mul_f32 v95, v90, v80
  v_fmac_f32 v95, v89, v81
  v_fmac_f32 v95, v88, v82
  v_fmac_f32 v95, v87, v83
  v_and_b32 v84, s12, v44
  v_and_b32 v85, s12, v48
  v_and_b32 v86, s12, v52
  v_and_b32 v87, s12, v56
  v_mul_f32 v92, v92, v84
  v_mul_f32 v93, v93, v85
  v_mul_f32 v94, v94, v86
  v_mul_f32 v95, v95, v87
  v_cvt_pk_bf16_f32 v100, v95, v94
  v_cvt_pk_bf16_f32 v101, v93, v92
  ds_write_b64 v78, v[100:101] offset:128
  v_accvgpr_read_b32 v81, a52
  v_accvgpr_read_b32 v83, a53
  v_lshlrev_b32 v84, 16, v17
  v_lshlrev_b32 v85, 16, v21
  v_lshlrev_b32 v86, 16, v25
  v_lshlrev_b32 v87, 16, v29
  v_lshlrev_b32 v88, 16, v33
  v_lshlrev_b32 v89, 16, v37
  v_lshlrev_b32 v90, 16, v41
  v_lshlrev_b32 v80, 16, v81
  v_and_b32 v81, s12, v81
  v_lshlrev_b32 v82, 16, v83
  v_and_b32 v83, s12, v83
  v_mul_f32 v92, v87, v80
  v_fmac_f32 v92, v86, v81
  v_fmac_f32 v92, v85, v82
  v_fmac_f32 v92, v84, v83
  v_mul_f32 v93, v88, v80
  v_fmac_f32 v93, v87, v81
  v_fmac_f32 v93, v86, v82
  v_fmac_f32 v93, v85, v83
  v_mul_f32 v94, v89, v80
  v_fmac_f32 v94, v88, v81
  v_fmac_f32 v94, v87, v82
  v_fmac_f32 v94, v86, v83
  v_mul_f32 v95, v90, v80
  v_fmac_f32 v95, v89, v81
  v_fmac_f32 v95, v88, v82
  v_fmac_f32 v95, v87, v83
  v_lshlrev_b32 v84, 16, v45
  v_lshlrev_b32 v85, 16, v49
  v_lshlrev_b32 v86, 16, v53
  v_lshlrev_b32 v87, 16, v57
  v_mul_f32 v92, v92, v84
  v_mul_f32 v93, v93, v85
  v_mul_f32 v94, v94, v86
  v_mul_f32 v95, v95, v87
  v_cvt_pk_bf16_f32 v104, v95, v94
  v_cvt_pk_bf16_f32 v105, v93, v92
  ds_write_b64 v78, v[104:105] offset:256
  v_accvgpr_read_b32 v81, a54
  v_accvgpr_read_b32 v83, a55
  v_and_b32 v84, s12, v17
  v_and_b32 v85, s12, v21
  v_and_b32 v86, s12, v25
  v_and_b32 v87, s12, v29
  v_and_b32 v88, s12, v33
  v_and_b32 v89, s12, v37
  v_and_b32 v90, s12, v41
  v_lshlrev_b32 v80, 16, v81
  v_and_b32 v81, s12, v81
  v_lshlrev_b32 v82, 16, v83
  v_and_b32 v83, s12, v83
  v_mul_f32 v92, v87, v80
  v_fmac_f32 v92, v86, v81
  v_fmac_f32 v92, v85, v82
  v_fmac_f32 v92, v84, v83
  v_mul_f32 v93, v88, v80
  v_fmac_f32 v93, v87, v81
  v_fmac_f32 v93, v86, v82
  v_fmac_f32 v93, v85, v83
  v_mul_f32 v94, v89, v80
  v_fmac_f32 v94, v88, v81
  v_fmac_f32 v94, v87, v82
  v_fmac_f32 v94, v86, v83
  v_mul_f32 v95, v90, v80
  v_fmac_f32 v95, v89, v81
  v_fmac_f32 v95, v88, v82
  v_fmac_f32 v95, v87, v83
  v_and_b32 v84, s12, v45
  v_and_b32 v85, s12, v49
  v_and_b32 v86, s12, v53
  v_and_b32 v87, s12, v57
  v_mul_f32 v92, v92, v84
  v_mul_f32 v93, v93, v85
  v_mul_f32 v94, v94, v86
  v_mul_f32 v95, v95, v87
  v_cvt_pk_bf16_f32 v108, v95, v94
  v_cvt_pk_bf16_f32 v109, v93, v92
  ds_write_b64 v78, v[108:109] offset:384
  v_accvgpr_read_b32 v81, a56
  v_accvgpr_read_b32 v83, a57
  v_lshlrev_b32 v84, 16, v18
  v_lshlrev_b32 v85, 16, v22
  v_lshlrev_b32 v86, 16, v26
  v_lshlrev_b32 v87, 16, v30
  v_lshlrev_b32 v88, 16, v34
  v_lshlrev_b32 v89, 16, v38
  v_lshlrev_b32 v90, 16, v42
  v_lshlrev_b32 v80, 16, v81
  v_and_b32 v81, s12, v81
  v_lshlrev_b32 v82, 16, v83
  v_and_b32 v83, s12, v83
  v_mul_f32 v92, v87, v80
  v_fmac_f32 v92, v86, v81
  v_fmac_f32 v92, v85, v82
  v_fmac_f32 v92, v84, v83
  v_mul_f32 v93, v88, v80
  v_fmac_f32 v93, v87, v81
  v_fmac_f32 v93, v86, v82
  v_fmac_f32 v93, v85, v83
  v_mul_f32 v94, v89, v80
  v_fmac_f32 v94, v88, v81
  v_fmac_f32 v94, v87, v82
  v_fmac_f32 v94, v86, v83
  v_mul_f32 v95, v90, v80
  v_fmac_f32 v95, v89, v81
  v_fmac_f32 v95, v88, v82
  v_fmac_f32 v95, v87, v83
  v_lshlrev_b32 v84, 16, v46
  v_lshlrev_b32 v85, 16, v50
  v_lshlrev_b32 v86, 16, v54
  v_lshlrev_b32 v87, 16, v58
  v_mul_f32 v92, v92, v84
  v_mul_f32 v93, v93, v85
  v_mul_f32 v94, v94, v86
  v_mul_f32 v95, v95, v87
  v_cvt_pk_bf16_f32 v112, v95, v94
  v_cvt_pk_bf16_f32 v113, v93, v92
  ds_write_b64 v78, v[112:113] offset:512
  v_accvgpr_read_b32 v81, a58
  v_accvgpr_read_b32 v83, a59
  v_and_b32 v84, s12, v18
  v_and_b32 v85, s12, v22
  v_and_b32 v86, s12, v26
  v_and_b32 v87, s12, v30
  v_and_b32 v88, s12, v34
  v_and_b32 v89, s12, v38
  v_and_b32 v90, s12, v42
  v_lshlrev_b32 v80, 16, v81
  v_and_b32 v81, s12, v81
  v_lshlrev_b32 v82, 16, v83
  v_and_b32 v83, s12, v83
  v_mul_f32 v92, v87, v80
  v_fmac_f32 v92, v86, v81
  v_fmac_f32 v92, v85, v82
  v_fmac_f32 v92, v84, v83
  v_mul_f32 v93, v88, v80
  v_fmac_f32 v93, v87, v81
  v_fmac_f32 v93, v86, v82
  v_fmac_f32 v93, v85, v83
  v_mul_f32 v94, v89, v80
  v_fmac_f32 v94, v88, v81
  v_fmac_f32 v94, v87, v82
  v_fmac_f32 v94, v86, v83
  v_mul_f32 v95, v90, v80
  v_fmac_f32 v95, v89, v81
  v_fmac_f32 v95, v88, v82
  v_fmac_f32 v95, v87, v83
  v_and_b32 v84, s12, v46
  v_and_b32 v85, s12, v50
  v_and_b32 v86, s12, v54
  v_and_b32 v87, s12, v58
  v_mul_f32 v92, v92, v84
  v_mul_f32 v93, v93, v85
  v_mul_f32 v94, v94, v86
  v_mul_f32 v95, v95, v87
  v_cvt_pk_bf16_f32 v116, v95, v94
  v_cvt_pk_bf16_f32 v117, v93, v92
  ds_write_b64 v78, v[116:117] offset:640
  v_accvgpr_read_b32 v81, a60
  v_accvgpr_read_b32 v83, a61
  v_lshlrev_b32 v84, 16, v19
  v_lshlrev_b32 v85, 16, v23
  v_lshlrev_b32 v86, 16, v27
  v_lshlrev_b32 v87, 16, v31
  v_lshlrev_b32 v88, 16, v35
  v_lshlrev_b32 v89, 16, v39
  v_lshlrev_b32 v90, 16, v43
  v_lshlrev_b32 v80, 16, v81
  v_and_b32 v81, s12, v81
  v_lshlrev_b32 v82, 16, v83
  v_and_b32 v83, s12, v83
  v_mul_f32 v92, v87, v80
  v_fmac_f32 v92, v86, v81
  v_fmac_f32 v92, v85, v82
  v_fmac_f32 v92, v84, v83
  v_mul_f32 v93, v88, v80
  v_fmac_f32 v93, v87, v81
  v_fmac_f32 v93, v86, v82
  v_fmac_f32 v93, v85, v83
  v_mul_f32 v94, v89, v80
  v_fmac_f32 v94, v88, v81
  v_fmac_f32 v94, v87, v82
  v_fmac_f32 v94, v86, v83
  v_mul_f32 v95, v90, v80
  v_fmac_f32 v95, v89, v81
  v_fmac_f32 v95, v88, v82
  v_fmac_f32 v95, v87, v83
  v_lshlrev_b32 v84, 16, v47
  v_lshlrev_b32 v85, 16, v51
  v_lshlrev_b32 v86, 16, v55
  v_lshlrev_b32 v87, 16, v59
  v_mul_f32 v92, v92, v84
  v_mul_f32 v93, v93, v85
  v_mul_f32 v94, v94, v86
  v_mul_f32 v95, v95, v87
  v_cvt_pk_bf16_f32 v120, v95, v94
  v_cvt_pk_bf16_f32 v121, v93, v92
  ds_write_b64 v78, v[120:121] offset:768
  v_accvgpr_read_b32 v81, a62
  v_accvgpr_read_b32 v83, a63
  v_and_b32 v84, s12, v19
  v_and_b32 v85, s12, v23
  v_and_b32 v86, s12, v27
  v_and_b32 v87, s12, v31
  v_and_b32 v88, s12, v35
  v_and_b32 v89, s12, v39
  v_and_b32 v90, s12, v43
  v_lshlrev_b32 v80, 16, v81
  v_and_b32 v81, s12, v81
  v_lshlrev_b32 v82, 16, v83
  v_and_b32 v83, s12, v83
  v_mul_f32 v92, v87, v80
  v_fmac_f32 v92, v86, v81
  v_fmac_f32 v92, v85, v82
  v_fmac_f32 v92, v84, v83
  v_mul_f32 v93, v88, v80
  v_fmac_f32 v93, v87, v81
  v_fmac_f32 v93, v86, v82
  v_fmac_f32 v93, v85, v83
  v_mul_f32 v94, v89, v80
  v_fmac_f32 v94, v88, v81
  v_fmac_f32 v94, v87, v82
  v_fmac_f32 v94, v86, v83
  v_mul_f32 v95, v90, v80
  v_fmac_f32 v95, v89, v81
  v_fmac_f32 v95, v88, v82
  v_fmac_f32 v95, v87, v83
  v_and_b32 v84, s12, v47
  v_and_b32 v85, s12, v51
  v_and_b32 v86, s12, v55
  v_and_b32 v87, s12, v59
  v_mul_f32 v92, v92, v84
  v_mul_f32 v93, v93, v85
  v_mul_f32 v94, v94, v86
  v_mul_f32 v95, v95, v87
  v_cvt_pk_bf16_f32 v124, v95, v94
  v_cvt_pk_bf16_f32 v125, v93, v92
  ds_write_b64 v78, v[124:125] offset:896
  v_add_u32 v78, s15, v2
  ds_read_b128 v[16:19], v78 offset:0
  ds_read_b128 v[20:23], v78 offset:1024
  ds_read_b128 v[24:27], v78 offset:2048
  ds_read_b128 v[28:31], v78 offset:3072
  v_lshrrev_b32 v76, 3, v1
  v_lshlrev_b32 v76, 12, v76
  v_and_b32 v77, 7, v1
  v_lshl_add_u32 v76, v77, 4, v76
  s_mul_i32 s34, s96, 3641
  s_lshr_b32 s34, s34, 16
  s_mul_i32 s47, s34, 18
  s_sub_u32 s47, s96, s47
  s_lshl_b32 s47, s47, 17
  s_lshl_b32 s34, s34, 7
  s_add_u32 s13, s47, 104857600
  s_add_u32 s13, s13, s34
  s_add_u32 s12, s47, 100667264
  s_sub_u32 s12, s12, s34
  s_waitcnt lgkmcnt(3)
  buffer_store_dwordx4 v[16:19], v76, s[4:7], s12 offen sc1
  s_add_u32 s12, s12, 32768
  s_waitcnt lgkmcnt(2)
  buffer_store_dwordx4 v[20:23], v76, s[4:7], s12 offen sc1
  s_add_u32 s12, s12, 32768
  s_waitcnt lgkmcnt(1)
  buffer_store_dwordx4 v[24:27], v76, s[4:7], s12 offen sc1
  s_add_u32 s12, s12, 32768
  s_waitcnt lgkmcnt(0)
  buffer_store_dwordx4 v[28:31], v76, s[4:7], s12 offen sc1
  s_add_u32 s12, s12, 32768
  s_nop 1
F1_NOS1:
  v_mov_b32 v72, 0
  v_mov_b32 v73, 0
  v_mov_b32 v74, 0
  v_mov_b32 v75, 0
  v_mov_b32 v76, 0
  v_mov_b32 v77, 0
  v_mov_b32 v78, 0
  v_mov_b32 v79, 0
  v_mov_b32 v80, 0
  v_mov_b32 v81, 0
  v_mov_b32 v82, 0
  v_mov_b32 v83, 0
  v_mov_b32 v84, 0
  v_mov_b32 v85, 0
  v_mov_b32 v86, 0
  v_mov_b32 v87, 0
  v_mov_b32 v88, 0
  v_mov_b32 v89, 0
  v_mov_b32 v90, 0
  v_mov_b32 v91, 0
  v_mov_b32 v92, 0
  v_mov_b32 v93, 0
  v_mov_b32 v94, 0
  v_mov_b32 v95, 0
  v_mov_b32 v96, 0
  v_mov_b32 v97, 0
  v_mov_b32 v98, 0
  v_mov_b32 v99, 0
  v_mov_b32 v100, 0
  v_mov_b32 v101, 0
  v_mov_b32 v102, 0
  v_mov_b32 v103, 0
  v_mov_b32 v104, 0
  v_mov_b32 v105, 0
  v_mov_b32 v106, 0
  v_mov_b32 v107, 0
  v_mov_b32 v108, 0
  v_mov_b32 v109, 0
  v_mov_b32 v110, 0
  v_mov_b32 v111, 0
  v_mov_b32 v112, 0
  v_mov_b32 v113, 0
  v_mov_b32 v114, 0
  v_mov_b32 v115, 0
  v_mov_b32 v116, 0
  v_mov_b32 v117, 0
  v_mov_b32 v118, 0
  v_mov_b32 v119, 0
  v_mov_b32 v120, 0
  v_mov_b32 v121, 0
  v_mov_b32 v122, 0
  v_mov_b32 v123, 0
  v_mov_b32 v124, 0
  v_mov_b32 v125, 0
  v_mov_b32 v126, 0
  v_mov_b32 v127, 0
  v_mov_b32 v128, 0
  v_mov_b32 v129, 0
  v_mov_b32 v130, 0
  v_mov_b32 v131, 0
  v_mov_b32 v132, 0
  v_mov_b32 v133, 0
  v_mov_b32 v134, 0
  v_mov_b32 v135, 0
  v_mov_b32 v136, 0
  v_mov_b32 v137, 0
  v_mov_b32 v138, 0
  v_mov_b32 v139, 0
  v_mov_b32 v140, 0
  v_mov_b32 v141, 0
  v_mov_b32 v142, 0
  v_mov_b32 v143, 0
  v_mov_b32 v5, 0
  v_mov_b32 v6, 0
  v_mov_b32 v4, v2
  v_mov_b32 v3, v2
  s_mov_b32 s42, 1
  s_mov_b32 s31, 0
  s_mov_b32 s35, 0
  s_mov_b32 s43, 0x8000
  s_cmp_lg_u32 s28, 0
  s_cbranch_scc1 F1_OTHER
  v_mov_b32 v14, 0
  s_mov_b32 s63, 0x40000
F1_POLL:
  buffer_load_dwordx2 v[12:13], v14, s[4:7], s60 offen sc0 sc1
  s_waitcnt vmcnt(0)
  v_cmp_ne_u32 vcc, s98, v12
  v_cmp_ne_u32 s[100:101], s99, v13
  s_or_b64 vcc, vcc, s[100:101]
  s_cmp_eq_u64 vcc, 0
  s_cbranch_scc1 F1_GOT
  s_sleep 2
  s_sub_u32 s63, s63, 1
  s_cmp_lg_u32 s63, 0
  s_cbranch_scc1 F1_POLL
F1_GOT:
  s_branch F1_WAITED
F1_OTHER:
F1_WAITED:
  s_load_dwordx2 s[24:25], s[90:91], 0
  s_mov_b32 s26, 2359296
  s_cmp_ge_u32 s29, 4
  s_cselect_b32 s94, 3072, 0
  s_cselect_b32 s95, 1536, 0
  s_cselect_b32 s34, 5, 0
  s_cselect_b32 s47, 2, 0
  v_min_u32 v22, s34, v1
  v_lshlrev_b32 v22, 7, v22
  v_min_u32 v0, s47, v1
  v_lshlrev_b32 v0, 7, v0
  s_and_b32 s34, s29, 3
  s_lshr_b32 s47, s2, 6
  s_lshl_b32 s47, s47, 2
  s_add_u32 s34, s34, s47
  s_lshl_b32 s34, s34, 3
  s_and_b32 s47, s2, 7
  s_add_u32 s34, s34, s47
  s_mul_i32 s96, s34, 36864
  s_mul_i32 s97, s34, 18432
  s_and_b32 s47, s28, 3
  s_mul_i32 s34, s47, 768
  s_add_u32 s96, s96, s34
  s_mul_i32 s34, s47, 384
  s_add_u32 s97, s97, s34
  s_waitcnt lgkmcnt(0)
  s_barrier
F1_ATTN:
  s_mov_b32 m0, s58
  s_add_u32 s58, s58, 0x8000
  buffer_load_dwordx4 v2, s[4:7], s37 offen sc1 lds
  buffer_load_dwordx4 v2, s[4:7], s37 offen offset:1024 sc1 lds
  s_and_b32 s58, s58, 0x1ffff
  s_add_u32 s37, s37, 16384
  s_mov_b32 m0, s58
  s_add_u32 s58, s58, 0x8000
  buffer_load_dwordx4 v2, s[4:7], s37 offen sc1 lds
  buffer_load_dwordx4 v2, s[4:7], s37 offen offset:1024 sc1 lds
  s_and_b32 s58, s58, 0x1ffff
  s_add_u32 s37, s37, 16384
  s_mov_b32 m0, s59
  s_add_u32 s59, s59, 0x8000
  buffer_load_dwordx4 v2, s[4:7], s38 offen sc1 lds
  buffer_load_dwordx4 v2, s[4:7], s38 offen offset:1024 sc1 lds
  s_and_b32 s59, s59, 0x1ffff
  s_add_u32 s38, s38, 16384
  s_waitcnt vmcnt(4)
  s_barrier
  s_cmp_ge_u32 s28, 4
  s_cbranch_scc1 F1A_G1
  ds_read_b128 a[48:51], v4 offset:0
  ds_read_b128 a[52:55], v4 offset:1024
  ds_read_b128 a[56:59], v4 offset:2048
  ds_read_b128 a[60:63], v4 offset:3072
  ds_read_b128 a[64:67], v4 offset:4096
  ds_read_b128 a[68:71], v4 offset:5120
  ds_read_b128 a[72:75], v4 offset:6144
  ds_read_b128 a[76:79], v4 offset:7168
  s_waitcnt lgkmcnt(4)
  v_mfma_f32_16x16x32_bf16 v[24:27], a[48:51], a[0:3], v[72:75]
  v_mfma_f32_16x16x32_bf16 v[24:27], a[52:55], a[4:7], v[24:27]
  ds_read_b128 a[80:83], v4 offset:8192
  v_mfma_f32_16x16x32_bf16 v[24:27], a[56:59], a[8:11], v[24:27]
  v_mfma_f32_16x16x32_bf16 v[24:27], a[60:63], a[12:15], v[24:27]
  ds_read_b128 a[84:87], v4 offset:9216
  v_mfma_f32_16x16x32_bf16 v[40:43], a[48:51], a[16:19], v[76:79]
  v_mfma_f32_16x16x32_bf16 v[40:43], a[52:55], a[20:23], v[40:43]
  ds_read_b128 a[88:91], v4 offset:10240
  v_mfma_f32_16x16x32_bf16 v[40:43], a[56:59], a[24:27], v[40:43]
  v_mfma_f32_16x16x32_bf16 v[40:43], a[60:63], a[28:31], v[40:43]
  ds_read_b128 a[92:95], v4 offset:11264
  s_waitcnt lgkmcnt(4)
  v_mfma_f32_16x16x32_bf16 v[28:31], a[64:67], a[0:3], v[72:75]
  v_mfma_f32_16x16x32_bf16 v[28:31], a[68:71], a[4:7], v[28:31]
  ds_read_b128 a[96:99], v4 offset:12288
  v_mfma_f32_16x16x32_bf16 v[28:31], a[72:75], a[8:11], v[28:31]
  v_mfma_f32_16x16x32_bf16 v[28:31], a[76:79], a[12:15], v[28:31]
  ds_read_b128 a[100:103], v4 offset:13312
  v_mfma_f32_16x16x32_bf16 v[44:47], a[64:67], a[16:19], v[76:79]
  v_mfma_f32_16x16x32_bf16 v[44:47], a[68:71], a[20:23], v[44:47]
  ds_read_b128 a[104:107], v4 offset:14336
  v_mfma_f32_16x16x32_bf16 v[44:47], a[72:75], a[24:27], v[44:47]
  v_mfma_f32_16x16x32_bf16 v[44:47], a[76:79], a[28:31], v[44:47]
  ds_read_b128 a[108:111], v4 offset:15360
  s_waitcnt lgkmcnt(4)
  v_mfma_f32_16x16x32_bf16 v[32:35], a[80:83], a[0:3], v[72:75]
  v_mfma_f32_16x16x32_bf16 v[32:35], a[84:87], a[4:7], v[32:35]
  v_mfma_f32_16x16x32_bf16 v[32:35], a[88:91], a[8:11], v[32:35]
  v_mfma_f32_16x16x32_bf16 v[32:35], a[92:95], a[12:15], v[32:35]
  v_mfma_f32_16x16x32_bf16 v[48:51], a[80:83], a[16:19], v[76:79]
  v_mfma_f32_16x16x32_bf16 v[48:51], a[84:87], a[20:23], v[48:51]
  v_mfma_f32_16x16x32_bf16 v[48:51], a[88:91], a[24:27], v[48:51]
  v_mfma_f32_16x16x32_bf16 v[48:51], a[92:95], a[28:31], v[48:51]
  s_waitcnt vmcnt(0) lgkmcnt(0)
  s_barrier
  s_cmp_lg_u32 s28, 0
  s_cbranch_scc1 F1_NP0
  s_lshl_b32 s34, s2, 7
  s_add_u32 s34, s34, 131072000
  v_mov_b32 v22, s98
  v_mov_b32 v23, s99
  v_mov_b32 v21, 0
  s_mov_b64 exec, 1
  buffer_store_dwordx2 v[22:23], v21, s[4:7], s34 offen sc0 sc1
  s_mov_b64 exec, -1
  v_and_b32 v0, 7, v1
  v_lshlrev_b32 v0, 7, v0
  s_lshl_b32 s34, s30, 10
  s_add_u32 s34, s34, 125829120
  buffer_load_dwordx2 v[22:23], v0, s[4:7], s34 offen sc0 sc1
F1_NP0:
  s_branch F1A_G0_S
F1A_G0_F:
  v_mfma_f32_16x16x32_bf16 v[36:39], a[96:99], a[0:3], v[72:75]
  v_mfma_f32_16x16x32_bf16 v[36:39], a[100:103], a[4:7], v[36:39]
  v_mfma_f32_16x16x32_bf16 v[36:39], a[104:107], a[8:11], v[36:39]
  v_mfma_f32_16x16x32_bf16 v[36:39], a[108:111], a[12:15], v[36:39]
  v_mfma_f32_16x16x32_bf16 v[52:55], a[96:99], a[16:19], v[76:79]
  v_mfma_f32_16x16x32_bf16 v[52:55], a[100:103], a[20:23], v[52:55]
  v_mfma_f32_16x16x32_bf16 v[52:55], a[104:107], a[24:27], v[52:55]
  v_mfma_f32_16x16x32_bf16 v[52:55], a[108:111], a[28:31], v[52:55]
  s_setprio 0
  v_mov_b32 v3, v4
  v_add_u32 v4, s43, v4
  v_and_b32 v4, 0x1ffff, v4
  v_exp_f32 v12, v24
  v_exp_f32 v13, v25
  s_mov_b32 m0, s58
  s_add_u32 s58, s58, 0x8000
  buffer_load_dwordx4 v2, s[4:7], s37 offen sc1 lds
  buffer_load_dwordx4 v2, s[4:7], s37 offen offset:1024 sc1 lds
  s_and_b32 s58, s58, 0x1ffff
  s_add_u32 s37, s37, 16384
  v_exp_f32 v14, v26
  v_exp_f32 v15, v27
  v_exp_f32 v16, v40
  v_exp_f32 v17, v41
  v_add_f32 v8, v12, v13
  s_mov_b32 m0, s59
  s_add_u32 s59, s59, 0x8000
  buffer_load_dwordx4 v2, s[4:7], s38 offen sc1 lds
  buffer_load_dwordx4 v2, s[4:7], s38 offen offset:1024 sc1 lds
  s_and_b32 s59, s59, 0x1ffff
  s_add_u32 s38, s38, 16384
  v_exp_f32 v18, v42
  v_exp_f32 v19, v43
  v_add_f32 v8, v8, v14
  v_add_f32 v8, v8, v15
  v_cvt_pk_bf16_f32 v56, v12, v13
  v_cvt_pk_bf16_f32 v57, v14, v15
  v_exp_f32 v12, v28
  v_exp_f32 v13, v29
  v_add_f32 v10, v16, v17
  s_cmp_eq_u32 s43, 0x8000
  s_cbranch_scc1 F1A_D1
  s_mov_b32 m0, s58
  s_add_u32 s58, s58, 0x8000
  buffer_load_dwordx4 v2, s[4:7], s37 offen sc1 lds
  buffer_load_dwordx4 v2, s[4:7], s37 offen offset:1024 sc1 lds
  s_and_b32 s58, s58, 0x1ffff
  s_add_u32 s37, s37, 16384
F1A_D1:
  v_exp_f32 v14, v30
  v_exp_f32 v15, v31
  v_add_f32 v10, v10, v18
  v_add_f32 v10, v10, v19
  v_cvt_pk_bf16_f32 v64, v16, v17
  v_cvt_pk_bf16_f32 v65, v18, v19
  v_exp_f32 v16, v44
  v_exp_f32 v17, v45
  v_add_f32 v8, v8, v12
  v_add_f32 v8, v8, v13
  s_cmp_eq_u32 s43, 0x8000
  s_cbranch_scc1 F1A_D2
  s_mov_b32 m0, s59
  s_add_u32 s59, s59, 0x8000
  buffer_load_dwordx4 v2, s[4:7], s38 offen sc1 lds
  buffer_load_dwordx4 v2, s[4:7], s38 offen offset:1024 sc1 lds
  s_and_b32 s59, s59, 0x1ffff
  s_add_u32 s38, s38, 16384
F1A_D2:
  v_exp_f32 v18, v46
  v_exp_f32 v19, v47
  v_add_f32 v8, v8, v14
  v_add_f32 v8, v8, v15
  v_cvt_pk_bf16_f32 v58, v12, v13
  v_cvt_pk_bf16_f32 v59, v14, v15
  v_exp_f32 v12, v32
  v_exp_f32 v13, v33
  v_add_f32 v10, v10, v16
  v_add_f32 v10, v10, v17
  ds_read_b128 a[48:51], v3 offset:16384
  v_exp_f32 v14, v34
  v_exp_f32 v15, v35
  v_add_f32 v10, v10, v18
  v_add_f32 v10, v10, v19
  v_cvt_pk_bf16_f32 v66, v16, v17
  v_cvt_pk_bf16_f32 v67, v18, v19
  ds_read_b128 a[52:55], v3 offset:24576
  v_exp_f32 v16, v48
  v_exp_f32 v17, v49
  v_add_f32 v8, v8, v12
  v_add_f32 v8, v8, v13
  ds_read_b128 a[56:59], v3 offset:17408
  v_exp_f32 v18, v50
  v_exp_f32 v19, v51
  v_add_f32 v8, v8, v14
  v_add_f32 v8, v8, v15
  v_cvt_pk_bf16_f32 v60, v12, v13
  v_cvt_pk_bf16_f32 v61, v14, v15
  ds_read_b128 a[60:63], v3 offset:25600
  v_exp_f32 v12, v36
  v_exp_f32 v13, v37
  v_add_f32 v10, v10, v16
  v_add_f32 v10, v10, v17
  ds_read_b128 a[64:67], v3 offset:18432
  v_exp_f32 v14, v38
  v_exp_f32 v15, v39
  v_add_f32 v10, v10, v18
  v_add_f32 v10, v10, v19
  v_cvt_pk_bf16_f32 v68, v16, v17
  v_cvt_pk_bf16_f32 v69, v18, v19
  ds_read_b128 a[68:71], v3 offset:26624
  v_exp_f32 v16, v52
  v_exp_f32 v17, v53
  v_add_f32 v8, v8, v12
  v_add_f32 v8, v8, v13
  ds_read_b128 a[72:75], v3 offset:19456
  v_exp_f32 v18, v54
  v_exp_f32 v19, v55
  v_add_f32 v8, v8, v14
  v_add_f32 v8, v8, v15
  v_cvt_pk_bf16_f32 v62, v12, v13
  v_cvt_pk_bf16_f32 v63, v14, v15
  ds_read_b128 a[76:79], v3 offset:27648
  v_add_f32 v10, v10, v16
  v_add_f32 v10, v10, v17
  v_cvt_pk_bf16_f32 v70, v16, v17
  v_add_f32 v10, v10, v18
  v_add_f32 v10, v10, v19
  v_cvt_pk_bf16_f32 v71, v18, v19
  v_add_f32 v20, v8, v10
  v_cmp_nge_f32 vcc, s44, v20
  s_cbranch_vccnz F1A_FIX_g0f
F1A_FIXRET_g0f:
  v_add_f32 v5, v5, v8
  v_add_f32 v6, v6, v10
  s_setprio 1
  s_lshr_b32 s34, s43, 15
  s_add_u32 s35, s35, s34
  s_add_u32 s31, s31, 1
  s_waitcnt lgkmcnt(6)
  v_mfma_f32_16x16x32_bf16 v[80:83], a[48:51], v[56:59], v[80:83]
  v_mfma_f32_16x16x32_bf16 v[80:83], a[52:55], v[60:63], v[80:83]
  ds_read_b128 a[80:83], v3 offset:20480
  v_mfma_f32_16x16x32_bf16 v[96:99], a[48:51], v[64:67], v[96:99]
  v_mfma_f32_16x16x32_bf16 v[96:99], a[52:55], v[68:71], v[96:99]
  ds_read_b128 a[84:87], v3 offset:28672
  s_waitcnt lgkmcnt(6)
  v_mfma_f32_16x16x32_bf16 v[84:87], a[56:59], v[56:59], v[84:87]
  v_mfma_f32_16x16x32_bf16 v[84:87], a[60:63], v[60:63], v[84:87]
  ds_read_b128 a[88:91], v3 offset:21504
  v_mfma_f32_16x16x32_bf16 v[100:103], a[56:59], v[64:67], v[100:103]
  v_mfma_f32_16x16x32_bf16 v[100:103], a[60:63], v[68:71], v[100:103]
  ds_read_b128 a[92:95], v3 offset:29696
  s_waitcnt lgkmcnt(6)
  v_mfma_f32_16x16x32_bf16 v[88:91], a[64:67], v[56:59], v[88:91]
  v_mfma_f32_16x16x32_bf16 v[88:91], a[68:71], v[60:63], v[88:91]
  ds_read_b128 a[96:99], v3 offset:22528
  v_mfma_f32_16x16x32_bf16 v[104:107], a[64:67], v[64:67], v[104:107]
  v_mfma_f32_16x16x32_bf16 v[104:107], a[68:71], v[68:71], v[104:107]
  ds_read_b128 a[100:103], v3 offset:30720
  s_waitcnt lgkmcnt(6)
  v_mfma_f32_16x16x32_bf16 v[92:95], a[72:75], v[56:59], v[92:95]
  v_mfma_f32_16x16x32_bf16 v[92:95], a[76:79], v[60:63], v[92:95]
  ds_read_b128 a[104:107], v3 offset:23552
  v_mfma_f32_16x16x32_bf16 v[108:111], a[72:75], v[64:67], v[108:111]
  v_mfma_f32_16x16x32_bf16 v[108:111], a[76:79], v[68:71], v[108:111]
  ds_read_b128 a[108:111], v3 offset:31744
  s_waitcnt lgkmcnt(6)
  v_mfma_f32_16x16x32_bf16 v[112:115], a[80:83], v[56:59], v[112:115]
  v_mfma_f32_16x16x32_bf16 v[112:115], a[84:87], v[60:63], v[112:115]
  ds_read_b128 a[48:51], v4 offset:0
  v_mfma_f32_16x16x32_bf16 v[128:131], a[80:83], v[64:67], v[128:131]
  v_mfma_f32_16x16x32_bf16 v[128:131], a[84:87], v[68:71], v[128:131]
  ds_read_b128 a[52:55], v4 offset:1024
  s_waitcnt lgkmcnt(6)
  v_mfma_f32_16x16x32_bf16 v[116:119], a[88:91], v[56:59], v[116:119]
  v_mfma_f32_16x16x32_bf16 v[116:119], a[92:95], v[60:63], v[116:119]
  ds_read_b128 a[56:59], v4 offset:2048
  v_mfma_f32_16x16x32_bf16 v[132:135], a[88:91], v[64:67], v[132:135]
  v_mfma_f32_16x16x32_bf16 v[132:135], a[92:95], v[68:71], v[132:135]
  ds_read_b128 a[60:63], v4 offset:3072
  s_waitcnt lgkmcnt(6)
  v_mfma_f32_16x16x32_bf16 v[120:123], a[96:99], v[56:59], v[120:123]
  v_mfma_f32_16x16x32_bf16 v[120:123], a[100:103], v[60:63], v[120:123]
  ds_read_b128 a[64:67], v4 offset:4096
  v_mfma_f32_16x16x32_bf16 v[136:139], a[96:99], v[64:67], v[136:139]
  v_mfma_f32_16x16x32_bf16 v[136:139], a[100:103], v[68:71], v[136:139]
  ds_read_b128 a[68:71], v4 offset:5120
  s_waitcnt lgkmcnt(6)
  v_mfma_f32_16x16x32_bf16 v[124:127], a[104:107], v[56:59], v[124:127]
  v_mfma_f32_16x16x32_bf16 v[124:127], a[108:111], v[60:63], v[124:127]
  ds_read_b128 a[72:75], v4 offset:6144
  v_mfma_f32_16x16x32_bf16 v[140:143], a[104:107], v[64:67], v[140:143]
  v_mfma_f32_16x16x32_bf16 v[140:143], a[108:111], v[68:71], v[140:143]
  ds_read_b128 a[76:79], v4 offset:7168
  s_waitcnt lgkmcnt(4)
  v_mfma_f32_16x16x32_bf16 v[24:27], a[48:51], a[0:3], v[72:75]
  v_mfma_f32_16x16x32_bf16 v[24:27], a[52:55], a[4:7], v[24:27]
  ds_read_b128 a[80:83], v4 offset:8192
  v_mfma_f32_16x16x32_bf16 v[24:27], a[56:59], a[8:11], v[24:27]
  v_mfma_f32_16x16x32_bf16 v[24:27], a[60:63], a[12:15], v[24:27]
  ds_read_b128 a[84:87], v4 offset:9216
  v_mfma_f32_16x16x32_bf16 v[40:43], a[48:51], a[16:19], v[76:79]
  v_mfma_f32_16x16x32_bf16 v[40:43], a[52:55], a[20:23], v[40:43]
  ds_read_b128 a[88:91], v4 offset:10240
  v_mfma_f32_16x16x32_bf16 v[40:43], a[56:59], a[24:27], v[40:43]
  v_mfma_f32_16x16x32_bf16 v[40:43], a[60:63], a[28:31], v[40:43]
  ds_read_b128 a[92:95], v4 offset:11264
  s_waitcnt lgkmcnt(4)
  v_mfma_f32_16x16x32_bf16 v[28:31], a[64:67], a[0:3], v[72:75]
  v_mfma_f32_16x16x32_bf16 v[28:31], a[68:71], a[4:7], v[28:31]
  ds_read_b128 a[96:99], v4 offset:12288
  v_mfma_f32_16x16x32_bf16 v[28:31], a[72:75], a[8:11], v[28:31]
  v_mfma_f32_16x16x32_bf16 v[28:31], a[76:79], a[12:15], v[28:31]
  ds_read_b128 a[100:103], v4 offset:13312
  v_mfma_f32_16x16x32_bf16 v[44:47], a[64:67], a[16:19], v[76:79]
  v_mfma_f32_16x16x32_bf16 v[44:47], a[68:71], a[20:23], v[44:47]
  ds_read_b128 a[104:107], v4 offset:14336
  v_mfma_f32_16x16x32_bf16 v[44:47], a[72:75], a[24:27], v[44:47]
  v_mfma_f32_16x16x32_bf16 v[44:47], a[76:79], a[28:31], v[44:47]
  ds_read_b128 a[108:111], v4 offset:15360
  s_waitcnt lgkmcnt(4)
  v_mfma_f32_16x16x32_bf16 v[32:35], a[80:83], a[0:3], v[72:75]
  v_mfma_f32_16x16x32_bf16 v[32:35], a[84:87], a[4:7], v[32:35]
  v_mfma_f32_16x16x32_bf16 v[32:35], a[88:91], a[8:11], v[32:35]
  v_mfma_f32_16x16x32_bf16 v[32:35], a[92:95], a[12:15], v[32:35]
  v_mfma_f32_16x16x32_bf16 v[48:51], a[80:83], a[16:19], v[76:79]
  v_mfma_f32_16x16x32_bf16 v[48:51], a[84:87], a[20:23], v[48:51]
  v_mfma_f32_16x16x32_bf16 v[48:51], a[88:91], a[24:27], v[48:51]
  v_mfma_f32_16x16x32_bf16 v[48:51], a[92:95], a[28:31], v[48:51]
  s_setprio 3
  s_bitcmp1_b32 s36, s31
  s_waitcnt vmcnt(0) lgkmcnt(0)
  s_barrier
  s_cbranch_scc0 F1A_G0_F
F1A_G0_S:
  s_lshl_b32 s34, s35, 6
  s_cmp_gt_u32 s34, s33
  s_cbranch_scc1 F1A_G0_SKIP
  v_mfma_f32_16x16x32_bf16 v[36:39], a[96:99], a[0:3], v[72:75]
  v_mfma_f32_16x16x32_bf16 v[36:39], a[100:103], a[4:7], v[36:39]
  v_mfma_f32_16x16x32_bf16 v[36:39], a[104:107], a[8:11], v[36:39]
  v_mfma_f32_16x16x32_bf16 v[36:39], a[108:111], a[12:15], v[36:39]
  v_mfma_f32_16x16x32_bf16 v[52:55], a[96:99], a[16:19], v[76:79]
  v_mfma_f32_16x16x32_bf16 v[52:55], a[100:103], a[20:23], v[52:55]
  v_mfma_f32_16x16x32_bf16 v[52:55], a[104:107], a[24:27], v[52:55]
  v_mfma_f32_16x16x32_bf16 v[52:55], a[108:111], a[28:31], v[52:55]
  s_setprio 0
  s_add_u32 s47, s31, 1
  s_cmp_gt_u32 s47, s32
  s_cselect_b32 s43, 2, 1
  s_lshl_b32 s43, s43, 15
  s_cmp_eq_u32 s47, s32
  s_cbranch_scc1 F1A_QB
F1A_QB_RET:
  v_mov_b32 v3, v4
  v_add_u32 v4, s43, v4
  v_and_b32 v4, 0x1ffff, v4
  s_lshl_b32 s34, s35, 6
  s_add_u32 s34, s34, 63
  s_cmp_gt_u32 s34, s33
  s_cbranch_scc1 F1A_MASK_g0s
F1A_MASKRET_g0s:
  v_exp_f32 v12, v24
  v_exp_f32 v13, v25
  s_cmp_gt_u32 s37, s56
  s_cbranch_scc1 F1A_D3
  s_mov_b32 m0, s58
  s_add_u32 s58, s58, 0x8000
  buffer_load_dwordx4 v2, s[4:7], s37 offen sc1 lds
  buffer_load_dwordx4 v2, s[4:7], s37 offen offset:1024 sc1 lds
  s_and_b32 s58, s58, 0x1ffff
  s_add_u32 s37, s37, 16384
F1A_D3:
  v_exp_f32 v14, v26
  v_exp_f32 v15, v27
  v_exp_f32 v16, v40
  v_exp_f32 v17, v41
  v_add_f32 v8, v12, v13
  s_cmp_gt_u32 s38, s57
  s_cbranch_scc1 F1A_D4
  s_mov_b32 m0, s59
  s_add_u32 s59, s59, 0x8000
  buffer_load_dwordx4 v2, s[4:7], s38 offen sc1 lds
  buffer_load_dwordx4 v2, s[4:7], s38 offen offset:1024 sc1 lds
  s_and_b32 s59, s59, 0x1ffff
  s_add_u32 s38, s38, 16384
F1A_D4:
  v_exp_f32 v18, v42
  v_exp_f32 v19, v43
  v_add_f32 v8, v8, v14
  v_add_f32 v8, v8, v15
  v_cvt_pk_bf16_f32 v56, v12, v13
  v_cvt_pk_bf16_f32 v57, v14, v15
  v_exp_f32 v12, v28
  v_exp_f32 v13, v29
  v_add_f32 v10, v16, v17
  s_cmp_gt_u32 s37, s56
  s_cbranch_scc1 F1A_D5
  s_add_u32 s47, s31, 1
  s_cmp_lt_u32 s47, s32
  s_cbranch_scc1 F1A_D5
  s_mov_b32 m0, s58
  s_add_u32 s58, s58, 0x8000
  buffer_load_dwordx4 v2, s[4:7], s37 offen sc1 lds
  buffer_load_dwordx4 v2, s[4:7], s37 offen offset:1024 sc1 lds
  s_and_b32 s58, s58, 0x1ffff
  s_add_u32 s37, s37, 16384
F1A_D5:
  v_exp_f32 v14, v30
  v_exp_f32 v15, v31
  v_add_f32 v10, v10, v18
  v_add_f32 v10, v10, v19
  v_cvt_pk_bf16_f32 v64, v16, v17
  v_cvt_pk_bf16_f32 v65, v18, v19
  v_exp_f32 v16, v44
  v_exp_f32 v17, v45
  v_add_f32 v8, v8, v12
  v_add_f32 v8, v8, v13
  s_cmp_gt_u32 s38, s57
  s_cbranch_scc1 F1A_D6
  s_cmp_lt_u32 s31, s32
  s_cbranch_scc1 F1A_D6
  s_mov_b32 m0, s59
  s_add_u32 s59, s59, 0x8000
  buffer_load_dwordx4 v2, s[4:7], s38 offen sc1 lds
  buffer_load_dwordx4 v2, s[4:7], s38 offen offset:1024 sc1 lds
  s_and_b32 s59, s59, 0x1ffff
  s_add_u32 s38, s38, 16384
F1A_D6:
  v_exp_f32 v18, v46
  v_exp_f32 v19, v47
  v_add_f32 v8, v8, v14
  v_add_f32 v8, v8, v15
  v_cvt_pk_bf16_f32 v58, v12, v13
  v_cvt_pk_bf16_f32 v59, v14, v15
  v_exp_f32 v12, v32
  v_exp_f32 v13, v33
  v_add_f32 v10, v10, v16
  v_add_f32 v10, v10, v17
  ds_read_b128 a[48:51], v3 offset:16384
  v_exp_f32 v14, v34
  v_exp_f32 v15, v35
  v_add_f32 v10, v10, v18
  v_add_f32 v10, v10, v19
  v_cvt_pk_bf16_f32 v66, v16, v17
  v_cvt_pk_bf16_f32 v67, v18, v19
  ds_read_b128 a[52:55], v3 offset:24576
  v_exp_f32 v16, v48
  v_exp_f32 v17, v49
  v_add_f32 v8, v8, v12
  v_add_f32 v8, v8, v13
  ds_read_b128 a[56:59], v3 offset:17408
  v_exp_f32 v18, v50
  v_exp_f32 v19, v51
  v_add_f32 v8, v8, v14
  v_add_f32 v8, v8, v15
  v_cvt_pk_bf16_f32 v60, v12, v13
  v_cvt_pk_bf16_f32 v61, v14, v15
  ds_read_b128 a[60:63], v3 offset:25600
  v_exp_f32 v12, v36
  v_exp_f32 v13, v37
  v_add_f32 v10, v10, v16
  v_add_f32 v10, v10, v17
  ds_read_b128 a[64:67], v3 offset:18432
  v_exp_f32 v14, v38
  v_exp_f32 v15, v39
  v_add_f32 v10, v10, v18
  v_add_f32 v10, v10, v19
  v_cvt_pk_bf16_f32 v68, v16, v17
  v_cvt_pk_bf16_f32 v69, v18, v19
  ds_read_b128 a[68:71], v3 offset:26624
  v_exp_f32 v16, v52
  v_exp_f32 v17, v53
  v_add_f32 v8, v8, v12
  v_add_f32 v8, v8, v13
  ds_read_b128 a[72:75], v3 offset:19456
  v_exp_f32 v18, v54
  v_exp_f32 v19, v55
  v_add_f32 v8, v8, v14
  v_add_f32 v8, v8, v15
  v_cvt_pk_bf16_f32 v62, v12, v13
  v_cvt_pk_bf16_f32 v63, v14, v15
  ds_read_b128 a[76:79], v3 offset:27648
  v_add_f32 v10, v10, v16
  v_add_f32 v10, v10, v17
  v_cvt_pk_bf16_f32 v70, v16, v17
  v_add_f32 v10, v10, v18
  v_add_f32 v10, v10, v19
  v_cvt_pk_bf16_f32 v71, v18, v19
  v_add_f32 v20, v8, v10
  v_cmp_nge_f32 vcc, s44, v20
  s_cbranch_vccnz F1A_FIX_g0s
  s_cmp_lg_u32 s42, 0
  s_cbranch_scc1 F1A_INIT_g0s
F1A_FIXRET_g0s:
  v_add_f32 v5, v5, v8
  v_add_f32 v6, v6, v10
  s_setprio 1
  s_cmp_eq_u32 s31, 16
  s_cbranch_scc1 F1A_G0_LAST
  s_add_u32 s47, s31, 1
  s_cmp_eq_u32 s47, s32
  s_cbranch_scc1 F1A_SWITCH
F1A_SWITCH_RET:
  s_lshr_b32 s34, s43, 15
  s_add_u32 s35, s35, s34
  s_add_u32 s31, s31, 1
  s_lshl_b32 s34, s35, 6
  s_cmp_gt_u32 s34, s33
  s_cselect_b32 s47, s31, 99
  s_cmp_lt_u32 s47, s32
  s_cbranch_scc1 F1A_PVONLY
  s_sub_u32 s47, s31, 1
  s_cmp_eq_u32 s47, s32
  s_cbranch_scc1 F1A_FRESH
  s_waitcnt lgkmcnt(6)
  v_mfma_f32_16x16x32_bf16 v[80:83], a[48:51], v[56:59], v[80:83]
  v_mfma_f32_16x16x32_bf16 v[80:83], a[52:55], v[60:63], v[80:83]
  ds_read_b128 a[80:83], v3 offset:20480
  v_mfma_f32_16x16x32_bf16 v[96:99], a[48:51], v[64:67], v[96:99]
  v_mfma_f32_16x16x32_bf16 v[96:99], a[52:55], v[68:71], v[96:99]
  ds_read_b128 a[84:87], v3 offset:28672
  s_waitcnt lgkmcnt(6)
  v_mfma_f32_16x16x32_bf16 v[84:87], a[56:59], v[56:59], v[84:87]
  v_mfma_f32_16x16x32_bf16 v[84:87], a[60:63], v[60:63], v[84:87]
  ds_read_b128 a[88:91], v3 offset:21504
  v_mfma_f32_16x16x32_bf16 v[100:103], a[56:59], v[64:67], v[100:103]
  v_mfma_f32_16x16x32_bf16 v[100:103], a[60:63], v[68:71], v[100:103]
  ds_read_b128 a[92:95], v3 offset:29696
  s_waitcnt lgkmcnt(6)
  v_mfma_f32_16x16x32_bf16 v[88:91], a[64:67], v[56:59], v[88:91]
  v_mfma_f32_16x16x32_bf16 v[88:91], a[68:71], v[60:63], v[88:91]
  ds_read_b128 a[96:99], v3 offset:22528
  v_mfma_f32_16x16x32_bf16 v[104:107], a[64:67], v[64:67], v[104:107]
  v_mfma_f32_16x16x32_bf16 v[104:107], a[68:71], v[68:71], v[104:107]
  ds_read_b128 a[100:103], v3 offset:30720
  s_waitcnt lgkmcnt(6)
  v_mfma_f32_16x16x32_bf16 v[92:95], a[72:75], v[56:59], v[92:95]
  v_mfma_f32_16x16x32_bf16 v[92:95], a[76:79], v[60:63], v[92:95]
  ds_read_b128 a[104:107], v3 offset:23552
  v_mfma_f32_16x16x32_bf16 v[108:111], a[72:75], v[64:67], v[108:111]
  v_mfma_f32_16x16x32_bf16 v[108:111], a[76:79], v[68:71], v[108:111]
  ds_read_b128 a[108:111], v3 offset:31744
  s_waitcnt lgkmcnt(6)
  v_mfma_f32_16x16x32_bf16 v[112:115], a[80:83], v[56:59], v[112:115]
  v_mfma_f32_16x16x32_bf16 v[112:115], a[84:87], v[60:63], v[112:115]
  ds_read_b128 a[48:51], v4 offset:0
  v_mfma_f32_16x16x32_bf16 v[128:131], a[80:83], v[64:67], v[128:131]
  v_mfma_f32_16x16x32_bf16 v[128:131], a[84:87], v[68:71], v[128:131]
  ds_read_b128 a[52:55], v4 offset:1024
  s_waitcnt lgkmcnt(6)
  v_mfma_f32_16x16x32_bf16 v[116:119], a[88:91], v[56:59], v[116:119]
  v_mfma_f32_16x16x32_bf16 v[116:119], a[92:95], v[60:63], v[116:119]
  ds_read_b128 a[56:59], v4 offset:2048
  v_mfma_f32_16x16x32_bf16 v[132:135], a[88:91], v[64:67], v[132:135]
  v_mfma_f32_16x16x32_bf16 v[132:135], a[92:95], v[68:71], v[132:135]
  ds_read_b128 a[60:63], v4 offset:3072
  s_waitcnt lgkmcnt(6)
  v_mfma_f32_16x16x32_bf16 v[120:123], a[96:99], v[56:59], v[120:123]
  v_mfma_f32_16x16x32_bf16 v[120:123], a[100:103], v[60:63], v[120:123]
  ds_read_b128 a[64:67], v4 offset:4096
  v_mfma_f32_16x16x32_bf16 v[136:139], a[96:99], v[64:67], v[136:139]
  v_mfma_f32_16x16x32_bf16 v[136:139], a[100:103], v[68:71], v[136:139]
  ds_read_b128 a[68:71], v4 offset:5120
  s_waitcnt lgkmcnt(6)
  v_mfma_f32_16x16x32_bf16 v[124:127], a[104:107], v[56:59], v[124:127]
  v_mfma_f32_16x16x32_bf16 v[124:127], a[108:111], v[60:63], v[124:127]
  ds_read_b128 a[72:75], v4 offset:6144
  v_mfma_f32_16x16x32_bf16 v[140:143], a[104:107], v[64:67], v[140:143]
  v_mfma_f32_16x16x32_bf16 v[140:143], a[108:111], v[68:71], v[140:143]
  ds_read_b128 a[76:79], v4 offset:7168
F1A_FRESH_RET:
  s_waitcnt lgkmcnt(4)
  v_mfma_f32_16x16x32_bf16 v[24:27], a[48:51], a[0:3], v[72:75]
  v_mfma_f32_16x16x32_bf16 v[24:27], a[52:55], a[4:7], v[24:27]
  ds_read_b128 a[80:83], v4 offset:8192
  v_mfma_f32_16x16x32_bf16 v[24:27], a[56:59], a[8:11], v[24:27]
  v_mfma_f32_16x16x32_bf16 v[24:27], a[60:63], a[12:15], v[24:27]
  ds_read_b128 a[84:87], v4 offset:9216
  v_mfma_f32_16x16x32_bf16 v[40:43], a[48:51], a[16:19], v[76:79]
  v_mfma_f32_16x16x32_bf16 v[40:43], a[52:55], a[20:23], v[40:43]
  ds_read_b128 a[88:91], v4 offset:10240
  v_mfma_f32_16x16x32_bf16 v[40:43], a[56:59], a[24:27], v[40:43]
  v_mfma_f32_16x16x32_bf16 v[40:43], a[60:63], a[28:31], v[40:43]
  ds_read_b128 a[92:95], v4 offset:11264
  s_waitcnt lgkmcnt(4)
  v_mfma_f32_16x16x32_bf16 v[28:31], a[64:67], a[0:3], v[72:75]
  v_mfma_f32_16x16x32_bf16 v[28:31], a[68:71], a[4:7], v[28:31]
  ds_read_b128 a[96:99], v4 offset:12288
  v_mfma_f32_16x16x32_bf16 v[28:31], a[72:75], a[8:11], v[28:31]
  v_mfma_f32_16x16x32_bf16 v[28:31], a[76:79], a[12:15], v[28:31]
  ds_read_b128 a[100:103], v4 offset:13312
  v_mfma_f32_16x16x32_bf16 v[44:47], a[64:67], a[16:19], v[76:79]
  v_mfma_f32_16x16x32_bf16 v[44:47], a[68:71], a[20:23], v[44:47]
  ds_read_b128 a[104:107], v4 offset:14336
  v_mfma_f32_16x16x32_bf16 v[44:47], a[72:75], a[24:27], v[44:47]
  v_mfma_f32_16x16x32_bf16 v[44:47], a[76:79], a[28:31], v[44:47]
  ds_read_b128 a[108:111], v4 offset:15360
  s_waitcnt lgkmcnt(4)
  v_mfma_f32_16x16x32_bf16 v[32:35], a[80:83], a[0:3], v[72:75]
  v_mfma_f32_16x16x32_bf16 v[32:35], a[84:87], a[4:7], v[32:35]
  v_mfma_f32_16x16x32_bf16 v[32:35], a[88:91], a[8:11], v[32:35]
  v_mfma_f32_16x16x32_bf16 v[32:35], a[92:95], a[12:15], v[32:35]
  v_mfma_f32_16x16x32_bf16 v[48:51], a[80:83], a[16:19], v[76:79]
  v_mfma_f32_16x16x32_bf16 v[48:51], a[84:87], a[20:23], v[48:51]
  v_mfma_f32_16x16x32_bf16 v[48:51], a[88:91], a[24:27], v[48:51]
  v_mfma_f32_16x16x32_bf16 v[48:51], a[92:95], a[28:31], v[48:51]
F1A_MDONE:
  s_setprio 3
  s_cmp_ge_u32 s31, s32
  s_cselect_b32 s43, 2, 1
  s_lshl_b32 s43, s43, 15
  s_cmp_eq_u32 s31, s32
  s_cbranch_scc1 F1A_EPI_A
  s_waitcnt vmcnt(0)
  s_or_b32 s34, s28, s31
  s_cmp_lg_u32 s34, 1
  s_cbranch_scc1 F1_E0
  s_cmp_lg_u32 s28, 0
  s_cbranch_scc1 F1_E0
  s_mov_b32 s47, 0x40000
F1_E0L:
  v_cmp_ne_u32 vcc, s98, v22
  v_cmp_ne_u32 s[100:101], s99, v23
  s_or_b64 vcc, vcc, s[100:101]
  s_cmp_eq_u64 vcc, 0
  s_cbranch_scc1 F1_E0
  s_lshl_b32 s34, s30, 10
  s_add_u32 s34, s34, 125829120
  buffer_load_dwordx2 v[22:23], v0, s[4:7], s34 offen sc0 sc1
  s_waitcnt vmcnt(0)
  s_sub_u32 s47, s47, 1
  s_cmp_lg_u32 s47, 0
  s_cbranch_scc1 F1_E0L
F1_E0:
  s_bitcmp1_b32 s36, s31
  s_waitcnt vmcnt(0) lgkmcnt(0)
  s_barrier
  s_cbranch_scc0 F1A_G0_F
  s_branch F1A_G0_S
F1A_PVONLY:
  s_waitcnt lgkmcnt(6)
  v_mfma_f32_16x16x32_bf16 v[80:83], a[48:51], v[56:59], v[80:83]
  v_mfma_f32_16x16x32_bf16 v[80:83], a[52:55], v[60:63], v[80:83]
  ds_read_b128 a[80:83], v3 offset:20480
  v_mfma_f32_16x16x32_bf16 v[96:99], a[48:51], v[64:67], v[96:99]
  v_mfma_f32_16x16x32_bf16 v[96:99], a[52:55], v[68:71], v[96:99]
  ds_read_b128 a[84:87], v3 offset:28672
  s_waitcnt lgkmcnt(6)
  v_mfma_f32_16x16x32_bf16 v[84:87], a[56:59], v[56:59], v[84:87]
  v_mfma_f32_16x16x32_bf16 v[84:87], a[60:63], v[60:63], v[84:87]
  ds_read_b128 a[88:91], v3 offset:21504
  v_mfma_f32_16x16x32_bf16 v[100:103], a[56:59], v[64:67], v[100:103]
  v_mfma_f32_16x16x32_bf16 v[100:103], a[60:63], v[68:71], v[100:103]
  ds_read_b128 a[92:95], v3 offset:29696
  s_waitcnt lgkmcnt(6)
  v_mfma_f32_16x16x32_bf16 v[88:91], a[64:67], v[56:59], v[88:91]
  v_mfma_f32_16x16x32_bf16 v[88:91], a[68:71], v[60:63], v[88:91]
  ds_read_b128 a[96:99], v3 offset:22528
  v_mfma_f32_16x16x32_bf16 v[104:107], a[64:67], v[64:67], v[104:107]
  v_mfma_f32_16x16x32_bf16 v[104:107], a[68:71], v[68:71], v[104:107]
  ds_read_b128 a[100:103], v3 offset:30720
  s_waitcnt lgkmcnt(6)
  v_mfma_f32_16x16x32_bf16 v[92:95], a[72:75], v[56:59], v[92:95]
  v_mfma_f32_16x16x32_bf16 v[92:95], a[76:79], v[60:63], v[92:95]
  ds_read_b128 a[104:107], v3 offset:23552
  v_mfma_f32_16x16x32_bf16 v[108:111], a[72:75], v[64:67], v[108:111]
  v_mfma_f32_16x16x32_bf16 v[108:111], a[76:79], v[68:71], v[108:111]
  ds_read_b128 a[108:111], v3 offset:31744
  s_waitcnt lgkmcnt(6)
  v_mfma_f32_16x16x32_bf16 v[112:115], a[80:83], v[56:59], v[112:115]
  v_mfma_f32_16x16x32_bf16 v[112:115], a[84:87], v[60:63], v[112:115]
  v_mfma_f32_16x16x32_bf16 v[128:131], a[80:83], v[64:67], v[128:131]
  v_mfma_f32_16x16x32_bf16 v[128:131], a[84:87], v[68:71], v[128:131]
  s_waitcnt lgkmcnt(4)
  v_mfma_f32_16x16x32_bf16 v[116:119], a[88:91], v[56:59], v[116:119]
  v_mfma_f32_16x16x32_bf16 v[116:119], a[92:95], v[60:63], v[116:119]
  v_mfma_f32_16x16x32_bf16 v[132:135], a[88:91], v[64:67], v[132:135]
  v_mfma_f32_16x16x32_bf16 v[132:135], a[92:95], v[68:71], v[132:135]
  s_waitcnt lgkmcnt(2)
  v_mfma_f32_16x16x32_bf16 v[120:123], a[96:99], v[56:59], v[120:123]
  v_mfma_f32_16x16x32_bf16 v[120:123], a[100:103], v[60:63], v[120:123]
  v_mfma_f32_16x16x32_bf16 v[136:139], a[96:99], v[64:67], v[136:139]
  v_mfma_f32_16x16x32_bf16 v[136:139], a[100:103], v[68:71], v[136:139]
  s_waitcnt lgkmcnt(0)
  v_mfma_f32_16x16x32_bf16 v[124:127], a[104:107], v[56:59], v[124:127]
  v_mfma_f32_16x16x32_bf16 v[124:127], a[108:111], v[60:63], v[124:127]
  v_mfma_f32_16x16x32_bf16 v[140:143], a[104:107], v[64:67], v[140:143]
  v_mfma_f32_16x16x32_bf16 v[140:143], a[108:111], v[68:71], v[140:143]
  s_branch F1A_MDONE
F1A_G0_SKIP:
  s_setprio 0
  s_and_b32 s34, s28, 3
  s_lshl_b32 s34, s34, 13
  s_add_u32 s34, s34, 131072
  v_add_u32 v23, s34, v2
  ds_read_b128 a[0:3], v23 offset:0
  ds_read_b128 a[4:7], v23 offset:1024
  ds_read_b128 a[8:11], v23 offset:2048
  ds_read_b128 a[12:15], v23 offset:3072
  ds_read_b128 a[16:19], v23 offset:4096
  ds_read_b128 a[20:23], v23 offset:5120
  ds_read_b128 a[24:27], v23 offset:6144
  ds_read_b128 a[28:31], v23 offset:7168
  v_mov_b32 v3, v4
  v_add_u32 v4, s43, v4
  v_and_b32 v4, 0x1ffff, v4
  s_cmp_gt_u32 s37, s56
  s_cbranch_scc1 F1A_D7
  s_mov_b32 m0, s58
  s_add_u32 s58, s58, 0x8000
  buffer_load_dwordx4 v2, s[4:7], s37 offen sc1 lds
  buffer_load_dwordx4 v2, s[4:7], s37 offen offset:1024 sc1 lds
  s_and_b32 s58, s58, 0x1ffff
  s_add_u32 s37, s37, 16384
F1A_D7:
  s_cmp_gt_u32 s38, s57
  s_cbranch_scc1 F1A_D8
  s_mov_b32 m0, s59
  s_add_u32 s59, s59, 0x8000
  buffer_load_dwordx4 v2, s[4:7], s38 offen sc1 lds
  buffer_load_dwordx4 v2, s[4:7], s38 offen offset:1024 sc1 lds
  s_and_b32 s59, s59, 0x1ffff
  s_add_u32 s38, s38, 16384
F1A_D8:
  s_cmp_gt_u32 s37, s56
  s_cbranch_scc1 F1A_D9
  s_add_u32 s47, s31, 1
  s_cmp_lt_u32 s47, s32
  s_cbranch_scc1 F1A_D9
  s_mov_b32 m0, s58
  s_add_u32 s58, s58, 0x8000
  buffer_load_dwordx4 v2, s[4:7], s37 offen sc1 lds
  buffer_load_dwordx4 v2, s[4:7], s37 offen offset:1024 sc1 lds
  s_and_b32 s58, s58, 0x1ffff
  s_add_u32 s37, s37, 16384
F1A_D9:
  s_cmp_gt_u32 s38, s57
  s_cbranch_scc1 F1A_D10
  s_cmp_lt_u32 s31, s32
  s_cbranch_scc1 F1A_D10
  s_mov_b32 m0, s59
  s_add_u32 s59, s59, 0x8000
  buffer_load_dwordx4 v2, s[4:7], s38 offen sc1 lds
  buffer_load_dwordx4 v2, s[4:7], s38 offen offset:1024 sc1 lds
  s_and_b32 s59, s59, 0x1ffff
  s_add_u32 s38, s38, 16384
F1A_D10:
  v_mov_b32 v72, 0
  v_mov_b32 v73, 0
  v_mov_b32 v74, 0
  v_mov_b32 v75, 0
  v_mov_b32 v76, 0
  v_mov_b32 v77, 0
  v_mov_b32 v78, 0
  v_mov_b32 v79, 0
  s_add_u32 s35, s35, 1
  s_add_u32 s31, s31, 1
  s_waitcnt lgkmcnt(0)
  s_setprio 1
  ds_read_b128 a[48:51], v4 offset:0
  ds_read_b128 a[52:55], v4 offset:1024
  ds_read_b128 a[56:59], v4 offset:2048
  ds_read_b128 a[60:63], v4 offset:3072
  ds_read_b128 a[64:67], v4 offset:4096
  ds_read_b128 a[68:71], v4 offset:5120
  ds_read_b128 a[72:75], v4 offset:6144
  ds_read_b128 a[76:79], v4 offset:7168
  s_waitcnt lgkmcnt(4)
  v_mfma_f32_16x16x32_bf16 v[24:27], a[48:51], a[0:3], v[72:75]
  v_mfma_f32_16x16x32_bf16 v[24:27], a[52:55], a[4:7], v[24:27]
  ds_read_b128 a[80:83], v4 offset:8192
  v_mfma_f32_16x16x32_bf16 v[24:27], a[56:59], a[8:11], v[24:27]
  v_mfma_f32_16x16x32_bf16 v[24:27], a[60:63], a[12:15], v[24:27]
  ds_read_b128 a[84:87], v4 offset:9216
  v_mfma_f32_16x16x32_bf16 v[40:43], a[48:51], a[16:19], v[76:79]
  v_mfma_f32_16x16x32_bf16 v[40:43], a[52:55], a[20:23], v[40:43]
  ds_read_b128 a[88:91], v4 offset:10240
  v_mfma_f32_16x16x32_bf16 v[40:43], a[56:59], a[24:27], v[40:43]
  v_mfma_f32_16x16x32_bf16 v[40:43], a[60:63], a[28:31], v[40:43]
  ds_read_b128 a[92:95], v4 offset:11264
  s_waitcnt lgkmcnt(4)
  v_mfma_f32_16x16x32_bf16 v[28:31], a[64:67], a[0:3], v[72:75]
  v_mfma_f32_16x16x32_bf16 v[28:31], a[68:71], a[4:7], v[28:31]
  ds_read_b128 a[96:99], v4 offset:12288
  v_mfma_f32_16x16x32_bf16 v[28:31], a[72:75], a[8:11], v[28:31]
  v_mfma_f32_16x16x32_bf16 v[28:31], a[76:79], a[12:15], v[28:31]
  ds_read_b128 a[100:103], v4 offset:13312
  v_mfma_f32_16x16x32_bf16 v[44:47], a[64:67], a[16:19], v[76:79]
  v_mfma_f32_16x16x32_bf16 v[44:47], a[68:71], a[20:23], v[44:47]
  ds_read_b128 a[104:107], v4 offset:14336
  v_mfma_f32_16x16x32_bf16 v[44:47], a[72:75], a[24:27], v[44:47]
  v_mfma_f32_16x16x32_bf16 v[44:47], a[76:79], a[28:31], v[44:47]
  ds_read_b128 a[108:111], v4 offset:15360
  s_waitcnt lgkmcnt(4)
  v_mfma_f32_16x16x32_bf16 v[32:35], a[80:83], a[0:3], v[72:75]
  v_mfma_f32_16x16x32_bf16 v[32:35], a[84:87], a[4:7], v[32:35]
  v_mfma_f32_16x16x32_bf16 v[32:35], a[88:91], a[8:11], v[32:35]
  v_mfma_f32_16x16x32_bf16 v[32:35], a[92:95], a[12:15], v[32:35]
  v_mfma_f32_16x16x32_bf16 v[48:51], a[80:83], a[16:19], v[76:79]
  v_mfma_f32_16x16x32_bf16 v[48:51], a[84:87], a[20:23], v[48:51]
  v_mfma_f32_16x16x32_bf16 v[48:51], a[88:91], a[24:27], v[48:51]
  v_mfma_f32_16x16x32_bf16 v[48:51], a[92:95], a[28:31], v[48:51]
  s_branch F1A_MDONE
F1A_FRESH:
  s_waitcnt lgkmcnt(6)
  v_mfma_f32_16x16x32_bf16 v[80:83], a[48:51], v[56:59], 0
  v_mfma_f32_16x16x32_bf16 v[80:83], a[52:55], v[60:63], v[80:83]
  ds_read_b128 a[80:83], v3 offset:20480
  v_mfma_f32_16x16x32_bf16 v[96:99], a[48:51], v[64:67], 0
  v_mfma_f32_16x16x32_bf16 v[96:99], a[52:55], v[68:71], v[96:99]
  ds_read_b128 a[84:87], v3 offset:28672
  s_waitcnt lgkmcnt(6)
  v_mfma_f32_16x16x32_bf16 v[84:87], a[56:59], v[56:59], 0
  v_mfma_f32_16x16x32_bf16 v[84:87], a[60:63], v[60:63], v[84:87]
  ds_read_b128 a[88:91], v3 offset:21504
  v_mfma_f32_16x16x32_bf16 v[100:103], a[56:59], v[64:67], 0
  v_mfma_f32_16x16x32_bf16 v[100:103], a[60:63], v[68:71], v[100:103]
  ds_read_b128 a[92:95], v3 offset:29696
  s_waitcnt lgkmcnt(6)
  v_mfma_f32_16x16x32_bf16 v[88:91], a[64:67], v[56:59], 0
  v_mfma_f32_16x16x32_bf16 v[88:91], a[68:71], v[60:63], v[88:91]
  ds_read_b128 a[96:99], v3 offset:22528
  v_mfma_f32_16x16x32_bf16 v[104:107], a[64:67], v[64:67], 0
  v_mfma_f32_16x16x32_bf16 v[104:107], a[68:71], v[68:71], v[104:107]
  ds_read_b128 a[100:103], v3 offset:30720
  s_waitcnt lgkmcnt(6)
  v_mfma_f32_16x16x32_bf16 v[92:95], a[72:75], v[56:59], 0
  v_mfma_f32_16x16x32_bf16 v[92:95], a[76:79], v[60:63], v[92:95]
  ds_read_b128 a[104:107], v3 offset:23552
  v_mfma_f32_16x16x32_bf16 v[108:111], a[72:75], v[64:67], 0
  v_mfma_f32_16x16x32_bf16 v[108:111], a[76:79], v[68:71], v[108:111]
  ds_read_b128 a[108:111], v3 offset:31744
  s_waitcnt lgkmcnt(6)
  v_mfma_f32_16x16x32_bf16 v[112:115], a[80:83], v[56:59], 0
  v_mfma_f32_16x16x32_bf16 v[112:115], a[84:87], v[60:63], v[112:115]
  ds_read_b128 a[48:51], v4 offset:0
  v_mfma_f32_16x16x32_bf16 v[128:131], a[80:83], v[64:67], 0
  v_mfma_f32_16x16x32_bf16 v[128:131], a[84:87], v[68:71], v[128:131]
  ds_read_b128 a[52:55], v4 offset:1024
  s_waitcnt lgkmcnt(6)
  v_mfma_f32_16x16x32_bf16 v[116:119], a[88:91], v[56:59], 0
  v_mfma_f32_16x16x32_bf16 v[116:119], a[92:95], v[60:63], v[116:119]
  ds_read_b128 a[56:59], v4 offset:2048
  v_mfma_f32_16x16x32_bf16 v[132:135], a[88:91], v[64:67], 0
  v_mfma_f32_16x16x32_bf16 v[132:135], a[92:95], v[68:71], v[132:135]
  ds_read_b128 a[60:63], v4 offset:3072
  s_waitcnt lgkmcnt(6)
  v_mfma_f32_16x16x32_bf16 v[120:123], a[96:99], v[56:59], 0
  v_mfma_f32_16x16x32_bf16 v[120:123], a[100:103], v[60:63], v[120:123]
  ds_read_b128 a[64:67], v4 offset:4096
  v_mfma_f32_16x16x32_bf16 v[136:139], a[96:99], v[64:67], 0
  v_mfma_f32_16x16x32_bf16 v[136:139], a[100:103], v[68:71], v[136:139]
  ds_read_b128 a[68:71], v4 offset:5120
  s_waitcnt lgkmcnt(6)
  v_mfma_f32_16x16x32_bf16 v[124:127], a[104:107], v[56:59], 0
  v_mfma_f32_16x16x32_bf16 v[124:127], a[108:111], v[60:63], v[124:127]
  ds_read_b128 a[72:75], v4 offset:6144
  v_mfma_f32_16x16x32_bf16 v[140:143], a[104:107], v[64:67], 0
  v_mfma_f32_16x16x32_bf16 v[140:143], a[108:111], v[68:71], v[140:143]
  ds_read_b128 a[76:79], v4 offset:7168
  s_branch F1A_FRESH_RET
F1A_QB:
  s_and_b32 s34, s28, 3
  s_lshl_b32 s34, s34, 13
  s_add_u32 s34, s34, 131072
  v_add_u32 v23, s34, v2
  ds_read_b128 a[0:3], v23 offset:0
  ds_read_b128 a[4:7], v23 offset:1024
  ds_read_b128 a[8:11], v23 offset:2048
  ds_read_b128 a[12:15], v23 offset:3072
  ds_read_b128 a[16:19], v23 offset:4096
  ds_read_b128 a[20:23], v23 offset:5120
  ds_read_b128 a[24:27], v23 offset:6144
  ds_read_b128 a[28:31], v23 offset:7168
  s_waitcnt lgkmcnt(0)
  s_branch F1A_QB_RET
F1A_SWITCH:
  v_mov_b32 v72, 0
  v_mov_b32 v73, 0
  v_mov_b32 v74, 0
  v_mov_b32 v75, 0
  v_mov_b32 v76, 0
  v_mov_b32 v77, 0
  v_mov_b32 v78, 0
  v_mov_b32 v79, 0
  s_branch F1A_SWITCH_RET
F1A_EPI_A:
  v_mov_b32 v12, v5
  v_mov_b32 v13, v5
  s_nop 1
  v_permlane32_swap_b32 v12, v13
  s_nop 1
  v_add_f32 v5, v12, v13
  v_mov_b32 v12, v5
  v_mov_b32 v13, v5
  s_nop 1
  v_permlane16_swap_b32 v12, v13
  s_nop 1
  v_add_f32 v5, v12, v13
  v_rcp_f32 v5, v5
  v_mov_b32 v12, v6
  v_mov_b32 v13, v6
  s_nop 1
  v_permlane32_swap_b32 v12, v13
  s_nop 1
  v_add_f32 v6, v12, v13
  v_mov_b32 v12, v6
  v_mov_b32 v13, v6
  s_nop 1
  v_permlane16_swap_b32 v12, v13
  s_nop 1
  v_add_f32 v6, v12, v13
  v_rcp_f32 v6, v6
  s_nop 0
  v_mul_f32 v80, v80, v5
  v_mul_f32 v81, v81, v5
  v_mul_f32 v82, v82, v5
  v_mul_f32 v83, v83, v5
  v_mul_f32 v84, v84, v5
  v_mul_f32 v85, v85, v5
  v_mul_f32 v86, v86, v5
  v_mul_f32 v87, v87, v5
  v_cvt_pk_bf16_f32 v12, v80, v81
  v_cvt_pk_bf16_f32 v13, v82, v83
  v_cvt_pk_bf16_f32 v14, v84, v85
  v_cvt_pk_bf16_f32 v15, v86, v87
  buffer_store_dwordx4 v[12:15], v2, s[4:7], s45 offen offset:0 sc1
  v_mul_f32 v88, v88, v5
  v_mul_f32 v89, v89, v5
  v_mul_f32 v90, v90, v5
  v_mul_f32 v91, v91, v5
  v_mul_f32 v92, v92, v5
  v_mul_f32 v93, v93, v5
  v_mul_f32 v94, v94, v5
  v_mul_f32 v95, v95, v5
  v_cvt_pk_bf16_f32 v16, v88, v89
  v_cvt_pk_bf16_f32 v17, v90, v91
  v_cvt_pk_bf16_f32 v18, v92, v93
  v_cvt_pk_bf16_f32 v19, v94, v95
  buffer_store_dwordx4 v[16:19], v2, s[4:7], s45 offen offset:1024 sc1
  v_mul_f32 v112, v112, v5
  v_mul_f32 v113, v113, v5
  v_mul_f32 v114, v114, v5
  v_mul_f32 v115, v115, v5
  v_mul_f32 v116, v116, v5
  v_mul_f32 v117, v117, v5
  v_mul_f32 v118, v118, v5
  v_mul_f32 v119, v119, v5
  v_cvt_pk_bf16_f32 v12, v112, v113
  v_cvt_pk_bf16_f32 v13, v114, v115
  v_cvt_pk_bf16_f32 v14, v116, v117
  v_cvt_pk_bf16_f32 v15, v118, v119
  buffer_store_dwordx4 v[12:15], v2, s[4:7], s45 offen offset:2048 sc1
  v_mul_f32 v120, v120, v5
  v_mul_f32 v121, v121, v5
  v_mul_f32 v122, v122, v5
  v_mul_f32 v123, v123, v5
  v_mul_f32 v124, v124, v5
  v_mul_f32 v125, v125, v5
  v_mul_f32 v126, v126, v5
  v_mul_f32 v127, v127, v5
  v_cvt_pk_bf16_f32 v16, v120, v121
  v_cvt_pk_bf16_f32 v17, v122, v123
  v_cvt_pk_bf16_f32 v18, v124, v125
  v_cvt_pk_bf16_f32 v19, v126, v127
  buffer_store_dwordx4 v[16:19], v2, s[4:7], s45 offen offset:3072 sc1
  v_mul_f32 v96, v96, v6
  v_mul_f32 v97, v97, v6
  v_mul_f32 v98, v98, v6
  v_mul_f32 v99, v99, v6
  v_mul_f32 v100, v100, v6
  v_mul_f32 v101, v101, v6
  v_mul_f32 v102, v102, v6
  v_mul_f32 v103, v103, v6
  v_cvt_pk_bf16_f32 v12, v96, v97
  v_cvt_pk_bf16_f32 v13, v98, v99
  v_cvt_pk_bf16_f32 v14, v100, v101
  v_cvt_pk_bf16_f32 v15, v102, v103
  s_add_u32 s45, s45, 4096
  buffer_store_dwordx4 v[12:15], v2, s[4:7], s45 offen offset:0 sc1
  v_mul_f32 v104, v104, v6
  v_mul_f32 v105, v105, v6
  v_mul_f32 v106, v106, v6
  v_mul_f32 v107, v107, v6
  v_mul_f32 v108, v108, v6
  v_mul_f32 v109, v109, v6
  v_mul_f32 v110, v110, v6
  v_mul_f32 v111, v111, v6
  v_cvt_pk_bf16_f32 v16, v104, v105
  v_cvt_pk_bf16_f32 v17, v106, v107
  v_cvt_pk_bf16_f32 v18, v108, v109
  v_cvt_pk_bf16_f32 v19, v110, v111
  buffer_store_dwordx4 v[16:19], v2, s[4:7], s45 offen offset:1024 sc1
  v_mul_f32 v128, v128, v6
  v_mul_f32 v129, v129, v6
  v_mul_f32 v130, v130, v6
  v_mul_f32 v131, v131, v6
  v_mul_f32 v132, v132, v6
  v_mul_f32 v133, v133, v6
  v_mul_f32 v134, v134, v6
  v_mul_f32 v135, v135, v6
  v_cvt_pk_bf16_f32 v12, v128, v129
  v_cvt_pk_bf16_f32 v13, v130, v131
  v_cvt_pk_bf16_f32 v14, v132, v133
  v_cvt_pk_bf16_f32 v15, v134, v135
  buffer_store_dwordx4 v[12:15], v2, s[4:7], s45 offen offset:2048 sc1
  v_mul_f32 v136, v136, v6
  v_mul_f32 v137, v137, v6
  v_mul_f32 v138, v138, v6
  v_mul_f32 v139, v139, v6
  v_mul_f32 v140, v140, v6
  v_mul_f32 v141, v141, v6
  v_mul_f32 v142, v142, v6
  v_mul_f32 v143, v143, v6
  v_cvt_pk_bf16_f32 v16, v136, v137
  v_cvt_pk_bf16_f32 v17, v138, v139
  v_cvt_pk_bf16_f32 v18, v140, v141
  v_cvt_pk_bf16_f32 v19, v142, v143
  buffer_store_dwordx4 v[16:19], v2, s[4:7], s45 offen offset:3072 sc1
  v_mov_b32 v5, 0
  v_mov_b32 v6, 0
  s_mov_b32 s42, 1
  s_lshl_b32 s33, s50, 5
  s_waitcnt vmcnt(8) lgkmcnt(0)
  s_barrier
  s_branch F1A_G0_S
F1A_INIT_g0s:
  v_mov_b32 v20, v8
  v_mov_b32 v12, v20
  v_mov_b32 v13, v20
  s_nop 1
  v_permlane32_swap_b32 v12, v13
  s_nop 1
  v_add_f32 v20, v12, v13
  v_mov_b32 v12, v20
  v_mov_b32 v13, v20
  s_nop 1
  v_permlane16_swap_b32 v12, v13
  s_nop 1
  v_add_f32 v20, v12, v13
  v_mov_b32 v21, v10
  v_mov_b32 v12, v21
  v_mov_b32 v13, v21
  s_nop 1
  v_permlane32_swap_b32 v12, v13
  s_nop 1
  v_add_f32 v21, v12, v13
  v_mov_b32 v12, v21
  v_mov_b32 v13, v21
  s_nop 1
  v_permlane16_swap_b32 v12, v13
  s_nop 1
  v_add_f32 v21, v12, v13
  v_min_f32 v20, v20, v21
  v_cmp_nle_f32 vcc, 0x35800000, v20
  s_cbranch_vccnz F1A_FIX_g0s
  s_mov_b32 s42, 0
  s_branch F1A_FIXRET_g0s
F1A_MASK_g0s:
  s_lshl_b32 s34, s35, 6
  s_sub_u32 s34, s33, s34
  v_and_b32 v7, 15, v1
  v_lshrrev_b32 v12, 4, v1
  v_lshlrev_b32 v12, 2, v12
  v_sub_u32 v7, v7, v12
  v_mov_b32 v12, 0xff800000
  v_cmp_gt_i32 s[60:61], 0, v7
  v_cmp_gt_i32 s[62:63], 1, v7
  v_cmp_gt_i32 s[52:53], 2, v7
  v_cmp_gt_i32 vcc, 3, v7
  s_cmp_eq_u32 s34, 32
  s_cbranch_scc1 F1A_MASK32_g0s
  v_mov_b32 v32, v12
  v_mov_b32 v33, v12
  v_mov_b32 v34, v12
  v_mov_b32 v35, v12
  v_mov_b32 v48, v12
  v_mov_b32 v49, v12
  v_mov_b32 v50, v12
  v_mov_b32 v51, v12
  v_mov_b32 v36, v12
  v_mov_b32 v37, v12
  v_mov_b32 v38, v12
  v_mov_b32 v39, v12
  v_mov_b32 v52, v12
  v_mov_b32 v53, v12
  v_mov_b32 v54, v12
  v_mov_b32 v55, v12
  v_mov_b32 v28, v12
  v_mov_b32 v29, v12
  v_mov_b32 v30, v12
  v_mov_b32 v31, v12
  s_cmp_eq_u32 s34, 0
  s_cbranch_scc1 F1A_MASK0_g0s
  v_mov_b32 v24, v12
  v_mov_b32 v25, v12
  v_mov_b32 v26, v12
  v_mov_b32 v27, v12
  v_mov_b32 v40, v12
  v_mov_b32 v41, v12
  v_mov_b32 v42, v12
  v_mov_b32 v43, v12
  v_mov_b32 v44, v12
  v_mov_b32 v45, v12
  v_mov_b32 v46, v12
  v_mov_b32 v47, v12
  s_branch F1A_MASKRET_g0s
F1A_MASK0_g0s:
  v_cndmask_b32 v24, v24, v12, s[60:61]
  v_cndmask_b32 v25, v25, v12, s[62:63]
  v_cndmask_b32 v26, v26, v12, s[52:53]
  v_cndmask_b32 v27, v27, v12, vcc
  v_cndmask_b32 v44, v44, v12, s[60:61]
  v_cndmask_b32 v45, v45, v12, s[62:63]
  v_cndmask_b32 v46, v46, v12, s[52:53]
  v_cndmask_b32 v47, v47, v12, vcc
  s_branch F1A_MASKRET_g0s
F1A_MASK32_g0s:
  v_cndmask_b32 v32, v32, v12, s[60:61]
  v_cndmask_b32 v33, v33, v12, s[62:63]
  v_cndmask_b32 v34, v34, v12, s[52:53]
  v_cndmask_b32 v35, v35, v12, vcc
  v_cndmask_b32 v52, v52, v12, s[60:61]
  v_cndmask_b32 v53, v53, v12, s[62:63]
  v_cndmask_b32 v54, v54, v12, s[52:53]
  v_cndmask_b32 v55, v55, v12, vcc
  v_mov_b32 v36, v12
  v_mov_b32 v37, v12
  v_mov_b32 v38, v12
  v_mov_b32 v39, v12
  s_branch F1A_MASKRET_g0s
F1A_G0_LAST:
  s_cmp_lg_u32 s32, 16
  s_cbranch_scc1 F1A_LASTN
  s_waitcnt lgkmcnt(6)
  v_mfma_f32_16x16x32_bf16 v[80:83], a[48:51], v[56:59], 0
  v_mfma_f32_16x16x32_bf16 v[80:83], a[52:55], v[60:63], v[80:83]
  ds_read_b128 a[80:83], v3 offset:20480
  v_mfma_f32_16x16x32_bf16 v[96:99], a[48:51], v[64:67], 0
  v_mfma_f32_16x16x32_bf16 v[96:99], a[52:55], v[68:71], v[96:99]
  ds_read_b128 a[84:87], v3 offset:28672
  s_waitcnt lgkmcnt(6)
  v_mfma_f32_16x16x32_bf16 v[84:87], a[56:59], v[56:59], 0
  v_mfma_f32_16x16x32_bf16 v[84:87], a[60:63], v[60:63], v[84:87]
  ds_read_b128 a[88:91], v3 offset:21504
  v_mfma_f32_16x16x32_bf16 v[100:103], a[56:59], v[64:67], 0
  v_mfma_f32_16x16x32_bf16 v[100:103], a[60:63], v[68:71], v[100:103]
  ds_read_b128 a[92:95], v3 offset:29696
  s_waitcnt lgkmcnt(6)
  v_mfma_f32_16x16x32_bf16 v[88:91], a[64:67], v[56:59], 0
  v_mfma_f32_16x16x32_bf16 v[88:91], a[68:71], v[60:63], v[88:91]
  ds_read_b128 a[96:99], v3 offset:22528
  v_mfma_f32_16x16x32_bf16 v[104:107], a[64:67], v[64:67], 0
  v_mfma_f32_16x16x32_bf16 v[104:107], a[68:71], v[68:71], v[104:107]
  ds_read_b128 a[100:103], v3 offset:30720
  s_waitcnt lgkmcnt(6)
  v_mfma_f32_16x16x32_bf16 v[92:95], a[72:75], v[56:59], 0
  v_mfma_f32_16x16x32_bf16 v[92:95], a[76:79], v[60:63], v[92:95]
  ds_read_b128 a[104:107], v3 offset:23552
  v_mfma_f32_16x16x32_bf16 v[108:111], a[72:75], v[64:67], 0
  v_mfma_f32_16x16x32_bf16 v[108:111], a[76:79], v[68:71], v[108:111]
  ds_read_b128 a[108:111], v3 offset:31744
  s_waitcnt lgkmcnt(6)
  v_mfma_f32_16x16x32_bf16 v[112:115], a[80:83], v[56:59], 0
  v_mfma_f32_16x16x32_bf16 v[112:115], a[84:87], v[60:63], v[112:115]
  v_mfma_f32_16x16x32_bf16 v[128:131], a[80:83], v[64:67], 0
  v_mfma_f32_16x16x32_bf16 v[128:131], a[84:87], v[68:71], v[128:131]
  s_waitcnt lgkmcnt(4)
  v_mfma_f32_16x16x32_bf16 v[116:119], a[88:91], v[56:59], 0
  v_mfma_f32_16x16x32_bf16 v[116:119], a[92:95], v[60:63], v[116:119]
  v_mfma_f32_16x16x32_bf16 v[132:135], a[88:91], v[64:67], 0
  v_mfma_f32_16x16x32_bf16 v[132:135], a[92:95], v[68:71], v[132:135]
  s_waitcnt lgkmcnt(2)
  v_mfma_f32_16x16x32_bf16 v[120:123], a[96:99], v[56:59], 0
  v_mfma_f32_16x16x32_bf16 v[120:123], a[100:103], v[60:63], v[120:123]
  v_mfma_f32_16x16x32_bf16 v[136:139], a[96:99], v[64:67], 0
  v_mfma_f32_16x16x32_bf16 v[136:139], a[100:103], v[68:71], v[136:139]
  s_waitcnt lgkmcnt(0)
  v_mfma_f32_16x16x32_bf16 v[124:127], a[104:107], v[56:59], 0
  v_mfma_f32_16x16x32_bf16 v[124:127], a[108:111], v[60:63], v[124:127]
  v_mfma_f32_16x16x32_bf16 v[140:143], a[104:107], v[64:67], 0
  v_mfma_f32_16x16x32_bf16 v[140:143], a[108:111], v[68:71], v[140:143]
  s_branch F1A_LASTM
F1A_LASTN:
  s_waitcnt lgkmcnt(6)
  v_mfma_f32_16x16x32_bf16 v[80:83], a[48:51], v[56:59], v[80:83]
  v_mfma_f32_16x16x32_bf16 v[80:83], a[52:55], v[60:63], v[80:83]
  ds_read_b128 a[80:83], v3 offset:20480
  v_mfma_f32_16x16x32_bf16 v[96:99], a[48:51], v[64:67], v[96:99]
  v_mfma_f32_16x16x32_bf16 v[96:99], a[52:55], v[68:71], v[96:99]
  ds_read_b128 a[84:87], v3 offset:28672
  s_waitcnt lgkmcnt(6)
  v_mfma_f32_16x16x32_bf16 v[84:87], a[56:59], v[56:59], v[84:87]
  v_mfma_f32_16x16x32_bf16 v[84:87], a[60:63], v[60:63], v[84:87]
  ds_read_b128 a[88:91], v3 offset:21504
  v_mfma_f32_16x16x32_bf16 v[100:103], a[56:59], v[64:67], v[100:103]
  v_mfma_f32_16x16x32_bf16 v[100:103], a[60:63], v[68:71], v[100:103]
  ds_read_b128 a[92:95], v3 offset:29696
  s_waitcnt lgkmcnt(6)
  v_mfma_f32_16x16x32_bf16 v[88:91], a[64:67], v[56:59], v[88:91]
  v_mfma_f32_16x16x32_bf16 v[88:91], a[68:71], v[60:63], v[88:91]
  ds_read_b128 a[96:99], v3 offset:22528
  v_mfma_f32_16x16x32_bf16 v[104:107], a[64:67], v[64:67], v[104:107]
  v_mfma_f32_16x16x32_bf16 v[104:107], a[68:71], v[68:71], v[104:107]
  ds_read_b128 a[100:103], v3 offset:30720
  s_waitcnt lgkmcnt(6)
  v_mfma_f32_16x16x32_bf16 v[92:95], a[72:75], v[56:59], v[92:95]
  v_mfma_f32_16x16x32_bf16 v[92:95], a[76:79], v[60:63], v[92:95]
  ds_read_b128 a[104:107], v3 offset:23552
  v_mfma_f32_16x16x32_bf16 v[108:111], a[72:75], v[64:67], v[108:111]
  v_mfma_f32_16x16x32_bf16 v[108:111], a[76:79], v[68:71], v[108:111]
  ds_read_b128 a[108:111], v3 offset:31744
  s_waitcnt lgkmcnt(6)
  v_mfma_f32_16x16x32_bf16 v[112:115], a[80:83], v[56:59], v[112:115]
  v_mfma_f32_16x16x32_bf16 v[112:115], a[84:87], v[60:63], v[112:115]
  v_mfma_f32_16x16x32_bf16 v[128:131], a[80:83], v[64:67], v[128:131]
  v_mfma_f32_16x16x32_bf16 v[128:131], a[84:87], v[68:71], v[128:131]
  s_waitcnt lgkmcnt(4)
  v_mfma_f32_16x16x32_bf16 v[116:119], a[88:91], v[56:59], v[116:119]
  v_mfma_f32_16x16x32_bf16 v[116:119], a[92:95], v[60:63], v[116:119]
  v_mfma_f32_16x16x32_bf16 v[132:135], a[88:91], v[64:67], v[132:135]
  v_mfma_f32_16x16x32_bf16 v[132:135], a[92:95], v[68:71], v[132:135]
  s_waitcnt lgkmcnt(2)
  v_mfma_f32_16x16x32_bf16 v[120:123], a[96:99], v[56:59], v[120:123]
  v_mfma_f32_16x16x32_bf16 v[120:123], a[100:103], v[60:63], v[120:123]
  v_mfma_f32_16x16x32_bf16 v[136:139], a[96:99], v[64:67], v[136:139]
  v_mfma_f32_16x16x32_bf16 v[136:139], a[100:103], v[68:71], v[136:139]
  s_waitcnt lgkmcnt(0)
  v_mfma_f32_16x16x32_bf16 v[124:127], a[104:107], v[56:59], v[124:127]
  v_mfma_f32_16x16x32_bf16 v[124:127], a[108:111], v[60:63], v[124:127]
  v_mfma_f32_16x16x32_bf16 v[140:143], a[104:107], v[64:67], v[140:143]
  v_mfma_f32_16x16x32_bf16 v[140:143], a[108:111], v[68:71], v[140:143]
F1A_LASTM:
  s_setprio 0
  s_waitcnt vmcnt(0) lgkmcnt(0)
  s_barrier
  s_branch F1A_MERGE
F1A_G1:
  s_waitcnt vmcnt(0)
  s_barrier
  s_setprio 2
  ds_read_b128 a[48:51], v4 offset:0
  ds_read_b128 a[52:55], v4 offset:1024
  ds_read_b128 a[56:59], v4 offset:2048
  ds_read_b128 a[60:63], v4 offset:3072
  ds_read_b128 a[64:67], v4 offset:4096
  ds_read_b128 a[68:71], v4 offset:5120
  ds_read_b128 a[72:75], v4 offset:6144
  ds_read_b128 a[76:79], v4 offset:7168
  s_waitcnt lgkmcnt(4)
  v_mfma_f32_16x16x32_bf16 v[24:27], a[48:51], a[0:3], v[72:75]
  v_mfma_f32_16x16x32_bf16 v[24:27], a[52:55], a[4:7], v[24:27]
  ds_read_b128 a[80:83], v4 offset:8192
  v_mfma_f32_16x16x32_bf16 v[24:27], a[56:59], a[8:11], v[24:27]
  v_mfma_f32_16x16x32_bf16 v[24:27], a[60:63], a[12:15], v[24:27]
  ds_read_b128 a[84:87], v4 offset:9216
  v_mfma_f32_16x16x32_bf16 v[40:43], a[48:51], a[16:19], v[76:79]
  v_mfma_f32_16x16x32_bf16 v[40:43], a[52:55], a[20:23], v[40:43]
  ds_read_b128 a[88:91], v4 offset:10240
  v_mfma_f32_16x16x32_bf16 v[40:43], a[56:59], a[24:27], v[40:43]
  v_mfma_f32_16x16x32_bf16 v[40:43], a[60:63], a[28:31], v[40:43]
  ds_read_b128 a[92:95], v4 offset:11264
  s_waitcnt lgkmcnt(4)
  v_mfma_f32_16x16x32_bf16 v[28:31], a[64:67], a[0:3], v[72:75]
  v_mfma_f32_16x16x32_bf16 v[28:31], a[68:71], a[4:7], v[28:31]
  ds_read_b128 a[96:99], v4 offset:12288
  v_mfma_f32_16x16x32_bf16 v[28:31], a[72:75], a[8:11], v[28:31]
  v_mfma_f32_16x16x32_bf16 v[28:31], a[76:79], a[12:15], v[28:31]
  ds_read_b128 a[100:103], v4 offset:13312
  v_mfma_f32_16x16x32_bf16 v[44:47], a[64:67], a[16:19], v[76:79]
  v_mfma_f32_16x16x32_bf16 v[44:47], a[68:71], a[20:23], v[44:47]
  ds_read_b128 a[104:107], v4 offset:14336
  v_mfma_f32_16x16x32_bf16 v[44:47], a[72:75], a[24:27], v[44:47]
  v_mfma_f32_16x16x32_bf16 v[44:47], a[76:79], a[28:31], v[44:47]
  ds_read_b128 a[108:111], v4 offset:15360
  s_waitcnt lgkmcnt(4)
  v_mfma_f32_16x16x32_bf16 v[32:35], a[80:83], a[0:3], v[72:75]
  v_mfma_f32_16x16x32_bf16 v[32:35], a[84:87], a[4:7], v[32:35]
  v_mfma_f32_16x16x32_bf16 v[32:35], a[88:91], a[8:11], v[32:35]
  v_mfma_f32_16x16x32_bf16 v[32:35], a[92:95], a[12:15], v[32:35]
  v_mfma_f32_16x16x32_bf16 v[48:51], a[80:83], a[16:19], v[76:79]
  v_mfma_f32_16x16x32_bf16 v[48:51], a[84:87], a[20:23], v[48:51]
  v_mfma_f32_16x16x32_bf16 v[48:51], a[88:91], a[24:27], v[48:51]
  v_mfma_f32_16x16x32_bf16 v[48:51], a[92:95], a[28:31], v[48:51]
  s_waitcnt lgkmcnt(0)
  v_mfma_f32_16x16x32_bf16 v[36:39], a[96:99], a[0:3], v[72:75]
  v_mfma_f32_16x16x32_bf16 v[36:39], a[100:103], a[4:7], v[36:39]
  v_mfma_f32_16x16x32_bf16 v[36:39], a[104:107], a[8:11], v[36:39]
  v_mfma_f32_16x16x32_bf16 v[36:39], a[108:111], a[12:15], v[36:39]
  v_mfma_f32_16x16x32_bf16 v[52:55], a[96:99], a[16:19], v[76:79]
  v_mfma_f32_16x16x32_bf16 v[52:55], a[100:103], a[20:23], v[52:55]
  v_mfma_f32_16x16x32_bf16 v[52:55], a[104:107], a[24:27], v[52:55]
  v_mfma_f32_16x16x32_bf16 v[52:55], a[108:111], a[28:31], v[52:55]
  s_branch F1A_G1_V
F1A_G1_F:
  s_setprio 2
  ds_read_b128 a[48:51], v3 offset:16384
  ds_read_b128 a[52:55], v3 offset:24576
  ds_read_b128 a[56:59], v3 offset:17408
  ds_read_b128 a[60:63], v3 offset:25600
  ds_read_b128 a[64:67], v3 offset:18432
  ds_read_b128 a[68:71], v3 offset:26624
  ds_read_b128 a[72:75], v3 offset:19456
  ds_read_b128 a[76:79], v3 offset:27648
  s_waitcnt lgkmcnt(6)
  v_mfma_f32_16x16x32_bf16 v[80:83], a[48:51], v[56:59], v[80:83]
  v_mfma_f32_16x16x32_bf16 v[80:83], a[52:55], v[60:63], v[80:83]
  ds_read_b128 a[80:83], v3 offset:20480
  v_mfma_f32_16x16x32_bf16 v[96:99], a[48:51], v[64:67], v[96:99]
  v_mfma_f32_16x16x32_bf16 v[96:99], a[52:55], v[68:71], v[96:99]
  ds_read_b128 a[84:87], v3 offset:28672
  s_waitcnt lgkmcnt(6)
  v_mfma_f32_16x16x32_bf16 v[84:87], a[56:59], v[56:59], v[84:87]
  v_mfma_f32_16x16x32_bf16 v[84:87], a[60:63], v[60:63], v[84:87]
  ds_read_b128 a[88:91], v3 offset:21504
  v_mfma_f32_16x16x32_bf16 v[100:103], a[56:59], v[64:67], v[100:103]
  v_mfma_f32_16x16x32_bf16 v[100:103], a[60:63], v[68:71], v[100:103]
  ds_read_b128 a[92:95], v3 offset:29696
  s_waitcnt lgkmcnt(6)
  v_mfma_f32_16x16x32_bf16 v[88:91], a[64:67], v[56:59], v[88:91]
  v_mfma_f32_16x16x32_bf16 v[88:91], a[68:71], v[60:63], v[88:91]
  ds_read_b128 a[96:99], v3 offset:22528
  v_mfma_f32_16x16x32_bf16 v[104:107], a[64:67], v[64:67], v[104:107]
  v_mfma_f32_16x16x32_bf16 v[104:107], a[68:71], v[68:71], v[104:107]
  ds_read_b128 a[100:103], v3 offset:30720
  s_waitcnt lgkmcnt(6)
  v_mfma_f32_16x16x32_bf16 v[92:95], a[72:75], v[56:59], v[92:95]
  v_mfma_f32_16x16x32_bf16 v[92:95], a[76:79], v[60:63], v[92:95]
  ds_read_b128 a[104:107], v3 offset:23552
  v_mfma_f32_16x16x32_bf16 v[108:111], a[72:75], v[64:67], v[108:111]
  v_mfma_f32_16x16x32_bf16 v[108:111], a[76:79], v[68:71], v[108:111]
  ds_read_b128 a[108:111], v3 offset:31744
  s_waitcnt lgkmcnt(6)
  v_mfma_f32_16x16x32_bf16 v[112:115], a[80:83], v[56:59], v[112:115]
  v_mfma_f32_16x16x32_bf16 v[112:115], a[84:87], v[60:63], v[112:115]
  ds_read_b128 a[48:51], v4 offset:0
  v_mfma_f32_16x16x32_bf16 v[128:131], a[80:83], v[64:67], v[128:131]
  v_mfma_f32_16x16x32_bf16 v[128:131], a[84:87], v[68:71], v[128:131]
  ds_read_b128 a[52:55], v4 offset:1024
  s_waitcnt lgkmcnt(6)
  v_mfma_f32_16x16x32_bf16 v[116:119], a[88:91], v[56:59], v[116:119]
  v_mfma_f32_16x16x32_bf16 v[116:119], a[92:95], v[60:63], v[116:119]
  ds_read_b128 a[56:59], v4 offset:2048
  v_mfma_f32_16x16x32_bf16 v[132:135], a[88:91], v[64:67], v[132:135]
  v_mfma_f32_16x16x32_bf16 v[132:135], a[92:95], v[68:71], v[132:135]
  ds_read_b128 a[60:63], v4 offset:3072
  s_waitcnt lgkmcnt(6)
  v_mfma_f32_16x16x32_bf16 v[120:123], a[96:99], v[56:59], v[120:123]
  v_mfma_f32_16x16x32_bf16 v[120:123], a[100:103], v[60:63], v[120:123]
  ds_read_b128 a[64:67], v4 offset:4096
  v_mfma_f32_16x16x32_bf16 v[136:139], a[96:99], v[64:67], v[136:139]
  v_mfma_f32_16x16x32_bf16 v[136:139], a[100:103], v[68:71], v[136:139]
  ds_read_b128 a[68:71], v4 offset:5120
  s_waitcnt lgkmcnt(6)
  v_mfma_f32_16x16x32_bf16 v[124:127], a[104:107], v[56:59], v[124:127]
  v_mfma_f32_16x16x32_bf16 v[124:127], a[108:111], v[60:63], v[124:127]
  ds_read_b128 a[72:75], v4 offset:6144
  v_mfma_f32_16x16x32_bf16 v[140:143], a[104:107], v[64:67], v[140:143]
  v_mfma_f32_16x16x32_bf16 v[140:143], a[108:111], v[68:71], v[140:143]
  ds_read_b128 a[76:79], v4 offset:7168
  s_waitcnt lgkmcnt(4)
  v_mfma_f32_16x16x32_bf16 v[24:27], a[48:51], a[0:3], v[72:75]
  v_mfma_f32_16x16x32_bf16 v[24:27], a[52:55], a[4:7], v[24:27]
  ds_read_b128 a[80:83], v4 offset:8192
  v_mfma_f32_16x16x32_bf16 v[24:27], a[56:59], a[8:11], v[24:27]
  v_mfma_f32_16x16x32_bf16 v[24:27], a[60:63], a[12:15], v[24:27]
  ds_read_b128 a[84:87], v4 offset:9216
  v_mfma_f32_16x16x32_bf16 v[40:43], a[48:51], a[16:19], v[76:79]
  v_mfma_f32_16x16x32_bf16 v[40:43], a[52:55], a[20:23], v[40:43]
  ds_read_b128 a[88:91], v4 offset:10240
  v_mfma_f32_16x16x32_bf16 v[40:43], a[56:59], a[24:27], v[40:43]
  v_mfma_f32_16x16x32_bf16 v[40:43], a[60:63], a[28:31], v[40:43]
  ds_read_b128 a[92:95], v4 offset:11264
  s_waitcnt lgkmcnt(4)
  v_mfma_f32_16x16x32_bf16 v[28:31], a[64:67], a[0:3], v[72:75]
  v_mfma_f32_16x16x32_bf16 v[28:31], a[68:71], a[4:7], v[28:31]
  ds_read_b128 a[96:99], v4 offset:12288
  v_mfma_f32_16x16x32_bf16 v[28:31], a[72:75], a[8:11], v[28:31]
  v_mfma_f32_16x16x32_bf16 v[28:31], a[76:79], a[12:15], v[28:31]
  ds_read_b128 a[100:103], v4 offset:13312
  v_mfma_f32_16x16x32_bf16 v[44:47], a[64:67], a[16:19], v[76:79]
  v_mfma_f32_16x16x32_bf16 v[44:47], a[68:71], a[20:23], v[44:47]
  ds_read_b128 a[104:107], v4 offset:14336
  v_mfma_f32_16x16x32_bf16 v[44:47], a[72:75], a[24:27], v[44:47]
  v_mfma_f32_16x16x32_bf16 v[44:47], a[76:79], a[28:31], v[44:47]
  ds_read_b128 a[108:111], v4 offset:15360
  s_waitcnt lgkmcnt(4)
  v_mfma_f32_16x16x32_bf16 v[32:35], a[80:83], a[0:3], v[72:75]
  v_mfma_f32_16x16x32_bf16 v[32:35], a[84:87], a[4:7], v[32:35]
  v_mfma_f32_16x16x32_bf16 v[32:35], a[88:91], a[8:11], v[32:35]
  v_mfma_f32_16x16x32_bf16 v[32:35], a[92:95], a[12:15], v[32:35]
  v_mfma_f32_16x16x32_bf16 v[48:51], a[80:83], a[16:19], v[76:79]
  v_mfma_f32_16x16x32_bf16 v[48:51], a[84:87], a[20:23], v[48:51]
  v_mfma_f32_16x16x32_bf16 v[48:51], a[88:91], a[24:27], v[48:51]
  v_mfma_f32_16x16x32_bf16 v[48:51], a[92:95], a[28:31], v[48:51]
  s_waitcnt lgkmcnt(0)
  v_mfma_f32_16x16x32_bf16 v[36:39], a[96:99], a[0:3], v[72:75]
  v_mfma_f32_16x16x32_bf16 v[36:39], a[100:103], a[4:7], v[36:39]
  v_mfma_f32_16x16x32_bf16 v[36:39], a[104:107], a[8:11], v[36:39]
  v_mfma_f32_16x16x32_bf16 v[36:39], a[108:111], a[12:15], v[36:39]
  v_mfma_f32_16x16x32_bf16 v[52:55], a[96:99], a[16:19], v[76:79]
  v_mfma_f32_16x16x32_bf16 v[52:55], a[100:103], a[20:23], v[52:55]
  v_mfma_f32_16x16x32_bf16 v[52:55], a[104:107], a[24:27], v[52:55]
  v_mfma_f32_16x16x32_bf16 v[52:55], a[108:111], a[28:31], v[52:55]
  s_setprio 0
  v_exp_f32 v12, v24
  v_exp_f32 v13, v25
  s_mov_b32 m0, s58
  s_add_u32 s58, s58, 0x8000
  buffer_load_dwordx4 v2, s[4:7], s37 offen sc1 lds
  buffer_load_dwordx4 v2, s[4:7], s37 offen offset:1024 sc1 lds
  s_and_b32 s58, s58, 0x1ffff
  s_add_u32 s37, s37, 16384
  v_exp_f32 v14, v26
  v_exp_f32 v15, v27
  v_exp_f32 v16, v40
  v_exp_f32 v17, v41
  v_add_f32 v8, v12, v13
  s_mov_b32 m0, s59
  s_add_u32 s59, s59, 0x8000
  buffer_load_dwordx4 v2, s[4:7], s38 offen sc1 lds
  buffer_load_dwordx4 v2, s[4:7], s38 offen offset:1024 sc1 lds
  s_and_b32 s59, s59, 0x1ffff
  s_add_u32 s38, s38, 16384
  v_exp_f32 v18, v42
  v_exp_f32 v19, v43
  v_add_f32 v8, v8, v14
  v_add_f32 v8, v8, v15
  v_cvt_pk_bf16_f32 v56, v12, v13
  v_cvt_pk_bf16_f32 v57, v14, v15
  v_exp_f32 v12, v28
  v_exp_f32 v13, v29
  v_add_f32 v10, v16, v17
  s_cmp_eq_u32 s43, 0x8000
  s_cbranch_scc1 F1A_D11
  s_mov_b32 m0, s58
  s_add_u32 s58, s58, 0x8000
  buffer_load_dwordx4 v2, s[4:7], s37 offen sc1 lds
  buffer_load_dwordx4 v2, s[4:7], s37 offen offset:1024 sc1 lds
  s_and_b32 s58, s58, 0x1ffff
  s_add_u32 s37, s37, 16384
F1A_D11:
  v_exp_f32 v14, v30
  v_exp_f32 v15, v31
  v_add_f32 v10, v10, v18
  v_add_f32 v10, v10, v19
  v_cvt_pk_bf16_f32 v64, v16, v17
  v_cvt_pk_bf16_f32 v65, v18, v19
  v_exp_f32 v16, v44
  v_exp_f32 v17, v45
  v_add_f32 v8, v8, v12
  v_add_f32 v8, v8, v13
  s_cmp_eq_u32 s43, 0x8000
  s_cbranch_scc1 F1A_D12
  s_mov_b32 m0, s59
  s_add_u32 s59, s59, 0x8000
  buffer_load_dwordx4 v2, s[4:7], s38 offen sc1 lds
  buffer_load_dwordx4 v2, s[4:7], s38 offen offset:1024 sc1 lds
  s_and_b32 s59, s59, 0x1ffff
  s_add_u32 s38, s38, 16384
F1A_D12:
  v_exp_f32 v18, v46
  v_exp_f32 v19, v47
  v_add_f32 v8, v8, v14
  v_add_f32 v8, v8, v15
  v_cvt_pk_bf16_f32 v58, v12, v13
  v_cvt_pk_bf16_f32 v59, v14, v15
  v_exp_f32 v12, v32
  v_exp_f32 v13, v33
  v_add_f32 v10, v10, v16
  v_add_f32 v10, v10, v17
  v_exp_f32 v14, v34
  v_exp_f32 v15, v35
  v_add_f32 v10, v10, v18
  v_add_f32 v10, v10, v19
  v_cvt_pk_bf16_f32 v66, v16, v17
  v_cvt_pk_bf16_f32 v67, v18, v19
  v_exp_f32 v16, v48
  v_exp_f32 v17, v49
  v_add_f32 v8, v8, v12
  v_add_f32 v8, v8, v13
  v_exp_f32 v18, v50
  v_exp_f32 v19, v51
  v_add_f32 v8, v8, v14
  v_add_f32 v8, v8, v15
  v_cvt_pk_bf16_f32 v60, v12, v13
  v_cvt_pk_bf16_f32 v61, v14, v15
  v_exp_f32 v12, v36
  v_exp_f32 v13, v37
  v_add_f32 v10, v10, v16
  v_add_f32 v10, v10, v17
  v_exp_f32 v14, v38
  v_exp_f32 v15, v39
  v_add_f32 v10, v10, v18
  v_add_f32 v10, v10, v19
  v_cvt_pk_bf16_f32 v68, v16, v17
  v_cvt_pk_bf16_f32 v69, v18, v19
  v_exp_f32 v16, v52
  v_exp_f32 v17, v53
  v_add_f32 v8, v8, v12
  v_add_f32 v8, v8, v13
  v_exp_f32 v18, v54
  v_exp_f32 v19, v55
  v_add_f32 v8, v8, v14
  v_add_f32 v8, v8, v15
  v_cvt_pk_bf16_f32 v62, v12, v13
  v_cvt_pk_bf16_f32 v63, v14, v15
  v_add_f32 v10, v10, v16
  v_add_f32 v10, v10, v17
  v_cvt_pk_bf16_f32 v70, v16, v17
  v_add_f32 v10, v10, v18
  v_add_f32 v10, v10, v19
  v_cvt_pk_bf16_f32 v71, v18, v19
  v_add_f32 v20, v8, v10
  v_cmp_nge_f32 vcc, s44, v20
  s_cbranch_vccnz F1A_FIX_g1f
F1A_FIXRET_g1f:
  v_add_f32 v5, v5, v8
  v_add_f32 v6, v6, v10
  buffer_load_dword v23, v22, s[16:19], s96 offen sc1
  s_add_u32 s96, s96, s94
  buffer_load_dword v23, v0, s[20:23], s97 offen sc1
  buffer_load_dword v23, v0, s[24:27], s97 offen sc1
  s_add_u32 s97, s97, s95
  s_add_u32 s31, s31, 1
  v_mov_b32 v3, v4
  v_add_u32 v4, s43, v4
  v_and_b32 v4, 0x1ffff, v4
  s_lshr_b32 s34, s43, 15
  s_add_u32 s35, s35, s34
  s_bitcmp1_b32 s36, s31
  s_waitcnt vmcnt(3)
  s_barrier
  s_cbranch_scc0 F1A_G1_F
F1A_G1_S:
  s_setprio 2
  s_lshl_b32 s34, s35, 6
  s_cmp_gt_u32 s34, s33
  s_cbranch_scc1 F1A_G1_SKIP
  ds_read_b128 a[48:51], v3 offset:16384
  ds_read_b128 a[52:55], v3 offset:24576
  ds_read_b128 a[56:59], v3 offset:17408
  ds_read_b128 a[60:63], v3 offset:25600
  ds_read_b128 a[64:67], v3 offset:18432
  ds_read_b128 a[68:71], v3 offset:26624
  ds_read_b128 a[72:75], v3 offset:19456
  ds_read_b128 a[76:79], v3 offset:27648
  s_waitcnt lgkmcnt(6)
  v_mfma_f32_16x16x32_bf16 v[80:83], a[48:51], v[56:59], v[80:83]
  v_mfma_f32_16x16x32_bf16 v[80:83], a[52:55], v[60:63], v[80:83]
  ds_read_b128 a[80:83], v3 offset:20480
  v_mfma_f32_16x16x32_bf16 v[96:99], a[48:51], v[64:67], v[96:99]
  v_mfma_f32_16x16x32_bf16 v[96:99], a[52:55], v[68:71], v[96:99]
  ds_read_b128 a[84:87], v3 offset:28672
  s_waitcnt lgkmcnt(6)
  v_mfma_f32_16x16x32_bf16 v[84:87], a[56:59], v[56:59], v[84:87]
  v_mfma_f32_16x16x32_bf16 v[84:87], a[60:63], v[60:63], v[84:87]
  ds_read_b128 a[88:91], v3 offset:21504
  v_mfma_f32_16x16x32_bf16 v[100:103], a[56:59], v[64:67], v[100:103]
  v_mfma_f32_16x16x32_bf16 v[100:103], a[60:63], v[68:71], v[100:103]
  ds_read_b128 a[92:95], v3 offset:29696
  s_waitcnt lgkmcnt(6)
  v_mfma_f32_16x16x32_bf16 v[88:91], a[64:67], v[56:59], v[88:91]
  v_mfma_f32_16x16x32_bf16 v[88:91], a[68:71], v[60:63], v[88:91]
  ds_read_b128 a[96:99], v3 offset:22528
  v_mfma_f32_16x16x32_bf16 v[104:107], a[64:67], v[64:67], v[104:107]
  v_mfma_f32_16x16x32_bf16 v[104:107], a[68:71], v[68:71], v[104:107]
  ds_read_b128 a[100:103], v3 offset:30720
  s_waitcnt lgkmcnt(6)
  v_mfma_f32_16x16x32_bf16 v[92:95], a[72:75], v[56:59], v[92:95]
  v_mfma_f32_16x16x32_bf16 v[92:95], a[76:79], v[60:63], v[92:95]
  ds_read_b128 a[104:107], v3 offset:23552
  v_mfma_f32_16x16x32_bf16 v[108:111], a[72:75], v[64:67], v[108:111]
  v_mfma_f32_16x16x32_bf16 v[108:111], a[76:79], v[68:71], v[108:111]
  ds_read_b128 a[108:111], v3 offset:31744
  s_waitcnt lgkmcnt(6)
  v_mfma_f32_16x16x32_bf16 v[112:115], a[80:83], v[56:59], v[112:115]
  v_mfma_f32_16x16x32_bf16 v[112:115], a[84:87], v[60:63], v[112:115]
  ds_read_b128 a[48:51], v4 offset:0
  v_mfma_f32_16x16x32_bf16 v[128:131], a[80:83], v[64:67], v[128:131]
  v_mfma_f32_16x16x32_bf16 v[128:131], a[84:87], v[68:71], v[128:131]
  ds_read_b128 a[52:55], v4 offset:1024
  s_waitcnt lgkmcnt(6)
  v_mfma_f32_16x16x32_bf16 v[116:119], a[88:91], v[56:59], v[116:119]
  v_mfma_f32_16x16x32_bf16 v[116:119], a[92:95], v[60:63], v[116:119]
  ds_read_b128 a[56:59], v4 offset:2048
  v_mfma_f32_16x16x32_bf16 v[132:135], a[88:91], v[64:67], v[132:135]
  v_mfma_f32_16x16x32_bf16 v[132:135], a[92:95], v[68:71], v[132:135]
  ds_read_b128 a[60:63], v4 offset:3072
  s_waitcnt lgkmcnt(6)
  v_mfma_f32_16x16x32_bf16 v[120:123], a[96:99], v[56:59], v[120:123]
  v_mfma_f32_16x16x32_bf16 v[120:123], a[100:103], v[60:63], v[120:123]
  ds_read_b128 a[64:67], v4 offset:4096
  v_mfma_f32_16x16x32_bf16 v[136:139], a[96:99], v[64:67], v[136:139]
  v_mfma_f32_16x16x32_bf16 v[136:139], a[100:103], v[68:71], v[136:139]
  ds_read_b128 a[68:71], v4 offset:5120
  s_waitcnt lgkmcnt(6)
  v_mfma_f32_16x16x32_bf16 v[124:127], a[104:107], v[56:59], v[124:127]
  v_mfma_f32_16x16x32_bf16 v[124:127], a[108:111], v[60:63], v[124:127]
  ds_read_b128 a[72:75], v4 offset:6144
  v_mfma_f32_16x16x32_bf16 v[140:143], a[104:107], v[64:67], v[140:143]
  v_mfma_f32_16x16x32_bf16 v[140:143], a[108:111], v[68:71], v[140:143]
  ds_read_b128 a[76:79], v4 offset:7168
  s_waitcnt lgkmcnt(4)
  v_mfma_f32_16x16x32_bf16 v[24:27], a[48:51], a[0:3], v[72:75]
  v_mfma_f32_16x16x32_bf16 v[24:27], a[52:55], a[4:7], v[24:27]
  ds_read_b128 a[80:83], v4 offset:8192
  v_mfma_f32_16x16x32_bf16 v[24:27], a[56:59], a[8:11], v[24:27]
  v_mfma_f32_16x16x32_bf16 v[24:27], a[60:63], a[12:15], v[24:27]
  ds_read_b128 a[84:87], v4 offset:9216
  v_mfma_f32_16x16x32_bf16 v[40:43], a[48:51], a[16:19], v[76:79]
  v_mfma_f32_16x16x32_bf16 v[40:43], a[52:55], a[20:23], v[40:43]
  ds_read_b128 a[88:91], v4 offset:10240
  v_mfma_f32_16x16x32_bf16 v[40:43], a[56:59], a[24:27], v[40:43]
  v_mfma_f32_16x16x32_bf16 v[40:43], a[60:63], a[28:31], v[40:43]
  ds_read_b128 a[92:95], v4 offset:11264
  s_waitcnt lgkmcnt(4)
  v_mfma_f32_16x16x32_bf16 v[28:31], a[64:67], a[0:3], v[72:75]
  v_mfma_f32_16x16x32_bf16 v[28:31], a[68:71], a[4:7], v[28:31]
  ds_read_b128 a[96:99], v4 offset:12288
  v_mfma_f32_16x16x32_bf16 v[28:31], a[72:75], a[8:11], v[28:31]
  v_mfma_f32_16x16x32_bf16 v[28:31], a[76:79], a[12:15], v[28:31]
  ds_read_b128 a[100:103], v4 offset:13312
  v_mfma_f32_16x16x32_bf16 v[44:47], a[64:67], a[16:19], v[76:79]
  v_mfma_f32_16x16x32_bf16 v[44:47], a[68:71], a[20:23], v[44:47]
  ds_read_b128 a[104:107], v4 offset:14336
  v_mfma_f32_16x16x32_bf16 v[44:47], a[72:75], a[24:27], v[44:47]
  v_mfma_f32_16x16x32_bf16 v[44:47], a[76:79], a[28:31], v[44:47]
  ds_read_b128 a[108:111], v4 offset:15360
  s_waitcnt lgkmcnt(4)
  v_mfma_f32_16x16x32_bf16 v[32:35], a[80:83], a[0:3], v[72:75]
  v_mfma_f32_16x16x32_bf16 v[32:35], a[84:87], a[4:7], v[32:35]
  v_mfma_f32_16x16x32_bf16 v[32:35], a[88:91], a[8:11], v[32:35]
  v_mfma_f32_16x16x32_bf16 v[32:35], a[92:95], a[12:15], v[32:35]
  v_mfma_f32_16x16x32_bf16 v[48:51], a[80:83], a[16:19], v[76:79]
  v_mfma_f32_16x16x32_bf16 v[48:51], a[84:87], a[20:23], v[48:51]
  v_mfma_f32_16x16x32_bf16 v[48:51], a[88:91], a[24:27], v[48:51]
  v_mfma_f32_16x16x32_bf16 v[48:51], a[92:95], a[28:31], v[48:51]
  s_waitcnt lgkmcnt(0)
  v_mfma_f32_16x16x32_bf16 v[36:39], a[96:99], a[0:3], v[72:75]
  v_mfma_f32_16x16x32_bf16 v[36:39], a[100:103], a[4:7], v[36:39]
  v_mfma_f32_16x16x32_bf16 v[36:39], a[104:107], a[8:11], v[36:39]
  v_mfma_f32_16x16x32_bf16 v[36:39], a[108:111], a[12:15], v[36:39]
  v_mfma_f32_16x16x32_bf16 v[52:55], a[96:99], a[16:19], v[76:79]
  v_mfma_f32_16x16x32_bf16 v[52:55], a[100:103], a[20:23], v[52:55]
  v_mfma_f32_16x16x32_bf16 v[52:55], a[104:107], a[24:27], v[52:55]
  v_mfma_f32_16x16x32_bf16 v[52:55], a[108:111], a[28:31], v[52:55]
F1A_G1_V:
  s_setprio 0
  s_lshl_b32 s34, s35, 6
  s_add_u32 s34, s34, 63
  s_cmp_gt_u32 s34, s33
  s_cbranch_scc1 F1A_MASK_g1s
F1A_MASKRET_g1s:
  v_exp_f32 v12, v24
  v_exp_f32 v13, v25
  s_cmp_gt_u32 s37, s56
  s_cbranch_scc1 F1A_D13
  s_mov_b32 m0, s58
  s_add_u32 s58, s58, 0x8000
  buffer_load_dwordx4 v2, s[4:7], s37 offen sc1 lds
  buffer_load_dwordx4 v2, s[4:7], s37 offen offset:1024 sc1 lds
  s_and_b32 s58, s58, 0x1ffff
  s_add_u32 s37, s37, 16384
F1A_D13:
  v_exp_f32 v14, v26
  v_exp_f32 v15, v27
  v_exp_f32 v16, v40
  v_exp_f32 v17, v41
  v_add_f32 v8, v12, v13
  s_cmp_gt_u32 s38, s57
  s_cbranch_scc1 F1A_D14
  s_mov_b32 m0, s59
  s_add_u32 s59, s59, 0x8000
  buffer_load_dwordx4 v2, s[4:7], s38 offen sc1 lds
  buffer_load_dwordx4 v2, s[4:7], s38 offen offset:1024 sc1 lds
  s_and_b32 s59, s59, 0x1ffff
  s_add_u32 s38, s38, 16384
F1A_D14:
  v_exp_f32 v18, v42
  v_exp_f32 v19, v43
  v_add_f32 v8, v8, v14
  v_add_f32 v8, v8, v15
  v_cvt_pk_bf16_f32 v56, v12, v13
  v_cvt_pk_bf16_f32 v57, v14, v15
  v_exp_f32 v12, v28
  v_exp_f32 v13, v29
  v_add_f32 v10, v16, v17
  s_cmp_gt_u32 s37, s56
  s_cbranch_scc1 F1A_D15
  s_add_u32 s47, s31, 1
  s_cmp_lt_u32 s47, s32
  s_cbranch_scc1 F1A_D15
  s_mov_b32 m0, s58
  s_add_u32 s58, s58, 0x8000
  buffer_load_dwordx4 v2, s[4:7], s37 offen sc1 lds
  buffer_load_dwordx4 v2, s[4:7], s37 offen offset:1024 sc1 lds
  s_and_b32 s58, s58, 0x1ffff
  s_add_u32 s37, s37, 16384
F1A_D15:
  v_exp_f32 v14, v30
  v_exp_f32 v15, v31
  v_add_f32 v10, v10, v18
  v_add_f32 v10, v10, v19
  v_cvt_pk_bf16_f32 v64, v16, v17
  v_cvt_pk_bf16_f32 v65, v18, v19
  v_exp_f32 v16, v44
  v_exp_f32 v17, v45
  v_add_f32 v8, v8, v12
  v_add_f32 v8, v8, v13
  s_cmp_gt_u32 s38, s57
  s_cbranch_scc1 F1A_D16
  s_cmp_lt_u32 s31, s32
  s_cbranch_scc1 F1A_D16
  s_mov_b32 m0, s59
  s_add_u32 s59, s59, 0x8000
  buffer_load_dwordx4 v2, s[4:7], s38 offen sc1 lds
  buffer_load_dwordx4 v2, s[4:7], s38 offen offset:1024 sc1 lds
  s_and_b32 s59, s59, 0x1ffff
  s_add_u32 s38, s38, 16384
F1A_D16:
  v_exp_f32 v18, v46
  v_exp_f32 v19, v47
  v_add_f32 v8, v8, v14
  v_add_f32 v8, v8, v15
  v_cvt_pk_bf16_f32 v58, v12, v13
  v_cvt_pk_bf16_f32 v59, v14, v15
  v_exp_f32 v12, v32
  v_exp_f32 v13, v33
  v_add_f32 v10, v10, v16
  v_add_f32 v10, v10, v17
  v_exp_f32 v14, v34
  v_exp_f32 v15, v35
  v_add_f32 v10, v10, v18
  v_add_f32 v10, v10, v19
  v_cvt_pk_bf16_f32 v66, v16, v17
  v_cvt_pk_bf16_f32 v67, v18, v19
  v_exp_f32 v16, v48
  v_exp_f32 v17, v49
  v_add_f32 v8, v8, v12
  v_add_f32 v8, v8, v13
  v_exp_f32 v18, v50
  v_exp_f32 v19, v51
  v_add_f32 v8, v8, v14
  v_add_f32 v8, v8, v15
  v_cvt_pk_bf16_f32 v60, v12, v13
  v_cvt_pk_bf16_f32 v61, v14, v15
  v_exp_f32 v12, v36
  v_exp_f32 v13, v37
  v_add_f32 v10, v10, v16
  v_add_f32 v10, v10, v17
  v_exp_f32 v14, v38
  v_exp_f32 v15, v39
  v_add_f32 v10, v10, v18
  v_add_f32 v10, v10, v19
  v_cvt_pk_bf16_f32 v68, v16, v17
  v_cvt_pk_bf16_f32 v69, v18, v19
  v_exp_f32 v16, v52
  v_exp_f32 v17, v53
  v_add_f32 v8, v8, v12
  v_add_f32 v8, v8, v13
  v_exp_f32 v18, v54
  v_exp_f32 v19, v55
  v_add_f32 v8, v8, v14
  v_add_f32 v8, v8, v15
  v_cvt_pk_bf16_f32 v62, v12, v13
  v_cvt_pk_bf16_f32 v63, v14, v15
  v_add_f32 v10, v10, v16
  v_add_f32 v10, v10, v17
  v_cvt_pk_bf16_f32 v70, v16, v17
  v_add_f32 v10, v10, v18
  v_add_f32 v10, v10, v19
  v_cvt_pk_bf16_f32 v71, v18, v19
  v_add_f32 v20, v8, v10
  v_cmp_nge_f32 vcc, s44, v20
  s_cbranch_vccnz F1A_FIX_g1s
  s_cmp_lg_u32 s42, 0
  s_cbranch_scc1 F1A_INIT_g1s
F1A_FIXRET_g1s:
  v_add_f32 v5, v5, v8
  v_add_f32 v6, v6, v10
  s_add_u32 s31, s31, 1
  s_cmp_ge_u32 s31, s32
  s_cselect_b32 s43, 2, 1
  s_lshl_b32 s43, s43, 15
  v_mov_b32 v3, v4
  v_add_u32 v4, s43, v4
  v_and_b32 v4, 0x1ffff, v4
  s_lshr_b32 s34, s43, 15
  s_add_u32 s35, s35, s34
  s_bitcmp1_b32 s36, s31
  s_waitcnt vmcnt(0)
  s_barrier
  s_cbranch_scc1 F1A_G1_S
  s_cmp_lt_u32 s31, 17
  s_cbranch_scc1 F1A_G1_F
  ds_read_b128 a[48:51], v3 offset:16384
  ds_read_b128 a[52:55], v3 offset:24576
  ds_read_b128 a[56:59], v3 offset:17408
  ds_read_b128 a[60:63], v3 offset:25600
  ds_read_b128 a[64:67], v3 offset:18432
  ds_read_b128 a[68:71], v3 offset:26624
  ds_read_b128 a[72:75], v3 offset:19456
  ds_read_b128 a[76:79], v3 offset:27648
  s_waitcnt lgkmcnt(6)
  v_mfma_f32_16x16x32_bf16 v[80:83], a[48:51], v[56:59], v[80:83]
  v_mfma_f32_16x16x32_bf16 v[80:83], a[52:55], v[60:63], v[80:83]
  ds_read_b128 a[80:83], v3 offset:20480
  v_mfma_f32_16x16x32_bf16 v[96:99], a[48:51], v[64:67], v[96:99]
  v_mfma_f32_16x16x32_bf16 v[96:99], a[52:55], v[68:71], v[96:99]
  ds_read_b128 a[84:87], v3 offset:28672
  s_waitcnt lgkmcnt(6)
  v_mfma_f32_16x16x32_bf16 v[84:87], a[56:59], v[56:59], v[84:87]
  v_mfma_f32_16x16x32_bf16 v[84:87], a[60:63], v[60:63], v[84:87]
  ds_read_b128 a[88:91], v3 offset:21504
  v_mfma_f32_16x16x32_bf16 v[100:103], a[56:59], v[64:67], v[100:103]
  v_mfma_f32_16x16x32_bf16 v[100:103], a[60:63], v[68:71], v[100:103]
  ds_read_b128 a[92:95], v3 offset:29696
  s_waitcnt lgkmcnt(6)
  v_mfma_f32_16x16x32_bf16 v[88:91], a[64:67], v[56:59], v[88:91]
  v_mfma_f32_16x16x32_bf16 v[88:91], a[68:71], v[60:63], v[88:91]
  ds_read_b128 a[96:99], v3 offset:22528
  v_mfma_f32_16x16x32_bf16 v[104:107], a[64:67], v[64:67], v[104:107]
  v_mfma_f32_16x16x32_bf16 v[104:107], a[68:71], v[68:71], v[104:107]
  ds_read_b128 a[100:103], v3 offset:30720
  s_waitcnt lgkmcnt(6)
  v_mfma_f32_16x16x32_bf16 v[92:95], a[72:75], v[56:59], v[92:95]
  v_mfma_f32_16x16x32_bf16 v[92:95], a[76:79], v[60:63], v[92:95]
  ds_read_b128 a[104:107], v3 offset:23552
  v_mfma_f32_16x16x32_bf16 v[108:111], a[72:75], v[64:67], v[108:111]
  v_mfma_f32_16x16x32_bf16 v[108:111], a[76:79], v[68:71], v[108:111]
  ds_read_b128 a[108:111], v3 offset:31744
  s_waitcnt lgkmcnt(6)
  v_mfma_f32_16x16x32_bf16 v[112:115], a[80:83], v[56:59], v[112:115]
  v_mfma_f32_16x16x32_bf16 v[112:115], a[84:87], v[60:63], v[112:115]
  v_mfma_f32_16x16x32_bf16 v[128:131], a[80:83], v[64:67], v[128:131]
  v_mfma_f32_16x16x32_bf16 v[128:131], a[84:87], v[68:71], v[128:131]
  s_waitcnt lgkmcnt(4)
  v_mfma_f32_16x16x32_bf16 v[116:119], a[88:91], v[56:59], v[116:119]
  v_mfma_f32_16x16x32_bf16 v[116:119], a[92:95], v[60:63], v[116:119]
  v_mfma_f32_16x16x32_bf16 v[132:135], a[88:91], v[64:67], v[132:135]
  v_mfma_f32_16x16x32_bf16 v[132:135], a[92:95], v[68:71], v[132:135]
  s_waitcnt lgkmcnt(2)
  v_mfma_f32_16x16x32_bf16 v[120:123], a[96:99], v[56:59], v[120:123]
  v_mfma_f32_16x16x32_bf16 v[120:123], a[100:103], v[60:63], v[120:123]
  v_mfma_f32_16x16x32_bf16 v[136:139], a[96:99], v[64:67], v[136:139]
  v_mfma_f32_16x16x32_bf16 v[136:139], a[100:103], v[68:71], v[136:139]
  s_waitcnt lgkmcnt(0)
  v_mfma_f32_16x16x32_bf16 v[124:127], a[104:107], v[56:59], v[124:127]
  v_mfma_f32_16x16x32_bf16 v[124:127], a[108:111], v[60:63], v[124:127]
  v_mfma_f32_16x16x32_bf16 v[140:143], a[104:107], v[64:67], v[140:143]
  v_mfma_f32_16x16x32_bf16 v[140:143], a[108:111], v[68:71], v[140:143]
  s_branch F1A_MERGE
F1A_G1_SKIP:
  ds_read_b128 a[48:51], v3 offset:16384
  ds_read_b128 a[52:55], v3 offset:24576
  ds_read_b128 a[56:59], v3 offset:17408
  ds_read_b128 a[60:63], v3 offset:25600
  ds_read_b128 a[64:67], v3 offset:18432
  ds_read_b128 a[68:71], v3 offset:26624
  ds_read_b128 a[72:75], v3 offset:19456
  ds_read_b128 a[76:79], v3 offset:27648
  s_waitcnt lgkmcnt(6)
  v_mfma_f32_16x16x32_bf16 v[80:83], a[48:51], v[56:59], v[80:83]
  v_mfma_f32_16x16x32_bf16 v[80:83], a[52:55], v[60:63], v[80:83]
  ds_read_b128 a[80:83], v3 offset:20480
  v_mfma_f32_16x16x32_bf16 v[96:99], a[48:51], v[64:67], v[96:99]
  v_mfma_f32_16x16x32_bf16 v[96:99], a[52:55], v[68:71], v[96:99]
  ds_read_b128 a[84:87], v3 offset:28672
  s_waitcnt lgkmcnt(6)
  v_mfma_f32_16x16x32_bf16 v[84:87], a[56:59], v[56:59], v[84:87]
  v_mfma_f32_16x16x32_bf16 v[84:87], a[60:63], v[60:63], v[84:87]
  ds_read_b128 a[88:91], v3 offset:21504
  v_mfma_f32_16x16x32_bf16 v[100:103], a[56:59], v[64:67], v[100:103]
  v_mfma_f32_16x16x32_bf16 v[100:103], a[60:63], v[68:71], v[100:103]
  ds_read_b128 a[92:95], v3 offset:29696
  s_waitcnt lgkmcnt(6)
  v_mfma_f32_16x16x32_bf16 v[88:91], a[64:67], v[56:59], v[88:91]
  v_mfma_f32_16x16x32_bf16 v[88:91], a[68:71], v[60:63], v[88:91]
  ds_read_b128 a[96:99], v3 offset:22528
  v_mfma_f32_16x16x32_bf16 v[104:107], a[64:67], v[64:67], v[104:107]
  v_mfma_f32_16x16x32_bf16 v[104:107], a[68:71], v[68:71], v[104:107]
  ds_read_b128 a[100:103], v3 offset:30720
  s_waitcnt lgkmcnt(6)
  v_mfma_f32_16x16x32_bf16 v[92:95], a[72:75], v[56:59], v[92:95]
  v_mfma_f32_16x16x32_bf16 v[92:95], a[76:79], v[60:63], v[92:95]
  ds_read_b128 a[104:107], v3 offset:23552
  v_mfma_f32_16x16x32_bf16 v[108:111], a[72:75], v[64:67], v[108:111]
  v_mfma_f32_16x16x32_bf16 v[108:111], a[76:79], v[68:71], v[108:111]
  ds_read_b128 a[108:111], v3 offset:31744
  s_waitcnt lgkmcnt(6)
  v_mfma_f32_16x16x32_bf16 v[112:115], a[80:83], v[56:59], v[112:115]
  v_mfma_f32_16x16x32_bf16 v[112:115], a[84:87], v[60:63], v[112:115]
  v_mfma_f32_16x16x32_bf16 v[128:131], a[80:83], v[64:67], v[128:131]
  v_mfma_f32_16x16x32_bf16 v[128:131], a[84:87], v[68:71], v[128:131]
  s_waitcnt lgkmcnt(4)
  v_mfma_f32_16x16x32_bf16 v[116:119], a[88:91], v[56:59], v[116:119]
  v_mfma_f32_16x16x32_bf16 v[116:119], a[92:95], v[60:63], v[116:119]
  v_mfma_f32_16x16x32_bf16 v[132:135], a[88:91], v[64:67], v[132:135]
  v_mfma_f32_16x16x32_bf16 v[132:135], a[92:95], v[68:71], v[132:135]
  s_waitcnt lgkmcnt(2)
  v_mfma_f32_16x16x32_bf16 v[120:123], a[96:99], v[56:59], v[120:123]
  v_mfma_f32_16x16x32_bf16 v[120:123], a[100:103], v[60:63], v[120:123]
  v_mfma_f32_16x16x32_bf16 v[136:139], a[96:99], v[64:67], v[136:139]
  v_mfma_f32_16x16x32_bf16 v[136:139], a[100:103], v[68:71], v[136:139]
  s_waitcnt lgkmcnt(0)
  v_mfma_f32_16x16x32_bf16 v[124:127], a[104:107], v[56:59], v[124:127]
  v_mfma_f32_16x16x32_bf16 v[124:127], a[108:111], v[60:63], v[124:127]
  v_mfma_f32_16x16x32_bf16 v[140:143], a[104:107], v[64:67], v[140:143]
  v_mfma_f32_16x16x32_bf16 v[140:143], a[108:111], v[68:71], v[140:143]
  s_setprio 0
  s_cmp_gt_u32 s37, s56
  s_cbranch_scc1 F1A_D17
  s_mov_b32 m0, s58
  s_add_u32 s58, s58, 0x8000
  buffer_load_dwordx4 v2, s[4:7], s37 offen sc1 lds
  buffer_load_dwordx4 v2, s[4:7], s37 offen offset:1024 sc1 lds
  s_and_b32 s58, s58, 0x1ffff
  s_add_u32 s37, s37, 16384
F1A_D17:
  s_cmp_gt_u32 s38, s57
  s_cbranch_scc1 F1A_D18
  s_mov_b32 m0, s59
  s_add_u32 s59, s59, 0x8000
  buffer_load_dwordx4 v2, s[4:7], s38 offen sc1 lds
  buffer_load_dwordx4 v2, s[4:7], s38 offen offset:1024 sc1 lds
  s_and_b32 s59, s59, 0x1ffff
  s_add_u32 s38, s38, 16384
F1A_D18:
  s_cmp_gt_u32 s37, s56
  s_cbranch_scc1 F1A_D19
  s_add_u32 s47, s31, 1
  s_cmp_lt_u32 s47, s32
  s_cbranch_scc1 F1A_D19
  s_mov_b32 m0, s58
  s_add_u32 s58, s58, 0x8000
  buffer_load_dwordx4 v2, s[4:7], s37 offen sc1 lds
  buffer_load_dwordx4 v2, s[4:7], s37 offen offset:1024 sc1 lds
  s_and_b32 s58, s58, 0x1ffff
  s_add_u32 s37, s37, 16384
F1A_D19:
  s_cmp_gt_u32 s38, s57
  s_cbranch_scc1 F1A_D20
  s_cmp_lt_u32 s31, s32
  s_cbranch_scc1 F1A_D20
  s_mov_b32 m0, s59
  s_add_u32 s59, s59, 0x8000
  buffer_load_dwordx4 v2, s[4:7], s38 offen sc1 lds
  buffer_load_dwordx4 v2, s[4:7], s38 offen offset:1024 sc1 lds
  s_and_b32 s59, s59, 0x1ffff
  s_add_u32 s38, s38, 16384
F1A_D20:
  s_waitcnt vmcnt(0)
  s_barrier
  s_branch F1A_MERGE
F1A_INIT_g1s:
  v_mov_b32 v20, v8
  v_mov_b32 v12, v20
  v_mov_b32 v13, v20
  s_nop 1
  v_permlane32_swap_b32 v12, v13
  s_nop 1
  v_add_f32 v20, v12, v13
  v_mov_b32 v12, v20
  v_mov_b32 v13, v20
  s_nop 1
  v_permlane16_swap_b32 v12, v13
  s_nop 1
  v_add_f32 v20, v12, v13
  v_mov_b32 v21, v10
  v_mov_b32 v12, v21
  v_mov_b32 v13, v21
  s_nop 1
  v_permlane32_swap_b32 v12, v13
  s_nop 1
  v_add_f32 v21, v12, v13
  v_mov_b32 v12, v21
  v_mov_b32 v13, v21
  s_nop 1
  v_permlane16_swap_b32 v12, v13
  s_nop 1
  v_add_f32 v21, v12, v13
  v_min_f32 v20, v20, v21
  v_cmp_nle_f32 vcc, 0x35800000, v20
  s_cbranch_vccnz F1A_FIX_g1s
  s_mov_b32 s42, 0
  s_branch F1A_FIXRET_g1s
F1A_MASK_g1s:
  s_lshl_b32 s34, s35, 6
  s_sub_u32 s34, s33, s34
  v_and_b32 v7, 15, v1
  v_lshrrev_b32 v12, 4, v1
  v_lshlrev_b32 v12, 2, v12
  v_sub_u32 v7, v7, v12
  v_mov_b32 v12, 0xff800000
  v_cmp_gt_i32 s[60:61], 0, v7
  v_cmp_gt_i32 s[62:63], 1, v7
  v_cmp_gt_i32 s[52:53], 2, v7
  v_cmp_gt_i32 vcc, 3, v7
  s_cmp_eq_u32 s34, 32
  s_cbranch_scc1 F1A_MASK32_g1s
  v_mov_b32 v32, v12
  v_mov_b32 v33, v12
  v_mov_b32 v34, v12
  v_mov_b32 v35, v12
  v_mov_b32 v48, v12
  v_mov_b32 v49, v12
  v_mov_b32 v50, v12
  v_mov_b32 v51, v12
  v_mov_b32 v36, v12
  v_mov_b32 v37, v12
  v_mov_b32 v38, v12
  v_mov_b32 v39, v12
  v_mov_b32 v52, v12
  v_mov_b32 v53, v12
  v_mov_b32 v54, v12
  v_mov_b32 v55, v12
  v_mov_b32 v28, v12
  v_mov_b32 v29, v12
  v_mov_b32 v30, v12
  v_mov_b32 v31, v12
  s_cmp_eq_u32 s34, 0
  s_cbranch_scc1 F1A_MASK0_g1s
  v_mov_b32 v24, v12
  v_mov_b32 v25, v12
  v_mov_b32 v26, v12
  v_mov_b32 v27, v12
  v_mov_b32 v40, v12
  v_mov_b32 v41, v12
  v_mov_b32 v42, v12
  v_mov_b32 v43, v12
  v_mov_b32 v44, v12
  v_mov_b32 v45, v12
  v_mov_b32 v46, v12
  v_mov_b32 v47, v12
  s_branch F1A_MASKRET_g1s
F1A_MASK0_g1s:
  v_cndmask_b32 v24, v24, v12, s[60:61]
  v_cndmask_b32 v25, v25, v12, s[62:63]
  v_cndmask_b32 v26, v26, v12, s[52:53]
  v_cndmask_b32 v27, v27, v12, vcc
  v_cndmask_b32 v44, v44, v12, s[60:61]
  v_cndmask_b32 v45, v45, v12, s[62:63]
  v_cndmask_b32 v46, v46, v12, s[52:53]
  v_cndmask_b32 v47, v47, v12, vcc
  s_branch F1A_MASKRET_g1s
F1A_MASK32_g1s:
  v_cndmask_b32 v32, v32, v12, s[60:61]
  v_cndmask_b32 v33, v33, v12, s[62:63]
  v_cndmask_b32 v34, v34, v12, s[52:53]
  v_cndmask_b32 v35, v35, v12, vcc
  v_cndmask_b32 v52, v52, v12, s[60:61]
  v_cndmask_b32 v53, v53, v12, s[62:63]
  v_cndmask_b32 v54, v54, v12, s[52:53]
  v_cndmask_b32 v55, v55, v12, vcc
  v_mov_b32 v36, v12
  v_mov_b32 v37, v12
  v_mov_b32 v38, v12
  v_mov_b32 v39, v12
  s_branch F1A_MASKRET_g1s
F1A_FIX_g0f:
  s_getpc_b64 s[62:63]
F1A_FIXPC_g0f:
  s_add_u32 s62, s62, F1A_FIXRET_g0f-F1A_FIXPC_g0f
  s_addc_u32 s63, s63, -1
  s_branch F1A_FIXBODY_g0f
F1A_FIX_g0s:
  s_getpc_b64 s[62:63]
F1A_FIXPC_g0s:
  s_add_u32 s62, s62, F1A_FIXRET_g0s-F1A_FIXPC_g0s
  s_addc_u32 s63, s63, -1
  s_branch F1A_FIXBODY_g0f
F1A_FIX_g1f:
  s_getpc_b64 s[62:63]
F1A_FIXPC_g1f:
  s_add_u32 s62, s62, F1A_FIXRET_g1f-F1A_FIXPC_g1f
  s_addc_u32 s63, s63, -1
  s_branch F1A_FIXBODY_g0f
F1A_FIX_g1s:
  s_getpc_b64 s[62:63]
F1A_FIXPC_g1s:
  s_add_u32 s62, s62, F1A_FIXRET_g1s-F1A_FIXPC_g1s
  s_addc_u32 s63, s63, -1
  s_branch F1A_FIXBODY_g0f
F1A_FIXBODY_g0f:
  v_max3_f32 v20, v24, v25, v26
  v_max3_f32 v20, v20, v27, v28
  v_max3_f32 v20, v20, v29, v30
  v_max3_f32 v20, v20, v31, v32
  v_max3_f32 v20, v20, v33, v34
  v_max3_f32 v20, v20, v35, v36
  v_max3_f32 v20, v20, v37, v38
  v_max_f32 v20, v20, v39
  v_mov_b32 v14, v20
  v_mov_b32 v15, v20
  s_nop 1
  v_permlane32_swap_b32 v14, v15
  s_nop 1
  v_max_f32 v20, v14, v15
  v_mov_b32 v14, v20
  v_mov_b32 v15, v20
  s_nop 1
  v_permlane16_swap_b32 v14, v15
  s_nop 1
  v_max_f32 v20, v14, v15
  s_cmp_lg_u32 s42, 0
  s_cselect_b32 s34, 0xff800000, 0
  v_max_f32 v20, s34, v20
  v_sub_f32 v24, v24, v20
  v_sub_f32 v25, v25, v20
  v_sub_f32 v26, v26, v20
  v_sub_f32 v27, v27, v20
  v_sub_f32 v28, v28, v20
  v_sub_f32 v29, v29, v20
  v_sub_f32 v30, v30, v20
  v_sub_f32 v31, v31, v20
  v_sub_f32 v32, v32, v20
  v_sub_f32 v33, v33, v20
  v_sub_f32 v34, v34, v20
  v_sub_f32 v35, v35, v20
  v_sub_f32 v36, v36, v20
  v_sub_f32 v37, v37, v20
  v_sub_f32 v38, v38, v20
  v_sub_f32 v39, v39, v20
  v_sub_f32 v72, v72, v20
  v_sub_f32 v73, v73, v20
  v_sub_f32 v74, v74, v20
  v_sub_f32 v75, v75, v20
  v_max_f32 v20, 0, v20
  v_sub_f32 v16, 0, v20
  v_exp_f32 v16, v16
  s_nop 0
  v_mul_f32 v5, v5, v16
  v_mul_f32 v80, v80, v16
  v_mul_f32 v81, v81, v16
  v_mul_f32 v82, v82, v16
  v_mul_f32 v83, v83, v16
  v_mul_f32 v84, v84, v16
  v_mul_f32 v85, v85, v16
  v_mul_f32 v86, v86, v16
  v_mul_f32 v87, v87, v16
  v_mul_f32 v88, v88, v16
  v_mul_f32 v89, v89, v16
  v_mul_f32 v90, v90, v16
  v_mul_f32 v91, v91, v16
  v_mul_f32 v92, v92, v16
  v_mul_f32 v93, v93, v16
  v_mul_f32 v94, v94, v16
  v_mul_f32 v95, v95, v16
  v_mul_f32 v112, v112, v16
  v_mul_f32 v113, v113, v16
  v_mul_f32 v114, v114, v16
  v_mul_f32 v115, v115, v16
  v_mul_f32 v116, v116, v16
  v_mul_f32 v117, v117, v16
  v_mul_f32 v118, v118, v16
  v_mul_f32 v119, v119, v16
  v_mul_f32 v120, v120, v16
  v_mul_f32 v121, v121, v16
  v_mul_f32 v122, v122, v16
  v_mul_f32 v123, v123, v16
  v_mul_f32 v124, v124, v16
  v_mul_f32 v125, v125, v16
  v_mul_f32 v126, v126, v16
  v_mul_f32 v127, v127, v16
  v_max3_f32 v21, v40, v41, v42
  v_max3_f32 v21, v21, v43, v44
  v_max3_f32 v21, v21, v45, v46
  v_max3_f32 v21, v21, v47, v48
  v_max3_f32 v21, v21, v49, v50
  v_max3_f32 v21, v21, v51, v52
  v_max3_f32 v21, v21, v53, v54
  v_max_f32 v21, v21, v55
  v_mov_b32 v14, v21
  v_mov_b32 v15, v21
  s_nop 1
  v_permlane32_swap_b32 v14, v15
  s_nop 1
  v_max_f32 v21, v14, v15
  v_mov_b32 v14, v21
  v_mov_b32 v15, v21
  s_nop 1
  v_permlane16_swap_b32 v14, v15
  s_nop 1
  v_max_f32 v21, v14, v15
  s_cmp_lg_u32 s42, 0
  s_cselect_b32 s34, 0xff800000, 0
  v_max_f32 v21, s34, v21
  v_sub_f32 v40, v40, v21
  v_sub_f32 v41, v41, v21
  v_sub_f32 v42, v42, v21
  v_sub_f32 v43, v43, v21
  v_sub_f32 v44, v44, v21
  v_sub_f32 v45, v45, v21
  v_sub_f32 v46, v46, v21
  v_sub_f32 v47, v47, v21
  v_sub_f32 v48, v48, v21
  v_sub_f32 v49, v49, v21
  v_sub_f32 v50, v50, v21
  v_sub_f32 v51, v51, v21
  v_sub_f32 v52, v52, v21
  v_sub_f32 v53, v53, v21
  v_sub_f32 v54, v54, v21
  v_sub_f32 v55, v55, v21
  v_sub_f32 v76, v76, v21
  v_sub_f32 v77, v77, v21
  v_sub_f32 v78, v78, v21
  v_sub_f32 v79, v79, v21
  v_max_f32 v21, 0, v21
  v_sub_f32 v16, 0, v21
  v_exp_f32 v16, v16
  s_nop 0
  v_mul_f32 v6, v6, v16
  v_mul_f32 v96, v96, v16
  v_mul_f32 v97, v97, v16
  v_mul_f32 v98, v98, v16
  v_mul_f32 v99, v99, v16
  v_mul_f32 v100, v100, v16
  v_mul_f32 v101, v101, v16
  v_mul_f32 v102, v102, v16
  v_mul_f32 v103, v103, v16
  v_mul_f32 v104, v104, v16
  v_mul_f32 v105, v105, v16
  v_mul_f32 v106, v106, v16
  v_mul_f32 v107, v107, v16
  v_mul_f32 v108, v108, v16
  v_mul_f32 v109, v109, v16
  v_mul_f32 v110, v110, v16
  v_mul_f32 v111, v111, v16
  v_mul_f32 v128, v128, v16
  v_mul_f32 v129, v129, v16
  v_mul_f32 v130, v130, v16
  v_mul_f32 v131, v131, v16
  v_mul_f32 v132, v132, v16
  v_mul_f32 v133, v133, v16
  v_mul_f32 v134, v134, v16
  v_mul_f32 v135, v135, v16
  v_mul_f32 v136, v136, v16
  v_mul_f32 v137, v137, v16
  v_mul_f32 v138, v138, v16
  v_mul_f32 v139, v139, v16
  v_mul_f32 v140, v140, v16
  v_mul_f32 v141, v141, v16
  v_mul_f32 v142, v142, v16
  v_mul_f32 v143, v143, v16
  v_exp_f32 v12, v24
  v_exp_f32 v13, v25
  v_exp_f32 v14, v26
  v_exp_f32 v15, v27
  v_exp_f32 v16, v40
  v_exp_f32 v17, v41
  v_add_f32 v8, v12, v13
  v_exp_f32 v18, v42
  v_exp_f32 v19, v43
  v_add_f32 v8, v8, v14
  v_add_f32 v8, v8, v15
  v_cvt_pk_bf16_f32 v56, v12, v13
  v_cvt_pk_bf16_f32 v57, v14, v15
  v_exp_f32 v12, v28
  v_exp_f32 v13, v29
  v_add_f32 v10, v16, v17
  v_exp_f32 v14, v30
  v_exp_f32 v15, v31
  v_add_f32 v10, v10, v18
  v_add_f32 v10, v10, v19
  v_cvt_pk_bf16_f32 v64, v16, v17
  v_cvt_pk_bf16_f32 v65, v18, v19
  v_exp_f32 v16, v44
  v_exp_f32 v17, v45
  v_add_f32 v8, v8, v12
  v_add_f32 v8, v8, v13
  v_exp_f32 v18, v46
  v_exp_f32 v19, v47
  v_add_f32 v8, v8, v14
  v_add_f32 v8, v8, v15
  v_cvt_pk_bf16_f32 v58, v12, v13
  v_cvt_pk_bf16_f32 v59, v14, v15
  v_exp_f32 v12, v32
  v_exp_f32 v13, v33
  v_add_f32 v10, v10, v16
  v_add_f32 v10, v10, v17
  v_exp_f32 v14, v34
  v_exp_f32 v15, v35
  v_add_f32 v10, v10, v18
  v_add_f32 v10, v10, v19
  v_cvt_pk_bf16_f32 v66, v16, v17
  v_cvt_pk_bf16_f32 v67, v18, v19
  v_exp_f32 v16, v48
  v_exp_f32 v17, v49
  v_add_f32 v8, v8, v12
  v_add_f32 v8, v8, v13
  v_exp_f32 v18, v50
  v_exp_f32 v19, v51
  v_add_f32 v8, v8, v14
  v_add_f32 v8, v8, v15
  v_cvt_pk_bf16_f32 v60, v12, v13
  v_cvt_pk_bf16_f32 v61, v14, v15
  v_exp_f32 v12, v36
  v_exp_f32 v13, v37
  v_add_f32 v10, v10, v16
  v_add_f32 v10, v10, v17
  v_exp_f32 v14, v38
  v_exp_f32 v15, v39
  v_add_f32 v10, v10, v18
  v_add_f32 v10, v10, v19
  v_cvt_pk_bf16_f32 v68, v16, v17
  v_cvt_pk_bf16_f32 v69, v18, v19
  v_exp_f32 v16, v52
  v_exp_f32 v17, v53
  v_add_f32 v8, v8, v12
  v_add_f32 v8, v8, v13
  v_exp_f32 v18, v54
  v_exp_f32 v19, v55
  v_add_f32 v8, v8, v14
  v_add_f32 v8, v8, v15
  v_cvt_pk_bf16_f32 v62, v12, v13
  v_cvt_pk_bf16_f32 v63, v14, v15
  v_add_f32 v10, v10, v16
  v_add_f32 v10, v10, v17
  v_cvt_pk_bf16_f32 v70, v16, v17
  v_add_f32 v10, v10, v18
  v_add_f32 v10, v10, v19
  v_cvt_pk_bf16_f32 v71, v18, v19
  s_mov_b32 s42, 0
  s_setpc_b64 s[62:63]
F1A_MERGE:
  s_lshl_b32 s34, s30, 10
  s_lshl_b32 s47, s29, 7
  s_add_u32 s34, s34, s47
  s_add_u32 s34, s34, 125829120
  v_mov_b32 v22, 0
  buffer_load_dwordx2 v[22:23], v22, s[4:7], s34 offen sc0 sc1
  s_cmp_lt_u32 s2, 192
  s_cbranch_scc1 F1_NF5
  s_cmp_lg_u32 s28, 7
  s_cbranch_scc1 F1_NF5
  v_lshlrev_b32 v48, 7, v1
  s_mov_b32 s34, 131072000
  buffer_load_dwordx2 v[40:41], v48, s[4:7], s34 offen sc0 sc1
  s_mov_b32 s34, 131080192
  buffer_load_dwordx2 v[42:43], v48, s[4:7], s34 offen sc0 sc1
  s_mov_b32 s34, 131088384
  buffer_load_dwordx2 v[44:45], v48, s[4:7], s34 offen sc0 sc1
  s_mov_b32 s34, 131096576
  buffer_load_dwordx2 v[46:47], v48, s[4:7], s34 offen sc0 sc1
F1_NF5:
  s_lshl_b32 s34, s28, 6
  v_add_u32 v0, s34, v1
  s_getpc_b64 s[60:61]
F1A_FIN_ct52:
  s_add_u32 s60, s60, F1A_FIN-F1A_FIN_ct52
  s_addc_u32 s61, s61, 0
  v_lshlrev_b32 v52, 7, v0
  v_min_u32 v52, F1_END-F1A_FIN, v52
  v_mov_b32 v53, s61
  v_add_co_u32 v52, vcc, s60, v52
  s_nop 1
  v_addc_co_u32 v53, vcc, 0, v53, vcc
  global_load_dword v50, v[52:53], off
  v_mov_b32 v12, v5
  v_mov_b32 v13, v5
  s_nop 1
  v_permlane32_swap_b32 v12, v13
  s_nop 1
  v_add_f32 v5, v12, v13
  v_mov_b32 v12, v5
  v_mov_b32 v13, v5
  s_nop 1
  v_permlane16_swap_b32 v12, v13
  s_nop 1
  v_add_f32 v5, v12, v13
  v_mov_b32 v12, v6
  v_mov_b32 v13, v6
  s_nop 1
  v_permlane32_swap_b32 v12, v13
  s_nop 1
  v_add_f32 v6, v12, v13
  v_mov_b32 v12, v6
  v_mov_b32 v13, v6
  s_nop 1
  v_permlane16_swap_b32 v12, v13
  s_nop 1
  v_add_f32 v6, v12, v13
  s_lshr_b32 s34, s28, 1
  s_lshl_b32 s34, s34, 15
  s_and_b32 s47, s28, 1
  s_lshl_b32 s47, s47, 13
  s_add_u32 s34, s34, s47
  v_add_u32 v4, s34, v2
  v_xor_b32 v3, 0x10000, v4
  s_lshl_b32 s34, s28, 10
  s_add_u32 s34, s34, 0x20000
  v_add_u32 v20, s34, v2
  v_xor_b32 v21, 0x1000, v20
  v_mov_b32 v16, v72
  v_mov_b32 v17, v76
  v_mov_b32 v18, v5
  v_mov_b32 v19, v6
  ds_write_b128 v20, v[16:19]
  s_cmp_ge_u32 s28, 4
  s_cbranch_scc1 F1A_MG1
  ds_write_b128 v4, v[112:115] offset:0
  ds_write_b128 v4, v[116:119] offset:1024
  ds_write_b128 v4, v[120:123] offset:2048
  ds_write_b128 v4, v[124:127] offset:3072
  ds_write_b128 v4, v[128:131] offset:4096
  ds_write_b128 v4, v[132:135] offset:5120
  ds_write_b128 v4, v[136:139] offset:6144
  ds_write_b128 v4, v[140:143] offset:7168
  s_waitcnt lgkmcnt(0)
  s_barrier
  ds_read_b128 v[24:27], v21
  ds_read_b128 v[112:115], v3 offset:0
  ds_read_b128 v[116:119], v3 offset:1024
  ds_read_b128 v[120:123], v3 offset:2048
  ds_read_b128 v[124:127], v3 offset:3072
  ds_read_b128 v[128:131], v3 offset:4096
  ds_read_b128 v[132:135], v3 offset:5120
  ds_read_b128 v[136:139], v3 offset:6144
  ds_read_b128 v[140:143], v3 offset:7168
  s_waitcnt lgkmcnt(8)
  v_min_f32 v32, v16, v24
  v_sub_f32 v28, v32, v16
  v_sub_f32 v29, v32, v24
  v_exp_f32 v28, v28
  v_exp_f32 v29, v29
  s_nop 0
  v_mul_f32 v32, v28, v5
  v_fma_f32 v32, v29, v26, v32
  v_rcp_f32 v32, v32
  s_nop 0
  v_mul_f32 v28, v28, v32
  v_mul_f32 v29, v29, v32
  v_min_f32 v32, v17, v25
  v_sub_f32 v30, v32, v17
  v_sub_f32 v31, v32, v25
  v_exp_f32 v30, v30
  v_exp_f32 v31, v31
  s_nop 0
  v_mul_f32 v32, v30, v6
  v_fma_f32 v32, v31, v27, v32
  v_rcp_f32 v32, v32
  s_nop 0
  v_mul_f32 v30, v30, v32
  v_mul_f32 v31, v31, v32
  s_waitcnt lgkmcnt(0)
  v_mul_f32 v80, v80, v28
  v_fma_f32 v80, v112, v29, v80
  v_mul_f32 v81, v81, v28
  v_fma_f32 v81, v113, v29, v81
  v_mul_f32 v82, v82, v28
  v_fma_f32 v82, v114, v29, v82
  v_mul_f32 v83, v83, v28
  v_fma_f32 v83, v115, v29, v83
  v_mul_f32 v84, v84, v28
  v_fma_f32 v84, v116, v29, v84
  v_mul_f32 v85, v85, v28
  v_fma_f32 v85, v117, v29, v85
  v_mul_f32 v86, v86, v28
  v_fma_f32 v86, v118, v29, v86
  v_mul_f32 v87, v87, v28
  v_fma_f32 v87, v119, v29, v87
  v_cvt_pk_bf16_f32 v12, v80, v81
  v_cvt_pk_bf16_f32 v13, v82, v83
  v_cvt_pk_bf16_f32 v14, v84, v85
  v_cvt_pk_bf16_f32 v15, v86, v87
  s_add_u32 s34, s55, 0
  buffer_store_dwordx4 v[12:15], v2, s[4:7], s34 offen offset:0 sc1
  v_mul_f32 v88, v88, v28
  v_fma_f32 v88, v120, v29, v88
  v_mul_f32 v89, v89, v28
  v_fma_f32 v89, v121, v29, v89
  v_mul_f32 v90, v90, v28
  v_fma_f32 v90, v122, v29, v90
  v_mul_f32 v91, v91, v28
  v_fma_f32 v91, v123, v29, v91
  v_mul_f32 v92, v92, v28
  v_fma_f32 v92, v124, v29, v92
  v_mul_f32 v93, v93, v28
  v_fma_f32 v93, v125, v29, v93
  v_mul_f32 v94, v94, v28
  v_fma_f32 v94, v126, v29, v94
  v_mul_f32 v95, v95, v28
  v_fma_f32 v95, v127, v29, v95
  v_cvt_pk_bf16_f32 v16, v88, v89
  v_cvt_pk_bf16_f32 v17, v90, v91
  v_cvt_pk_bf16_f32 v18, v92, v93
  v_cvt_pk_bf16_f32 v19, v94, v95
  s_add_u32 s34, s55, 0
  buffer_store_dwordx4 v[16:19], v2, s[4:7], s34 offen offset:1024 sc1
  v_mul_f32 v96, v96, v30
  v_fma_f32 v96, v128, v31, v96
  v_mul_f32 v97, v97, v30
  v_fma_f32 v97, v129, v31, v97
  v_mul_f32 v98, v98, v30
  v_fma_f32 v98, v130, v31, v98
  v_mul_f32 v99, v99, v30
  v_fma_f32 v99, v131, v31, v99
  v_mul_f32 v100, v100, v30
  v_fma_f32 v100, v132, v31, v100
  v_mul_f32 v101, v101, v30
  v_fma_f32 v101, v133, v31, v101
  v_mul_f32 v102, v102, v30
  v_fma_f32 v102, v134, v31, v102
  v_mul_f32 v103, v103, v30
  v_fma_f32 v103, v135, v31, v103
  v_cvt_pk_bf16_f32 v12, v96, v97
  v_cvt_pk_bf16_f32 v13, v98, v99
  v_cvt_pk_bf16_f32 v14, v100, v101
  v_cvt_pk_bf16_f32 v15, v102, v103
  s_add_u32 s34, s55, 4096
  buffer_store_dwordx4 v[12:15], v2, s[4:7], s34 offen offset:0 sc1
  v_mul_f32 v104, v104, v30
  v_fma_f32 v104, v136, v31, v104
  v_mul_f32 v105, v105, v30
  v_fma_f32 v105, v137, v31, v105
  v_mul_f32 v106, v106, v30
  v_fma_f32 v106, v138, v31, v106
  v_mul_f32 v107, v107, v30
  v_fma_f32 v107, v139, v31, v107
  v_mul_f32 v108, v108, v30
  v_fma_f32 v108, v140, v31, v108
  v_mul_f32 v109, v109, v30
  v_fma_f32 v109, v141, v31, v109
  v_mul_f32 v110, v110, v30
  v_fma_f32 v110, v142, v31, v110
  v_mul_f32 v111, v111, v30
  v_fma_f32 v111, v143, v31, v111
  v_cvt_pk_bf16_f32 v16, v104, v105
  v_cvt_pk_bf16_f32 v17, v106, v107
  v_cvt_pk_bf16_f32 v18, v108, v109
  v_cvt_pk_bf16_f32 v19, v110, v111
  s_add_u32 s34, s55, 4096
  buffer_store_dwordx4 v[16:19], v2, s[4:7], s34 offen offset:1024 sc1
  s_branch F1A_FIN
F1A_MG1:
  ds_write_b128 v4, v[80:83] offset:0
  ds_write_b128 v4, v[84:87] offset:1024
  ds_write_b128 v4, v[88:91] offset:2048
  ds_write_b128 v4, v[92:95] offset:3072
  ds_write_b128 v4, v[96:99] offset:4096
  ds_write_b128 v4, v[100:103] offset:5120
  ds_write_b128 v4, v[104:107] offset:6144
  ds_write_b128 v4, v[108:111] offset:7168
F1A_MG1W:
  s_waitcnt lgkmcnt(0)
  s_barrier
  ds_read_b128 v[24:27], v21
  ds_read_b128 v[80:83], v3 offset:0
  ds_read_b128 v[84:87], v3 offset:1024
  ds_read_b128 v[88:91], v3 offset:2048
  ds_read_b128 v[92:95], v3 offset:3072
  ds_read_b128 v[96:99], v3 offset:4096
  ds_read_b128 v[100:103], v3 offset:5120
  ds_read_b128 v[104:107], v3 offset:6144
  ds_read_b128 v[108:111], v3 offset:7168
  s_waitcnt lgkmcnt(8)
  v_min_f32 v32, v16, v24
  v_sub_f32 v28, v32, v16
  v_sub_f32 v29, v32, v24
  v_exp_f32 v28, v28
  v_exp_f32 v29, v29
  s_nop 0
  v_mul_f32 v32, v28, v5
  v_fma_f32 v32, v29, v26, v32
  v_rcp_f32 v32, v32
  s_nop 0
  v_mul_f32 v28, v28, v32
  v_mul_f32 v29, v29, v32
  v_min_f32 v32, v17, v25
  v_sub_f32 v30, v32, v17
  v_sub_f32 v31, v32, v25
  v_exp_f32 v30, v30
  v_exp_f32 v31, v31
  s_nop 0
  v_mul_f32 v32, v30, v6
  v_fma_f32 v32, v31, v27, v32
  v_rcp_f32 v32, v32
  s_nop 0
  v_mul_f32 v30, v30, v32
  v_mul_f32 v31, v31, v32
  s_waitcnt lgkmcnt(0)
  v_mul_f32 v112, v112, v28
  v_fma_f32 v112, v80, v29, v112
  v_mul_f32 v113, v113, v28
  v_fma_f32 v113, v81, v29, v113
  v_mul_f32 v114, v114, v28
  v_fma_f32 v114, v82, v29, v114
  v_mul_f32 v115, v115, v28
  v_fma_f32 v115, v83, v29, v115
  v_mul_f32 v116, v116, v28
  v_fma_f32 v116, v84, v29, v116
  v_mul_f32 v117, v117, v28
  v_fma_f32 v117, v85, v29, v117
  v_mul_f32 v118, v118, v28
  v_fma_f32 v118, v86, v29, v118
  v_mul_f32 v119, v119, v28
  v_fma_f32 v119, v87, v29, v119
  v_cvt_pk_bf16_f32 v12, v112, v113
  v_cvt_pk_bf16_f32 v13, v114, v115
  v_cvt_pk_bf16_f32 v14, v116, v117
  v_cvt_pk_bf16_f32 v15, v118, v119
  s_add_u32 s34, s55, 0
  buffer_store_dwordx4 v[12:15], v2, s[4:7], s34 offen offset:2048 sc1
  v_mul_f32 v120, v120, v28
  v_fma_f32 v120, v88, v29, v120
  v_mul_f32 v121, v121, v28
  v_fma_f32 v121, v89, v29, v121
  v_mul_f32 v122, v122, v28
  v_fma_f32 v122, v90, v29, v122
  v_mul_f32 v123, v123, v28
  v_fma_f32 v123, v91, v29, v123
  v_mul_f32 v124, v124, v28
  v_fma_f32 v124, v92, v29, v124
  v_mul_f32 v125, v125, v28
  v_fma_f32 v125, v93, v29, v125
  v_mul_f32 v126, v126, v28
  v_fma_f32 v126, v94, v29, v126
  v_mul_f32 v127, v127, v28
  v_fma_f32 v127, v95, v29, v127
  v_cvt_pk_bf16_f32 v16, v120, v121
  v_cvt_pk_bf16_f32 v17, v122, v123
  v_cvt_pk_bf16_f32 v18, v124, v125
  v_cvt_pk_bf16_f32 v19, v126, v127
  s_add_u32 s34, s55, 0
  buffer_store_dwordx4 v[16:19], v2, s[4:7], s34 offen offset:3072 sc1
  v_mul_f32 v128, v128, v30
  v_fma_f32 v128, v96, v31, v128
  v_mul_f32 v129, v129, v30
  v_fma_f32 v129, v97, v31, v129
  v_mul_f32 v130, v130, v30
  v_fma_f32 v130, v98, v31, v130
  v_mul_f32 v131, v131, v30
  v_fma_f32 v131, v99, v31, v131
  v_mul_f32 v132, v132, v30
  v_fma_f32 v132, v100, v31, v132
  v_mul_f32 v133, v133, v30
  v_fma_f32 v133, v101, v31, v133
  v_mul_f32 v134, v134, v30
  v_fma_f32 v134, v102, v31, v134
  v_mul_f32 v135, v135, v30
  v_fma_f32 v135, v103, v31, v135
  v_cvt_pk_bf16_f32 v12, v128, v129
  v_cvt_pk_bf16_f32 v13, v130, v131
  v_cvt_pk_bf16_f32 v14, v132, v133
  v_cvt_pk_bf16_f32 v15, v134, v135
  s_add_u32 s34, s55, 4096
  buffer_store_dwordx4 v[12:15], v2, s[4:7], s34 offen offset:2048 sc1
  v_mul_f32 v136, v136, v30
  v_fma_f32 v136, v104, v31, v136
  v_mul_f32 v137, v137, v30
  v_fma_f32 v137, v105, v31, v137
  v_mul_f32 v138, v138, v30
  v_fma_f32 v138, v106, v31, v138
  v_mul_f32 v139, v139, v30
  v_fma_f32 v139, v107, v31, v139
  v_mul_f32 v140, v140, v30
  v_fma_f32 v140, v108, v31, v140
  v_mul_f32 v141, v141, v30
  v_fma_f32 v141, v109, v31, v141
  v_mul_f32 v142, v142, v30
  v_fma_f32 v142, v110, v31, v142
  v_mul_f32 v143, v143, v30
  v_fma_f32 v143, v111, v31, v143
  v_cvt_pk_bf16_f32 v16, v136, v137
  v_cvt_pk_bf16_f32 v17, v138, v139
  v_cvt_pk_bf16_f32 v18, v140, v141
  v_cvt_pk_bf16_f32 v19, v142, v143
  s_add_u32 s34, s55, 4096
  buffer_store_dwordx4 v[16:19], v2, s[4:7], s34 offen offset:3072 sc1
F1A_FIN:
  s_load_dwordx4 s[44:47], s[90:91], 88
  s_load_dwordx4 s[52:55], s[90:91], 32
  s_lshl_b32 s60, s30, 3
  s_add_u32 s60, s60, s29
  s_lshl_b32 s60, s60, 7
  s_add_u32 s60, s60, 130023424
  s_waitcnt vmcnt(4)
  v_readfirstlane_b32 s62, v22
  v_readfirstlane_b32 s63, v23
  v_mov_b32 v14, 0
  s_cmp_ge_u32 s2, 192
  s_cbranch_scc1 T_CONV
  s_and_b32 s29, s2, 3
  s_lshr_b32 s34, s2, 3
  s_and_b32 s30, s34, 7
  s_and_b32 s35, s2, 4
  s_lshl_b32 s35, s35, 1
  s_add_u32 s30, s30, s35
  s_lshr_b32 s31, s34, 3
  s_lshr_b32 s42, s28, 2
  s_and_b32 s37, s28, 3
  s_lshl_b32 s34, s30, 2
  s_add_u32 s43, s34, s37
  s_lshl_b32 s33, s43, 18
  s_lshl_b32 s34, s29, 16
  s_add_u32 s33, s33, s34
  s_lshl_b32 s34, s42, 15
  s_add_u32 s33, s33, s34
  s_add_u32 s56, s33, 50331648
  s_add_u32 s57, s56, 4096
  s_mul_i32 s41, s29, 6
  s_mul_i32 s34, s42, 12
  s_add_u32 s41, s41, s34
  s_sub_u32 s34, s41, 24
  s_min_u32 s41, s41, s34
  s_mov_b32 s36, 2731
  v_add_u32 v20, 0, v1
  v_mul_u32_u24 v21, s36, v20
  v_lshrrev_b32 v21, 16, v21
  v_mul_u32_u24 v22, 24, v21
  v_sub_u32 v22, v20, v22
  v_and_b32 v23, 6, v21
  v_xor_b32 v22, v22, v23
  v_add_u32 v22, s41, v22
  v_subrev_u32 v23, 24, v22
  v_min_u32 v22, v22, v23
  v_mul_u32_u24 v21, 1152, v21
  v_lshl_add_u32 v3, v22, 4, v21
  v_add_u32 v20, 64, v1
  v_mul_u32_u24 v21, s36, v20
  v_lshrrev_b32 v21, 16, v21
  v_mul_u32_u24 v22, 24, v21
  v_sub_u32 v22, v20, v22
  v_and_b32 v23, 6, v21
  v_xor_b32 v22, v22, v23
  v_add_u32 v22, s41, v22
  v_subrev_u32 v23, 24, v22
  v_min_u32 v22, v22, v23
  v_mul_u32_u24 v21, 1152, v21
  v_lshl_add_u32 v4, v22, 4, v21
  v_add_u32 v20, 128, v1
  v_mul_u32_u24 v21, s36, v20
  v_lshrrev_b32 v21, 16, v21
  v_mul_u32_u24 v22, 24, v21
  v_sub_u32 v22, v20, v22
  v_and_b32 v23, 6, v21
  v_xor_b32 v22, v22, v23
  v_add_u32 v22, s41, v22
  v_subrev_u32 v23, 24, v22
  v_min_u32 v22, v22, v23
  v_mul_u32_u24 v21, 1152, v21
  v_lshl_add_u32 v5, v22, 4, v21
  s_lshl_b32 s32, s29, 10
  s_lshl_b32 s34, s42, 9
  s_add_u32 s32, s32, s34
  s_lshl_b32 s34, s37, 4
  s_add_u32 s32, s32, s34
  s_mul_i32 s32, s32, 1152
  s_mul_i32 s34, s31, 384
  s_add_u32 s32, s32, s34
  s_mul_i32 s38, s28, 6144
  s_waitcnt lgkmcnt(0)
  s_mov_b32 s8, s44
  s_mov_b32 s9, s45
  s_mov_b32 s10, 4718592
  s_mov_b32 s11, 0x20000
  s_waitcnt vmcnt(0)
  s_barrier
  s_cmp_lg_u32 s28, 0
  s_cbranch_scc1 T_NS0
  v_mov_b32 v12, s62
  v_mov_b32 v13, s63
  s_mov_b64 exec, 1
  buffer_store_dwordx2 v[12:13], v14, s[4:7], s60 offen sc0 sc1
  s_mov_b64 exec, -1
T_NS0:
  s_add_u32 m0, s38, 0
  s_add_u32 s34, s32, 0
  buffer_load_dwordx4 v3, s[8:11], s34 offen  lds
  s_add_u32 m0, s38, 1024
  s_nop 0
  buffer_load_dwordx4 v4, s[8:11], s34 offen  lds
  s_add_u32 m0, s38, 2048
  s_nop 0
  buffer_load_dwordx4 v5, s[8:11], s34 offen  lds
  s_add_u32 m0, s38, 3072
  s_add_u32 s34, s32, 9216
  buffer_load_dwordx4 v3, s[8:11], s34 offen  lds
  s_add_u32 m0, s38, 4096
  s_nop 0
  buffer_load_dwordx4 v4, s[8:11], s34 offen  lds
  s_add_u32 m0, s38, 5120
  s_nop 0
  buffer_load_dwordx4 v5, s[8:11], s34 offen  lds
  s_add_u32 m0, s38, 49152
  s_add_u32 s34, s32, 73728
  buffer_load_dwordx4 v3, s[8:11], s34 offen  lds
  s_add_u32 m0, s38, 50176
  s_nop 0
  buffer_load_dwordx4 v4, s[8:11], s34 offen  lds
  s_add_u32 m0, s38, 51200
  s_nop 0
  buffer_load_dwordx4 v5, s[8:11], s34 offen  lds
  s_add_u32 m0, s38, 52224
  s_add_u32 s34, s32, 82944
  buffer_load_dwordx4 v3, s[8:11], s34 offen  lds
  s_add_u32 m0, s38, 53248
  s_nop 0
  buffer_load_dwordx4 v4, s[8:11], s34 offen  lds
  s_add_u32 m0, s38, 54272
  s_nop 0
  buffer_load_dwordx4 v5, s[8:11], s34 offen  lds
  v_lshrrev_b32 v20, 2, v1
  v_mul_u32_u24 v21, 384, v20
  v_and_b32 v20, 6, v20
  v_bfe_u32 v22, v1, 1, 1
  v_or_b32 v20, v20, v22
  v_and_b32 v22, 1, v1
  v_lshl_add_u32 v21, v22, 3, v21
  s_mul_i32 s34, s42, 24576
  v_add_u32 v21, s34, v21
  v_xor_b32 v22, 0, v20
  v_lshl_add_u32 v24, v22, 4, v21
  v_xor_b32 v22, 2, v20
  v_lshl_add_u32 v25, v22, 4, v21
  v_xor_b32 v22, 4, v20
  v_lshl_add_u32 v26, v22, 4, v21
  v_xor_b32 v22, 6, v20
  v_lshl_add_u32 v27, v22, 4, v21
  v_mov_b32 v48, 0
  v_mov_b32 v49, 0
  v_mov_b32 v50, 0
  v_mov_b32 v51, 0
  v_mov_b32 v52, 0
  v_mov_b32 v53, 0
  v_mov_b32 v54, 0
  v_mov_b32 v55, 0
  v_mov_b32 v56, 0
  v_mov_b32 v57, 0
  v_mov_b32 v58, 0
  v_mov_b32 v59, 0
  v_mov_b32 v60, 0
  v_mov_b32 v61, 0
  v_mov_b32 v62, 0
  v_mov_b32 v63, 0
  v_mov_b32 v64, 0
  v_mov_b32 v65, 0
  v_mov_b32 v66, 0
  v_mov_b32 v67, 0
  v_mov_b32 v68, 0
  v_mov_b32 v69, 0
  v_mov_b32 v70, 0
  v_mov_b32 v71, 0
  v_mov_b32 v72, 0
  v_mov_b32 v73, 0
  v_mov_b32 v74, 0
  v_mov_b32 v75, 0
  v_mov_b32 v76, 0
  v_mov_b32 v77, 0
  v_mov_b32 v78, 0
  v_mov_b32 v79, 0
  v_mov_b32 v80, 0
  v_mov_b32 v81, 0
  v_mov_b32 v82, 0
  v_mov_b32 v83, 0
  v_mov_b32 v84, 0
  v_mov_b32 v85, 0
  v_mov_b32 v86, 0
  v_mov_b32 v87, 0
  v_mov_b32 v88, 0
  v_mov_b32 v89, 0
  v_mov_b32 v90, 0
  v_mov_b32 v91, 0
  v_mov_b32 v92, 0
  v_mov_b32 v93, 0
  v_mov_b32 v94, 0
  v_mov_b32 v95, 0
  v_mov_b32 v96, 0
  v_mov_b32 v97, 0
  v_mov_b32 v98, 0
  v_mov_b32 v99, 0
  v_mov_b32 v100, 0
  v_mov_b32 v101, 0
  v_mov_b32 v102, 0
  v_mov_b32 v103, 0
  v_mov_b32 v104, 0
  v_mov_b32 v105, 0
  v_mov_b32 v106, 0
  v_mov_b32 v107, 0
  v_mov_b32 v108, 0
  v_mov_b32 v109, 0
  v_mov_b32 v110, 0
  v_mov_b32 v111, 0
  v_mov_b32 v112, 0
  v_mov_b32 v113, 0
  v_mov_b32 v114, 0
  v_mov_b32 v115, 0
  v_mov_b32 v116, 0
  v_mov_b32 v117, 0
  v_mov_b32 v118, 0
  v_mov_b32 v119, 0
  v_mov_b32 v120, 0
  v_mov_b32 v121, 0
  v_mov_b32 v122, 0
  v_mov_b32 v123, 0
  v_mov_b32 v124, 0
  v_mov_b32 v125, 0
  v_mov_b32 v126, 0
  v_mov_b32 v127, 0
  v_mov_b32 v128, 0
  v_mov_b32 v129, 0
  v_mov_b32 v130, 0
  v_mov_b32 v131, 0
  v_mov_b32 v132, 0
  v_mov_b32 v133, 0
  v_mov_b32 v134, 0
  v_mov_b32 v135, 0
  v_mov_b32 v136, 0
  v_mov_b32 v137, 0
  v_mov_b32 v138, 0
  v_mov_b32 v139, 0
  v_mov_b32 v140, 0
  v_mov_b32 v141, 0
  v_mov_b32 v142, 0
  v_mov_b32 v143, 0
  s_sub_u32 s34, 15, s30
  s_min_u32 s34, s34, s30
  s_lshl_b32 s34, s34, 7
  s_lshl_b32 s35, s29, 13
  s_add_u32 s39, s34, s35
  s_add_u32 s39, s39, 130023424
  v_and_b32 v20, 7, v1
  v_lshlrev_b32 v20, 10, v20
  s_cmp_lg_u32 s28, 0
  s_cbranch_scc1 T_P1_G
  s_mov_b32 s61, 0x40000
T_P1:
  buffer_load_dwordx2 v[16:17], v20, s[4:7], s39 offen sc0 sc1
  s_waitcnt vmcnt(0)
  v_cmp_ne_u32 vcc, s62, v16
  v_cmp_ne_u32 s[58:59], s63, v17
  s_or_b64 vcc, vcc, s[58:59]
  s_cmp_eq_u64 vcc, 0
  s_cbranch_scc1 T_P1_G
  s_sleep 1
  s_sub_u32 s61, s61, 1
  s_cmp_lg_u32 s61, 0
  s_cbranch_scc1 T_P1
T_P1_G:
  s_barrier
  s_add_u32 s35, s56, 0
  buffer_load_dwordx4 a[0:3], v2, s[4:7], s35 offen offset:0 sc1
  buffer_load_dwordx4 a[4:7], v2, s[4:7], s35 offen offset:1024 sc1
  s_add_u32 s35, s57, 0
  buffer_load_dwordx4 a[8:11], v2, s[4:7], s35 offen offset:0 sc1
  buffer_load_dwordx4 a[12:15], v2, s[4:7], s35 offen offset:1024 sc1
  s_add_u32 s35, s56, 0
  buffer_load_dwordx4 a[16:19], v2, s[4:7], s35 offen offset:2048 sc1
  buffer_load_dwordx4 a[20:23], v2, s[4:7], s35 offen offset:3072 sc1
  s_add_u32 s35, s57, 0
  buffer_load_dwordx4 a[24:27], v2, s[4:7], s35 offen offset:2048 sc1
  buffer_load_dwordx4 a[28:31], v2, s[4:7], s35 offen offset:3072 sc1
  s_waitcnt vmcnt(4)
  s_mul_i32 s34, s37, 12288
  s_mul_i32 s35, s42, 98304
  s_add_u32 s35, s35, s34
  v_add_u32 v9, s35, v2
  s_xor_b32 s35, s42, 1
  s_mul_i32 s35, s35, 98304
  s_add_u32 s35, s35, s34
  v_add_u32 v10, s35, v2
  v_add_u32 v28, 0, v24
  v_add_u32 v29, 0, v25
  v_add_u32 v30, 0, v26
  v_add_u32 v31, 0, v27
  s_barrier
  ds_read_b64_tr_b16 a[48:49], v28 offset:0
  ds_read_b64_tr_b16 a[50:51], v28 offset:6144
  ds_read_b64_tr_b16 a[52:53], v28 offset:12288
  ds_read_b64_tr_b16 a[54:55], v28 offset:18432
  ds_read_b64_tr_b16 a[56:57], v29 offset:0
  ds_read_b64_tr_b16 a[58:59], v29 offset:6144
  ds_read_b64_tr_b16 a[60:61], v29 offset:12288
  ds_read_b64_tr_b16 a[62:63], v29 offset:18432
  ds_read_b64_tr_b16 a[64:65], v30 offset:0
  ds_read_b64_tr_b16 a[66:67], v30 offset:6144
  ds_read_b64_tr_b16 a[68:69], v30 offset:12288
  ds_read_b64_tr_b16 a[70:71], v30 offset:18432
  ds_read_b64_tr_b16 a[72:73], v31 offset:0
  ds_read_b64_tr_b16 a[74:75], v31 offset:6144
  s_waitcnt lgkmcnt(10)
  v_mfma_f32_16x16x32_bf16 v[48:51], a[48:51], a[0:3], v[48:51]
  ds_read_b64_tr_b16 a[76:77], v31 offset:12288
  v_mfma_f32_16x16x32_bf16 v[48:51], a[52:55], a[4:7], v[48:51]
  ds_read_b64_tr_b16 a[78:79], v31 offset:18432
  v_mfma_f32_16x16x32_bf16 v[96:99], a[48:51], a[8:11], v[96:99]
  ds_read_b64_tr_b16 a[80:81], v28 offset:128
  v_mfma_f32_16x16x32_bf16 v[96:99], a[52:55], a[12:15], v[96:99]
  ds_read_b64_tr_b16 a[82:83], v28 offset:6272
  s_add_u32 s35, s56, 8192
  buffer_load_dwordx4 a[32:35], v2, s[4:7], s35 offen offset:0 sc1
  s_waitcnt lgkmcnt(10)
  v_mfma_f32_16x16x32_bf16 v[52:55], a[56:59], a[0:3], v[52:55]
  ds_read_b64_tr_b16 a[84:85], v28 offset:12416
  v_mfma_f32_16x16x32_bf16 v[52:55], a[60:63], a[4:7], v[52:55]
  ds_read_b64_tr_b16 a[86:87], v28 offset:18560
  v_mfma_f32_16x16x32_bf16 v[100:103], a[56:59], a[8:11], v[100:103]
  ds_read_b64_tr_b16 a[88:89], v29 offset:128
  v_mfma_f32_16x16x32_bf16 v[100:103], a[60:63], a[12:15], v[100:103]
  ds_read_b64_tr_b16 a[90:91], v29 offset:6272
  buffer_load_dwordx4 a[36:39], v2, s[4:7], s35 offen offset:1024 sc1
  s_waitcnt lgkmcnt(10)
  v_mfma_f32_16x16x32_bf16 v[56:59], a[64:67], a[0:3], v[56:59]
  ds_read_b64_tr_b16 a[92:93], v29 offset:12416
  v_mfma_f32_16x16x32_bf16 v[56:59], a[68:71], a[4:7], v[56:59]
  ds_read_b64_tr_b16 a[94:95], v29 offset:18560
  v_mfma_f32_16x16x32_bf16 v[104:107], a[64:67], a[8:11], v[104:107]
  ds_read_b64_tr_b16 a[96:97], v30 offset:128
  v_mfma_f32_16x16x32_bf16 v[104:107], a[68:71], a[12:15], v[104:107]
  ds_read_b64_tr_b16 a[98:99], v30 offset:6272
  s_add_u32 s35, s57, 8192
  buffer_load_dwordx4 a[40:43], v2, s[4:7], s35 offen offset:0 sc1
  s_waitcnt lgkmcnt(10)
  v_mfma_f32_16x16x32_bf16 v[60:63], a[72:75], a[0:3], v[60:63]
  ds_read_b64_tr_b16 a[100:101], v30 offset:12416
  v_mfma_f32_16x16x32_bf16 v[60:63], a[76:79], a[4:7], v[60:63]
  ds_read_b64_tr_b16 a[102:103], v30 offset:18560
  v_mfma_f32_16x16x32_bf16 v[108:111], a[72:75], a[8:11], v[108:111]
  ds_read_b64_tr_b16 a[104:105], v31 offset:128
  v_mfma_f32_16x16x32_bf16 v[108:111], a[76:79], a[12:15], v[108:111]
  ds_read_b64_tr_b16 a[106:107], v31 offset:6272
  buffer_load_dwordx4 a[44:47], v2, s[4:7], s35 offen offset:1024 sc1
  s_waitcnt lgkmcnt(10)
  v_mfma_f32_16x16x32_bf16 v[64:67], a[80:83], a[0:3], v[64:67]
  ds_read_b64_tr_b16 a[108:109], v31 offset:12416
  v_mfma_f32_16x16x32_bf16 v[64:67], a[84:87], a[4:7], v[64:67]
  ds_read_b64_tr_b16 a[110:111], v31 offset:18560
  v_mfma_f32_16x16x32_bf16 v[112:115], a[80:83], a[8:11], v[112:115]
  ds_read_b64_tr_b16 a[48:49], v28 offset:256
  v_mfma_f32_16x16x32_bf16 v[112:115], a[84:87], a[12:15], v[112:115]
  ds_read_b64_tr_b16 a[50:51], v28 offset:6400
  s_add_u32 m0, s38, 98304
  s_add_u32 s34, s32, 147456
  buffer_load_dwordx4 v3, s[8:11], s34 offen  lds
  s_waitcnt lgkmcnt(10)
  v_mfma_f32_16x16x32_bf16 v[68:71], a[88:91], a[0:3], v[68:71]
  ds_read_b64_tr_b16 a[52:53], v28 offset:12544
  v_mfma_f32_16x16x32_bf16 v[68:71], a[92:95], a[4:7], v[68:71]
  ds_read_b64_tr_b16 a[54:55], v28 offset:18688
  v_mfma_f32_16x16x32_bf16 v[116:119], a[88:91], a[8:11], v[116:119]
  ds_read_b64_tr_b16 a[56:57], v29 offset:256
  v_mfma_f32_16x16x32_bf16 v[116:119], a[92:95], a[12:15], v[116:119]
  ds_read_b64_tr_b16 a[58:59], v29 offset:6400
  s_add_u32 m0, s38, 99328
  s_nop 0
  buffer_load_dwordx4 v4, s[8:11], s34 offen  lds
  s_waitcnt lgkmcnt(10)
  v_mfma_f32_16x16x32_bf16 v[72:75], a[96:99], a[0:3], v[72:75]
  ds_read_b64_tr_b16 a[60:61], v29 offset:12544
  v_mfma_f32_16x16x32_bf16 v[72:75], a[100:103], a[4:7], v[72:75]
  ds_read_b64_tr_b16 a[62:63], v29 offset:18688
  v_mfma_f32_16x16x32_bf16 v[120:123], a[96:99], a[8:11], v[120:123]
  ds_read_b64_tr_b16 a[64:65], v30 offset:256
  v_mfma_f32_16x16x32_bf16 v[120:123], a[100:103], a[12:15], v[120:123]
  ds_read_b64_tr_b16 a[66:67], v30 offset:6400
  s_add_u32 m0, s38, 100352
  s_nop 0
  buffer_load_dwordx4 v5, s[8:11], s34 offen  lds
  s_waitcnt lgkmcnt(10)
  v_mfma_f32_16x16x32_bf16 v[76:79], a[104:107], a[0:3], v[76:79]
  ds_read_b64_tr_b16 a[68:69], v30 offset:12544
  v_mfma_f32_16x16x32_bf16 v[76:79], a[108:111], a[4:7], v[76:79]
  ds_read_b64_tr_b16 a[70:71], v30 offset:18688
  v_mfma_f32_16x16x32_bf16 v[124:127], a[104:107], a[8:11], v[124:127]
  ds_read_b64_tr_b16 a[72:73], v31 offset:256
  v_mfma_f32_16x16x32_bf16 v[124:127], a[108:111], a[12:15], v[124:127]
  ds_read_b64_tr_b16 a[74:75], v31 offset:6400
  s_add_u32 m0, s38, 101376
  s_add_u32 s34, s32, 156672
  buffer_load_dwordx4 v3, s[8:11], s34 offen  lds
  s_waitcnt lgkmcnt(10)
  v_mfma_f32_16x16x32_bf16 v[80:83], a[48:51], a[0:3], v[80:83]
  ds_read_b64_tr_b16 a[76:77], v31 offset:12544
  v_mfma_f32_16x16x32_bf16 v[80:83], a[52:55], a[4:7], v[80:83]
  ds_read_b64_tr_b16 a[78:79], v31 offset:18688
  v_mfma_f32_16x16x32_bf16 v[128:131], a[48:51], a[8:11], v[128:131]
  v_mfma_f32_16x16x32_bf16 v[128:131], a[52:55], a[12:15], v[128:131]
  s_add_u32 m0, s38, 102400
  s_nop 0
  buffer_load_dwordx4 v4, s[8:11], s34 offen  lds
  s_waitcnt lgkmcnt(8)
  v_mfma_f32_16x16x32_bf16 v[84:87], a[56:59], a[0:3], v[84:87]
  v_mfma_f32_16x16x32_bf16 v[84:87], a[60:63], a[4:7], v[84:87]
  v_mfma_f32_16x16x32_bf16 v[132:135], a[56:59], a[8:11], v[132:135]
  v_mfma_f32_16x16x32_bf16 v[132:135], a[60:63], a[12:15], v[132:135]
  s_add_u32 m0, s38, 103424
  s_nop 0
  buffer_load_dwordx4 v5, s[8:11], s34 offen  lds
  s_waitcnt vmcnt(10) lgkmcnt(0)
  v_add_u32 v28, 49152, v24
  v_add_u32 v29, 49152, v25
  v_add_u32 v30, 49152, v26
  v_add_u32 v31, 49152, v27
  s_barrier
  v_mfma_f32_16x16x32_bf16 v[88:91], a[64:67], a[0:3], v[88:91]
  ds_read_b64_tr_b16 a[48:49], v28 offset:0
  v_mfma_f32_16x16x32_bf16 v[88:91], a[68:71], a[4:7], v[88:91]
  ds_read_b64_tr_b16 a[50:51], v28 offset:6144
  v_mfma_f32_16x16x32_bf16 v[136:139], a[64:67], a[8:11], v[136:139]
  ds_read_b64_tr_b16 a[52:53], v28 offset:12288
  v_mfma_f32_16x16x32_bf16 v[136:139], a[68:71], a[12:15], v[136:139]
  ds_read_b64_tr_b16 a[54:55], v28 offset:18432
  v_mfma_f32_16x16x32_bf16 v[92:95], a[72:75], a[0:3], v[92:95]
  ds_read_b64_tr_b16 a[56:57], v29 offset:0
  v_mfma_f32_16x16x32_bf16 v[92:95], a[76:79], a[4:7], v[92:95]
  ds_read_b64_tr_b16 a[58:59], v29 offset:6144
  v_mfma_f32_16x16x32_bf16 v[140:143], a[72:75], a[8:11], v[140:143]
  ds_read_b64_tr_b16 a[60:61], v29 offset:12288
  v_mfma_f32_16x16x32_bf16 v[140:143], a[76:79], a[12:15], v[140:143]
  ds_read_b64_tr_b16 a[62:63], v29 offset:18432
  ds_read_b64_tr_b16 a[64:65], v30 offset:0
  ds_read_b64_tr_b16 a[66:67], v30 offset:6144
  ds_read_b64_tr_b16 a[68:69], v30 offset:12288
  ds_read_b64_tr_b16 a[70:71], v30 offset:18432
  ds_read_b64_tr_b16 a[72:73], v31 offset:0
  ds_read_b64_tr_b16 a[74:75], v31 offset:6144
  s_waitcnt lgkmcnt(10)
  v_mfma_f32_16x16x32_bf16 v[48:51], a[48:51], a[16:19], v[48:51]
  ds_read_b64_tr_b16 a[76:77], v31 offset:12288
  v_mfma_f32_16x16x32_bf16 v[48:51], a[52:55], a[20:23], v[48:51]
  ds_read_b64_tr_b16 a[78:79], v31 offset:18432
  v_mfma_f32_16x16x32_bf16 v[96:99], a[48:51], a[24:27], v[96:99]
  ds_read_b64_tr_b16 a[80:81], v28 offset:128
  v_mfma_f32_16x16x32_bf16 v[96:99], a[52:55], a[28:31], v[96:99]
  ds_read_b64_tr_b16 a[82:83], v28 offset:6272
  s_add_u32 s35, s56, 8192
  buffer_load_dwordx4 a[0:3], v2, s[4:7], s35 offen offset:2048 sc1
  s_waitcnt lgkmcnt(10)
  v_mfma_f32_16x16x32_bf16 v[52:55], a[56:59], a[16:19], v[52:55]
  ds_read_b64_tr_b16 a[84:85], v28 offset:12416
  v_mfma_f32_16x16x32_bf16 v[52:55], a[60:63], a[20:23], v[52:55]
  ds_read_b64_tr_b16 a[86:87], v28 offset:18560
  v_mfma_f32_16x16x32_bf16 v[100:103], a[56:59], a[24:27], v[100:103]
  ds_read_b64_tr_b16 a[88:89], v29 offset:128
  v_mfma_f32_16x16x32_bf16 v[100:103], a[60:63], a[28:31], v[100:103]
  ds_read_b64_tr_b16 a[90:91], v29 offset:6272
  buffer_load_dwordx4 a[4:7], v2, s[4:7], s35 offen offset:3072 sc1
  s_waitcnt lgkmcnt(10)
  v_mfma_f32_16x16x32_bf16 v[56:59], a[64:67], a[16:19], v[56:59]
  ds_read_b64_tr_b16 a[92:93], v29 offset:12416
  v_mfma_f32_16x16x32_bf16 v[56:59], a[68:71], a[20:23], v[56:59]
  ds_read_b64_tr_b16 a[94:95], v29 offset:18560
  v_mfma_f32_16x16x32_bf16 v[104:107], a[64:67], a[24:27], v[104:107]
  ds_read_b64_tr_b16 a[96:97], v30 offset:128
  v_mfma_f32_16x16x32_bf16 v[104:107], a[68:71], a[28:31], v[104:107]
  ds_read_b64_tr_b16 a[98:99], v30 offset:6272
  s_add_u32 s35, s57, 8192
  buffer_load_dwordx4 a[8:11], v2, s[4:7], s35 offen offset:2048 sc1
  s_waitcnt lgkmcnt(10)
  v_mfma_f32_16x16x32_bf16 v[60:63], a[72:75], a[16:19], v[60:63]
  ds_read_b64_tr_b16 a[100:101], v30 offset:12416
  v_mfma_f32_16x16x32_bf16 v[60:63], a[76:79], a[20:23], v[60:63]
  ds_read_b64_tr_b16 a[102:103], v30 offset:18560
  v_mfma_f32_16x16x32_bf16 v[108:111], a[72:75], a[24:27], v[108:111]
  ds_read_b64_tr_b16 a[104:105], v31 offset:128
  v_mfma_f32_16x16x32_bf16 v[108:111], a[76:79], a[28:31], v[108:111]
  ds_read_b64_tr_b16 a[106:107], v31 offset:6272
  buffer_load_dwordx4 a[12:15], v2, s[4:7], s35 offen offset:3072 sc1
  s_waitcnt lgkmcnt(10)
  v_mfma_f32_16x16x32_bf16 v[64:67], a[80:83], a[16:19], v[64:67]
  ds_read_b64_tr_b16 a[108:109], v31 offset:12416
  v_mfma_f32_16x16x32_bf16 v[64:67], a[84:87], a[20:23], v[64:67]
  ds_read_b64_tr_b16 a[110:111], v31 offset:18560
  v_mfma_f32_16x16x32_bf16 v[112:115], a[80:83], a[24:27], v[112:115]
  ds_read_b64_tr_b16 a[48:49], v28 offset:256
  v_mfma_f32_16x16x32_bf16 v[112:115], a[84:87], a[28:31], v[112:115]
  ds_read_b64_tr_b16 a[50:51], v28 offset:6400
  s_add_u32 m0, s38, 0
  s_add_u32 s34, s32, 221184
  buffer_load_dwordx4 v3, s[8:11], s34 offen  lds
  s_waitcnt lgkmcnt(10)
  v_mfma_f32_16x16x32_bf16 v[68:71], a[88:91], a[16:19], v[68:71]
  ds_read_b64_tr_b16 a[52:53], v28 offset:12544
  v_mfma_f32_16x16x32_bf16 v[68:71], a[92:95], a[20:23], v[68:71]
  ds_read_b64_tr_b16 a[54:55], v28 offset:18688
  v_mfma_f32_16x16x32_bf16 v[116:119], a[88:91], a[24:27], v[116:119]
  ds_read_b64_tr_b16 a[56:57], v29 offset:256
  v_mfma_f32_16x16x32_bf16 v[116:119], a[92:95], a[28:31], v[116:119]
  ds_read_b64_tr_b16 a[58:59], v29 offset:6400
  s_add_u32 m0, s38, 1024
  s_nop 0
  buffer_load_dwordx4 v4, s[8:11], s34 offen  lds
  s_waitcnt lgkmcnt(10)
  v_mfma_f32_16x16x32_bf16 v[72:75], a[96:99], a[16:19], v[72:75]
  ds_read_b64_tr_b16 a[60:61], v29 offset:12544
  v_mfma_f32_16x16x32_bf16 v[72:75], a[100:103], a[20:23], v[72:75]
  ds_read_b64_tr_b16 a[62:63], v29 offset:18688
  v_mfma_f32_16x16x32_bf16 v[120:123], a[96:99], a[24:27], v[120:123]
  ds_read_b64_tr_b16 a[64:65], v30 offset:256
  v_mfma_f32_16x16x32_bf16 v[120:123], a[100:103], a[28:31], v[120:123]
  ds_read_b64_tr_b16 a[66:67], v30 offset:6400
  s_add_u32 m0, s38, 2048
  s_nop 0
  buffer_load_dwordx4 v5, s[8:11], s34 offen  lds
  s_waitcnt lgkmcnt(10)
  v_mfma_f32_16x16x32_bf16 v[76:79], a[104:107], a[16:19], v[76:79]
  ds_read_b64_tr_b16 a[68:69], v30 offset:12544
  v_mfma_f32_16x16x32_bf16 v[76:79], a[108:111], a[20:23], v[76:79]
  ds_read_b64_tr_b16 a[70:71], v30 offset:18688
  v_mfma_f32_16x16x32_bf16 v[124:127], a[104:107], a[24:27], v[124:127]
  ds_read_b64_tr_b16 a[72:73], v31 offset:256
  v_mfma_f32_16x16x32_bf16 v[124:127], a[108:111], a[28:31], v[124:127]
  ds_read_b64_tr_b16 a[74:75], v31 offset:6400
  s_add_u32 m0, s38, 3072
  s_add_u32 s34, s32, 230400
  buffer_load_dwordx4 v3, s[8:11], s34 offen  lds
  s_waitcnt lgkmcnt(10)
  v_mfma_f32_16x16x32_bf16 v[80:83], a[48:51], a[16:19], v[80:83]
  ds_read_b64_tr_b16 a[76:77], v31 offset:12544
  v_mfma_f32_16x16x32_bf16 v[80:83], a[52:55], a[20:23], v[80:83]
  ds_read_b64_tr_b16 a[78:79], v31 offset:18688
  v_mfma_f32_16x16x32_bf16 v[128:131], a[48:51], a[24:27], v[128:131]
  v_mfma_f32_16x16x32_bf16 v[128:131], a[52:55], a[28:31], v[128:131]
  s_add_u32 m0, s38, 4096
  s_nop 0
  buffer_load_dwordx4 v4, s[8:11], s34 offen  lds
  s_waitcnt lgkmcnt(8)
  v_mfma_f32_16x16x32_bf16 v[84:87], a[56:59], a[16:19], v[84:87]
  v_mfma_f32_16x16x32_bf16 v[84:87], a[60:63], a[20:23], v[84:87]
  v_mfma_f32_16x16x32_bf16 v[132:135], a[56:59], a[24:27], v[132:135]
  v_mfma_f32_16x16x32_bf16 v[132:135], a[60:63], a[28:31], v[132:135]
  s_add_u32 m0, s38, 5120
  s_nop 0
  buffer_load_dwordx4 v5, s[8:11], s34 offen  lds
  s_waitcnt vmcnt(10) lgkmcnt(0)
  v_add_u32 v28, 98304, v24
  v_add_u32 v29, 98304, v25
  v_add_u32 v30, 98304, v26
  v_add_u32 v31, 98304, v27
  s_barrier
  v_mfma_f32_16x16x32_bf16 v[88:91], a[64:67], a[16:19], v[88:91]
  ds_read_b64_tr_b16 a[48:49], v28 offset:0
  v_mfma_f32_16x16x32_bf16 v[88:91], a[68:71], a[20:23], v[88:91]
  ds_read_b64_tr_b16 a[50:51], v28 offset:6144
  v_mfma_f32_16x16x32_bf16 v[136:139], a[64:67], a[24:27], v[136:139]
  ds_read_b64_tr_b16 a[52:53], v28 offset:12288
  v_mfma_f32_16x16x32_bf16 v[136:139], a[68:71], a[28:31], v[136:139]
  ds_read_b64_tr_b16 a[54:55], v28 offset:18432
  v_mfma_f32_16x16x32_bf16 v[92:95], a[72:75], a[16:19], v[92:95]
  ds_read_b64_tr_b16 a[56:57], v29 offset:0
  v_mfma_f32_16x16x32_bf16 v[92:95], a[76:79], a[20:23], v[92:95]
  ds_read_b64_tr_b16 a[58:59], v29 offset:6144
  v_mfma_f32_16x16x32_bf16 v[140:143], a[72:75], a[24:27], v[140:143]
  ds_read_b64_tr_b16 a[60:61], v29 offset:12288
  v_mfma_f32_16x16x32_bf16 v[140:143], a[76:79], a[28:31], v[140:143]
  ds_read_b64_tr_b16 a[62:63], v29 offset:18432
  ds_read_b64_tr_b16 a[64:65], v30 offset:0
  ds_read_b64_tr_b16 a[66:67], v30 offset:6144
  ds_read_b64_tr_b16 a[68:69], v30 offset:12288
  ds_read_b64_tr_b16 a[70:71], v30 offset:18432
  ds_read_b64_tr_b16 a[72:73], v31 offset:0
  ds_read_b64_tr_b16 a[74:75], v31 offset:6144
  s_waitcnt lgkmcnt(10)
  v_mfma_f32_16x16x32_bf16 v[48:51], a[48:51], a[32:35], v[48:51]
  ds_read_b64_tr_b16 a[76:77], v31 offset:12288
  v_mfma_f32_16x16x32_bf16 v[48:51], a[52:55], a[36:39], v[48:51]
  ds_read_b64_tr_b16 a[78:79], v31 offset:18432
  v_mfma_f32_16x16x32_bf16 v[96:99], a[48:51], a[40:43], v[96:99]
  ds_read_b64_tr_b16 a[80:81], v28 offset:128
  v_mfma_f32_16x16x32_bf16 v[96:99], a[52:55], a[44:47], v[96:99]
  ds_read_b64_tr_b16 a[82:83], v28 offset:6272
  s_add_u32 s35, s56, 16384
  buffer_load_dwordx4 a[16:19], v2, s[4:7], s35 offen offset:0 sc1
  s_waitcnt lgkmcnt(10)
  v_mfma_f32_16x16x32_bf16 v[52:55], a[56:59], a[32:35], v[52:55]
  ds_read_b64_tr_b16 a[84:85], v28 offset:12416
  v_mfma_f32_16x16x32_bf16 v[52:55], a[60:63], a[36:39], v[52:55]
  ds_read_b64_tr_b16 a[86:87], v28 offset:18560
  v_mfma_f32_16x16x32_bf16 v[100:103], a[56:59], a[40:43], v[100:103]
  ds_read_b64_tr_b16 a[88:89], v29 offset:128
  v_mfma_f32_16x16x32_bf16 v[100:103], a[60:63], a[44:47], v[100:103]
  ds_read_b64_tr_b16 a[90:91], v29 offset:6272
  buffer_load_dwordx4 a[20:23], v2, s[4:7], s35 offen offset:1024 sc1
  s_waitcnt lgkmcnt(10)
  v_mfma_f32_16x16x32_bf16 v[56:59], a[64:67], a[32:35], v[56:59]
  ds_read_b64_tr_b16 a[92:93], v29 offset:12416
  v_mfma_f32_16x16x32_bf16 v[56:59], a[68:71], a[36:39], v[56:59]
  ds_read_b64_tr_b16 a[94:95], v29 offset:18560
  v_mfma_f32_16x16x32_bf16 v[104:107], a[64:67], a[40:43], v[104:107]
  ds_read_b64_tr_b16 a[96:97], v30 offset:128
  v_mfma_f32_16x16x32_bf16 v[104:107], a[68:71], a[44:47], v[104:107]
  ds_read_b64_tr_b16 a[98:99], v30 offset:6272
  s_add_u32 s35, s57, 16384
  buffer_load_dwordx4 a[24:27], v2, s[4:7], s35 offen offset:0 sc1
  s_waitcnt lgkmcnt(10)
  v_mfma_f32_16x16x32_bf16 v[60:63], a[72:75], a[32:35], v[60:63]
  ds_read_b64_tr_b16 a[100:101], v30 offset:12416
  v_mfma_f32_16x16x32_bf16 v[60:63], a[76:79], a[36:39], v[60:63]
  ds_read_b64_tr_b16 a[102:103], v30 offset:18560
  v_mfma_f32_16x16x32_bf16 v[108:111], a[72:75], a[40:43], v[108:111]
  ds_read_b64_tr_b16 a[104:105], v31 offset:128
  v_mfma_f32_16x16x32_bf16 v[108:111], a[76:79], a[44:47], v[108:111]
  ds_read_b64_tr_b16 a[106:107], v31 offset:6272
  buffer_load_dwordx4 a[28:31], v2, s[4:7], s35 offen offset:1024 sc1
  s_waitcnt lgkmcnt(10)
  v_mfma_f32_16x16x32_bf16 v[64:67], a[80:83], a[32:35], v[64:67]
  ds_read_b64_tr_b16 a[108:109], v31 offset:12416
  v_mfma_f32_16x16x32_bf16 v[64:67], a[84:87], a[36:39], v[64:67]
  ds_read_b64_tr_b16 a[110:111], v31 offset:18560
  v_mfma_f32_16x16x32_bf16 v[112:115], a[80:83], a[40:43], v[112:115]
  ds_read_b64_tr_b16 a[48:49], v28 offset:256
  v_mfma_f32_16x16x32_bf16 v[112:115], a[84:87], a[44:47], v[112:115]
  ds_read_b64_tr_b16 a[50:51], v28 offset:6400
  s_add_u32 m0, s38, 49152
  s_add_u32 s34, s32, 294912
  buffer_load_dwordx4 v3, s[8:11], s34 offen  lds
  s_waitcnt lgkmcnt(10)
  v_mfma_f32_16x16x32_bf16 v[68:71], a[88:91], a[32:35], v[68:71]
  ds_read_b64_tr_b16 a[52:53], v28 offset:12544
  v_mfma_f32_16x16x32_bf16 v[68:71], a[92:95], a[36:39], v[68:71]
  ds_read_b64_tr_b16 a[54:55], v28 offset:18688
  v_mfma_f32_16x16x32_bf16 v[116:119], a[88:91], a[40:43], v[116:119]
  ds_read_b64_tr_b16 a[56:57], v29 offset:256
  v_mfma_f32_16x16x32_bf16 v[116:119], a[92:95], a[44:47], v[116:119]
  ds_read_b64_tr_b16 a[58:59], v29 offset:6400
  s_add_u32 m0, s38, 50176
  s_nop 0
  buffer_load_dwordx4 v4, s[8:11], s34 offen  lds
  s_waitcnt lgkmcnt(10)
  v_mfma_f32_16x16x32_bf16 v[72:75], a[96:99], a[32:35], v[72:75]
  ds_read_b64_tr_b16 a[60:61], v29 offset:12544
  v_mfma_f32_16x16x32_bf16 v[72:75], a[100:103], a[36:39], v[72:75]
  ds_read_b64_tr_b16 a[62:63], v29 offset:18688
  v_mfma_f32_16x16x32_bf16 v[120:123], a[96:99], a[40:43], v[120:123]
  ds_read_b64_tr_b16 a[64:65], v30 offset:256
  v_mfma_f32_16x16x32_bf16 v[120:123], a[100:103], a[44:47], v[120:123]
  ds_read_b64_tr_b16 a[66:67], v30 offset:6400
  s_add_u32 m0, s38, 51200
  s_nop 0
  buffer_load_dwordx4 v5, s[8:11], s34 offen  lds
  s_waitcnt lgkmcnt(10)
  v_mfma_f32_16x16x32_bf16 v[76:79], a[104:107], a[32:35], v[76:79]
  ds_read_b64_tr_b16 a[68:69], v30 offset:12544
  v_mfma_f32_16x16x32_bf16 v[76:79], a[108:111], a[36:39], v[76:79]
  ds_read_b64_tr_b16 a[70:71], v30 offset:18688
  v_mfma_f32_16x16x32_bf16 v[124:127], a[104:107], a[40:43], v[124:127]
  ds_read_b64_tr_b16 a[72:73], v31 offset:256
  v_mfma_f32_16x16x32_bf16 v[124:127], a[108:111], a[44:47], v[124:127]
  ds_read_b64_tr_b16 a[74:75], v31 offset:6400
  s_add_u32 m0, s38, 52224
  s_add_u32 s34, s32, 304128
  buffer_load_dwordx4 v3, s[8:11], s34 offen  lds
  s_waitcnt lgkmcnt(10)
  v_mfma_f32_16x16x32_bf16 v[80:83], a[48:51], a[32:35], v[80:83]
  ds_read_b64_tr_b16 a[76:77], v31 offset:12544
  v_mfma_f32_16x16x32_bf16 v[80:83], a[52:55], a[36:39], v[80:83]
  ds_read_b64_tr_b16 a[78:79], v31 offset:18688
  v_mfma_f32_16x16x32_bf16 v[128:131], a[48:51], a[40:43], v[128:131]
  v_mfma_f32_16x16x32_bf16 v[128:131], a[52:55], a[44:47], v[128:131]
  s_add_u32 m0, s38, 53248
  s_nop 0
  buffer_load_dwordx4 v4, s[8:11], s34 offen  lds
  s_waitcnt lgkmcnt(8)
  v_mfma_f32_16x16x32_bf16 v[84:87], a[56:59], a[32:35], v[84:87]
  v_mfma_f32_16x16x32_bf16 v[84:87], a[60:63], a[36:39], v[84:87]
  v_mfma_f32_16x16x32_bf16 v[132:135], a[56:59], a[40:43], v[132:135]
  v_mfma_f32_16x16x32_bf16 v[132:135], a[60:63], a[44:47], v[132:135]
  s_add_u32 m0, s38, 54272
  s_nop 0
  buffer_load_dwordx4 v5, s[8:11], s34 offen  lds
  s_waitcnt vmcnt(10) lgkmcnt(0)
  v_add_u32 v28, 0, v24
  v_add_u32 v29, 0, v25
  v_add_u32 v30, 0, v26
  v_add_u32 v31, 0, v27
  s_barrier
  v_mfma_f32_16x16x32_bf16 v[88:91], a[64:67], a[32:35], v[88:91]
  ds_read_b64_tr_b16 a[48:49], v28 offset:0
  v_mfma_f32_16x16x32_bf16 v[88:91], a[68:71], a[36:39], v[88:91]
  ds_read_b64_tr_b16 a[50:51], v28 offset:6144
  v_mfma_f32_16x16x32_bf16 v[136:139], a[64:67], a[40:43], v[136:139]
  ds_read_b64_tr_b16 a[52:53], v28 offset:12288
  v_mfma_f32_16x16x32_bf16 v[136:139], a[68:71], a[44:47], v[136:139]
  ds_read_b64_tr_b16 a[54:55], v28 offset:18432
  v_mfma_f32_16x16x32_bf16 v[92:95], a[72:75], a[32:35], v[92:95]
  ds_read_b64_tr_b16 a[56:57], v29 offset:0
  v_mfma_f32_16x16x32_bf16 v[92:95], a[76:79], a[36:39], v[92:95]
  ds_read_b64_tr_b16 a[58:59], v29 offset:6144
  v_mfma_f32_16x16x32_bf16 v[140:143], a[72:75], a[40:43], v[140:143]
  ds_read_b64_tr_b16 a[60:61], v29 offset:12288
  v_mfma_f32_16x16x32_bf16 v[140:143], a[76:79], a[44:47], v[140:143]
  ds_read_b64_tr_b16 a[62:63], v29 offset:18432
  ds_read_b64_tr_b16 a[64:65], v30 offset:0
  ds_read_b64_tr_b16 a[66:67], v30 offset:6144
  ds_read_b64_tr_b16 a[68:69], v30 offset:12288
  ds_read_b64_tr_b16 a[70:71], v30 offset:18432
  ds_read_b64_tr_b16 a[72:73], v31 offset:0
  ds_read_b64_tr_b16 a[74:75], v31 offset:6144
  s_waitcnt lgkmcnt(10)
  v_mfma_f32_16x16x32_bf16 v[48:51], a[48:51], a[0:3], v[48:51]
  ds_read_b64_tr_b16 a[76:77], v31 offset:12288
  v_mfma_f32_16x16x32_bf16 v[48:51], a[52:55], a[4:7], v[48:51]
  ds_read_b64_tr_b16 a[78:79], v31 offset:18432
  v_mfma_f32_16x16x32_bf16 v[96:99], a[48:51], a[8:11], v[96:99]
  ds_read_b64_tr_b16 a[80:81], v28 offset:128
  v_mfma_f32_16x16x32_bf16 v[96:99], a[52:55], a[12:15], v[96:99]
  ds_read_b64_tr_b16 a[82:83], v28 offset:6272
  s_add_u32 s35, s56, 16384
  buffer_load_dwordx4 a[32:35], v2, s[4:7], s35 offen offset:2048 sc1
  s_waitcnt lgkmcnt(10)
  v_mfma_f32_16x16x32_bf16 v[52:55], a[56:59], a[0:3], v[52:55]
  ds_read_b64_tr_b16 a[84:85], v28 offset:12416
  v_mfma_f32_16x16x32_bf16 v[52:55], a[60:63], a[4:7], v[52:55]
  ds_read_b64_tr_b16 a[86:87], v28 offset:18560
  v_mfma_f32_16x16x32_bf16 v[100:103], a[56:59], a[8:11], v[100:103]
  ds_read_b64_tr_b16 a[88:89], v29 offset:128
  v_mfma_f32_16x16x32_bf16 v[100:103], a[60:63], a[12:15], v[100:103]
  ds_read_b64_tr_b16 a[90:91], v29 offset:6272
  buffer_load_dwordx4 a[36:39], v2, s[4:7], s35 offen offset:3072 sc1
  s_waitcnt lgkmcnt(10)
  v_mfma_f32_16x16x32_bf16 v[56:59], a[64:67], a[0:3], v[56:59]
  ds_read_b64_tr_b16 a[92:93], v29 offset:12416
  v_mfma_f32_16x16x32_bf16 v[56:59], a[68:71], a[4:7], v[56:59]
  ds_read_b64_tr_b16 a[94:95], v29 offset:18560
  v_mfma_f32_16x16x32_bf16 v[104:107], a[64:67], a[8:11], v[104:107]
  ds_read_b64_tr_b16 a[96:97], v30 offset:128
  v_mfma_f32_16x16x32_bf16 v[104:107], a[68:71], a[12:15], v[104:107]
  ds_read_b64_tr_b16 a[98:99], v30 offset:6272
  s_add_u32 s35, s57, 16384
  buffer_load_dwordx4 a[40:43], v2, s[4:7], s35 offen offset:2048 sc1
  s_waitcnt lgkmcnt(10)
  v_mfma_f32_16x16x32_bf16 v[60:63], a[72:75], a[0:3], v[60:63]
  ds_read_b64_tr_b16 a[100:101], v30 offset:12416
  v_mfma_f32_16x16x32_bf16 v[60:63], a[76:79], a[4:7], v[60:63]
  ds_read_b64_tr_b16 a[102:103], v30 offset:18560
  v_mfma_f32_16x16x32_bf16 v[108:111], a[72:75], a[8:11], v[108:111]
  ds_read_b64_tr_b16 a[104:105], v31 offset:128
  v_mfma_f32_16x16x32_bf16 v[108:111], a[76:79], a[12:15], v[108:111]
  ds_read_b64_tr_b16 a[106:107], v31 offset:6272
  buffer_load_dwordx4 a[44:47], v2, s[4:7], s35 offen offset:3072 sc1
  s_waitcnt lgkmcnt(10)
  v_mfma_f32_16x16x32_bf16 v[64:67], a[80:83], a[0:3], v[64:67]
  ds_read_b64_tr_b16 a[108:109], v31 offset:12416
  v_mfma_f32_16x16x32_bf16 v[64:67], a[84:87], a[4:7], v[64:67]
  ds_read_b64_tr_b16 a[110:111], v31 offset:18560
  v_mfma_f32_16x16x32_bf16 v[112:115], a[80:83], a[8:11], v[112:115]
  ds_read_b64_tr_b16 a[48:49], v28 offset:256
  v_mfma_f32_16x16x32_bf16 v[112:115], a[84:87], a[12:15], v[112:115]
  ds_read_b64_tr_b16 a[50:51], v28 offset:6400
  s_add_u32 m0, s38, 98304
  s_add_u32 s34, s32, 368640
  buffer_load_dwordx4 v3, s[8:11], s34 offen  lds
  s_waitcnt lgkmcnt(10)
  v_mfma_f32_16x16x32_bf16 v[68:71], a[88:91], a[0:3], v[68:71]
  ds_read_b64_tr_b16 a[52:53], v28 offset:12544
  v_mfma_f32_16x16x32_bf16 v[68:71], a[92:95], a[4:7], v[68:71]
  ds_read_b64_tr_b16 a[54:55], v28 offset:18688
  v_mfma_f32_16x16x32_bf16 v[116:119], a[88:91], a[8:11], v[116:119]
  ds_read_b64_tr_b16 a[56:57], v29 offset:256
  v_mfma_f32_16x16x32_bf16 v[116:119], a[92:95], a[12:15], v[116:119]
  ds_read_b64_tr_b16 a[58:59], v29 offset:6400
  s_add_u32 m0, s38, 99328
  s_nop 0
  buffer_load_dwordx4 v4, s[8:11], s34 offen  lds
  s_waitcnt lgkmcnt(10)
  v_mfma_f32_16x16x32_bf16 v[72:75], a[96:99], a[0:3], v[72:75]
  ds_read_b64_tr_b16 a[60:61], v29 offset:12544
  v_mfma_f32_16x16x32_bf16 v[72:75], a[100:103], a[4:7], v[72:75]
  ds_read_b64_tr_b16 a[62:63], v29 offset:18688
  v_mfma_f32_16x16x32_bf16 v[120:123], a[96:99], a[8:11], v[120:123]
  ds_read_b64_tr_b16 a[64:65], v30 offset:256
  v_mfma_f32_16x16x32_bf16 v[120:123], a[100:103], a[12:15], v[120:123]
  ds_read_b64_tr_b16 a[66:67], v30 offset:6400
  s_add_u32 m0, s38, 100352
  s_nop 0
  buffer_load_dwordx4 v5, s[8:11], s34 offen  lds
  s_waitcnt lgkmcnt(10)
  v_mfma_f32_16x16x32_bf16 v[76:79], a[104:107], a[0:3], v[76:79]
  ds_read_b64_tr_b16 a[68:69], v30 offset:12544
  v_mfma_f32_16x16x32_bf16 v[76:79], a[108:111], a[4:7], v[76:79]
  ds_read_b64_tr_b16 a[70:71], v30 offset:18688
  v_mfma_f32_16x16x32_bf16 v[124:127], a[104:107], a[8:11], v[124:127]
  ds_read_b64_tr_b16 a[72:73], v31 offset:256
  v_mfma_f32_16x16x32_bf16 v[124:127], a[108:111], a[12:15], v[124:127]
  ds_read_b64_tr_b16 a[74:75], v31 offset:6400
  s_add_u32 m0, s38, 101376
  s_add_u32 s34, s32, 377856
  buffer_load_dwordx4 v3, s[8:11], s34 offen  lds
  s_waitcnt lgkmcnt(10)
  v_mfma_f32_16x16x32_bf16 v[80:83], a[48:51], a[0:3], v[80:83]
  ds_read_b64_tr_b16 a[76:77], v31 offset:12544
  v_mfma_f32_16x16x32_bf16 v[80:83], a[52:55], a[4:7], v[80:83]
  ds_read_b64_tr_b16 a[78:79], v31 offset:18688
  v_mfma_f32_16x16x32_bf16 v[128:131], a[48:51], a[8:11], v[128:131]
  v_mfma_f32_16x16x32_bf16 v[128:131], a[52:55], a[12:15], v[128:131]
  s_add_u32 m0, s38, 102400
  s_nop 0
  buffer_load_dwordx4 v4, s[8:11], s34 offen  lds
  s_waitcnt lgkmcnt(8)
  v_mfma_f32_16x16x32_bf16 v[84:87], a[56:59], a[0:3], v[84:87]
  v_mfma_f32_16x16x32_bf16 v[84:87], a[60:63], a[4:7], v[84:87]
  v_mfma_f32_16x16x32_bf16 v[132:135], a[56:59], a[8:11], v[132:135]
  v_mfma_f32_16x16x32_bf16 v[132:135], a[60:63], a[12:15], v[132:135]
  s_add_u32 m0, s38, 103424
  s_nop 0
  buffer_load_dwordx4 v5, s[8:11], s34 offen  lds
  s_waitcnt vmcnt(10) lgkmcnt(0)
  v_add_u32 v28, 49152, v24
  v_add_u32 v29, 49152, v25
  v_add_u32 v30, 49152, v26
  v_add_u32 v31, 49152, v27
  s_barrier
  v_mfma_f32_16x16x32_bf16 v[88:91], a[64:67], a[0:3], v[88:91]
  ds_read_b64_tr_b16 a[48:49], v28 offset:0
  v_mfma_f32_16x16x32_bf16 v[88:91], a[68:71], a[4:7], v[88:91]
  ds_read_b64_tr_b16 a[50:51], v28 offset:6144
  v_mfma_f32_16x16x32_bf16 v[136:139], a[64:67], a[8:11], v[136:139]
  ds_read_b64_tr_b16 a[52:53], v28 offset:12288
  v_mfma_f32_16x16x32_bf16 v[136:139], a[68:71], a[12:15], v[136:139]
  ds_read_b64_tr_b16 a[54:55], v28 offset:18432
  v_mfma_f32_16x16x32_bf16 v[92:95], a[72:75], a[0:3], v[92:95]
  ds_read_b64_tr_b16 a[56:57], v29 offset:0
  v_mfma_f32_16x16x32_bf16 v[92:95], a[76:79], a[4:7], v[92:95]
  ds_read_b64_tr_b16 a[58:59], v29 offset:6144
  v_mfma_f32_16x16x32_bf16 v[140:143], a[72:75], a[8:11], v[140:143]
  ds_read_b64_tr_b16 a[60:61], v29 offset:12288
  v_mfma_f32_16x16x32_bf16 v[140:143], a[76:79], a[12:15], v[140:143]
  ds_read_b64_tr_b16 a[62:63], v29 offset:18432
  ds_read_b64_tr_b16 a[64:65], v30 offset:0
  ds_read_b64_tr_b16 a[66:67], v30 offset:6144
  ds_read_b64_tr_b16 a[68:69], v30 offset:12288
  ds_read_b64_tr_b16 a[70:71], v30 offset:18432
  ds_read_b64_tr_b16 a[72:73], v31 offset:0
  ds_read_b64_tr_b16 a[74:75], v31 offset:6144
  s_waitcnt lgkmcnt(10)
  v_mfma_f32_16x16x32_bf16 v[48:51], a[48:51], a[16:19], v[48:51]
  ds_read_b64_tr_b16 a[76:77], v31 offset:12288
  v_mfma_f32_16x16x32_bf16 v[48:51], a[52:55], a[20:23], v[48:51]
  ds_read_b64_tr_b16 a[78:79], v31 offset:18432
  v_mfma_f32_16x16x32_bf16 v[96:99], a[48:51], a[24:27], v[96:99]
  ds_read_b64_tr_b16 a[80:81], v28 offset:128
  v_mfma_f32_16x16x32_bf16 v[96:99], a[52:55], a[28:31], v[96:99]
  ds_read_b64_tr_b16 a[82:83], v28 offset:6272
  s_add_u32 s35, s56, 24576
  buffer_load_dwordx4 a[0:3], v2, s[4:7], s35 offen offset:0 sc1
  s_waitcnt lgkmcnt(10)
  v_mfma_f32_16x16x32_bf16 v[52:55], a[56:59], a[16:19], v[52:55]
  ds_read_b64_tr_b16 a[84:85], v28 offset:12416
  v_mfma_f32_16x16x32_bf16 v[52:55], a[60:63], a[20:23], v[52:55]
  ds_read_b64_tr_b16 a[86:87], v28 offset:18560
  v_mfma_f32_16x16x32_bf16 v[100:103], a[56:59], a[24:27], v[100:103]
  ds_read_b64_tr_b16 a[88:89], v29 offset:128
  v_mfma_f32_16x16x32_bf16 v[100:103], a[60:63], a[28:31], v[100:103]
  ds_read_b64_tr_b16 a[90:91], v29 offset:6272
  buffer_load_dwordx4 a[4:7], v2, s[4:7], s35 offen offset:1024 sc1
  s_waitcnt lgkmcnt(10)
  v_mfma_f32_16x16x32_bf16 v[56:59], a[64:67], a[16:19], v[56:59]
  ds_read_b64_tr_b16 a[92:93], v29 offset:12416
  v_mfma_f32_16x16x32_bf16 v[56:59], a[68:71], a[20:23], v[56:59]
  ds_read_b64_tr_b16 a[94:95], v29 offset:18560
  v_mfma_f32_16x16x32_bf16 v[104:107], a[64:67], a[24:27], v[104:107]
  ds_read_b64_tr_b16 a[96:97], v30 offset:128
  v_mfma_f32_16x16x32_bf16 v[104:107], a[68:71], a[28:31], v[104:107]
  ds_read_b64_tr_b16 a[98:99], v30 offset:6272
  s_add_u32 s35, s57, 24576
  buffer_load_dwordx4 a[8:11], v2, s[4:7], s35 offen offset:0 sc1
  s_waitcnt lgkmcnt(10)
  v_mfma_f32_16x16x32_bf16 v[60:63], a[72:75], a[16:19], v[60:63]
  ds_read_b64_tr_b16 a[100:101], v30 offset:12416
  v_mfma_f32_16x16x32_bf16 v[60:63], a[76:79], a[20:23], v[60:63]
  ds_read_b64_tr_b16 a[102:103], v30 offset:18560
  v_mfma_f32_16x16x32_bf16 v[108:111], a[72:75], a[24:27], v[108:111]
  ds_read_b64_tr_b16 a[104:105], v31 offset:128
  v_mfma_f32_16x16x32_bf16 v[108:111], a[76:79], a[28:31], v[108:111]
  ds_read_b64_tr_b16 a[106:107], v31 offset:6272
  buffer_load_dwordx4 a[12:15], v2, s[4:7], s35 offen offset:1024 sc1
  s_waitcnt lgkmcnt(10)
  v_mfma_f32_16x16x32_bf16 v[64:67], a[80:83], a[16:19], v[64:67]
  ds_read_b64_tr_b16 a[108:109], v31 offset:12416
  v_mfma_f32_16x16x32_bf16 v[64:67], a[84:87], a[20:23], v[64:67]
  ds_read_b64_tr_b16 a[110:111], v31 offset:18560
  v_mfma_f32_16x16x32_bf16 v[112:115], a[80:83], a[24:27], v[112:115]
  ds_read_b64_tr_b16 a[48:49], v28 offset:256
  v_mfma_f32_16x16x32_bf16 v[112:115], a[84:87], a[28:31], v[112:115]
  ds_read_b64_tr_b16 a[50:51], v28 offset:6400
  s_add_u32 m0, s38, 0
  s_add_u32 s34, s32, 442368
  buffer_load_dwordx4 v3, s[8:11], s34 offen  lds
  s_waitcnt lgkmcnt(10)
  v_mfma_f32_16x16x32_bf16 v[68:71], a[88:91], a[16:19], v[68:71]
  ds_read_b64_tr_b16 a[52:53], v28 offset:12544
  v_mfma_f32_16x16x32_bf16 v[68:71], a[92:95], a[20:23], v[68:71]
  ds_read_b64_tr_b16 a[54:55], v28 offset:18688
  v_mfma_f32_16x16x32_bf16 v[116:119], a[88:91], a[24:27], v[116:119]
  ds_read_b64_tr_b16 a[56:57], v29 offset:256
  v_mfma_f32_16x16x32_bf16 v[116:119], a[92:95], a[28:31], v[116:119]
  ds_read_b64_tr_b16 a[58:59], v29 offset:6400
  s_add_u32 m0, s38, 1024
  s_nop 0
  buffer_load_dwordx4 v4, s[8:11], s34 offen  lds
  s_waitcnt lgkmcnt(10)
  v_mfma_f32_16x16x32_bf16 v[72:75], a[96:99], a[16:19], v[72:75]
  ds_read_b64_tr_b16 a[60:61], v29 offset:12544
  v_mfma_f32_16x16x32_bf16 v[72:75], a[100:103], a[20:23], v[72:75]
  ds_read_b64_tr_b16 a[62:63], v29 offset:18688
  v_mfma_f32_16x16x32_bf16 v[120:123], a[96:99], a[24:27], v[120:123]
  ds_read_b64_tr_b16 a[64:65], v30 offset:256
  v_mfma_f32_16x16x32_bf16 v[120:123], a[100:103], a[28:31], v[120:123]
  ds_read_b64_tr_b16 a[66:67], v30 offset:6400
  s_add_u32 m0, s38, 2048
  s_nop 0
  buffer_load_dwordx4 v5, s[8:11], s34 offen  lds
  s_waitcnt lgkmcnt(10)
  v_mfma_f32_16x16x32_bf16 v[76:79], a[104:107], a[16:19], v[76:79]
  ds_read_b64_tr_b16 a[68:69], v30 offset:12544
  v_mfma_f32_16x16x32_bf16 v[76:79], a[108:111], a[20:23], v[76:79]
  ds_read_b64_tr_b16 a[70:71], v30 offset:18688
  v_mfma_f32_16x16x32_bf16 v[124:127], a[104:107], a[24:27], v[124:127]
  ds_read_b64_tr_b16 a[72:73], v31 offset:256
  v_mfma_f32_16x16x32_bf16 v[124:127], a[108:111], a[28:31], v[124:127]
  ds_read_b64_tr_b16 a[74:75], v31 offset:6400
  s_add_u32 m0, s38, 3072
  s_add_u32 s34, s32, 451584
  buffer_load_dwordx4 v3, s[8:11], s34 offen  lds
  s_waitcnt lgkmcnt(10)
  v_mfma_f32_16x16x32_bf16 v[80:83], a[48:51], a[16:19], v[80:83]
  ds_read_b64_tr_b16 a[76:77], v31 offset:12544
  v_mfma_f32_16x16x32_bf16 v[80:83], a[52:55], a[20:23], v[80:83]
  ds_read_b64_tr_b16 a[78:79], v31 offset:18688
  v_mfma_f32_16x16x32_bf16 v[128:131], a[48:51], a[24:27], v[128:131]
  v_mfma_f32_16x16x32_bf16 v[128:131], a[52:55], a[28:31], v[128:131]
  s_add_u32 m0, s38, 4096
  s_nop 0
  buffer_load_dwordx4 v4, s[8:11], s34 offen  lds
  s_waitcnt lgkmcnt(8)
  v_mfma_f32_16x16x32_bf16 v[84:87], a[56:59], a[16:19], v[84:87]
  v_mfma_f32_16x16x32_bf16 v[84:87], a[60:63], a[20:23], v[84:87]
  v_mfma_f32_16x16x32_bf16 v[132:135], a[56:59], a[24:27], v[132:135]
  v_mfma_f32_16x16x32_bf16 v[132:135], a[60:63], a[28:31], v[132:135]
  s_add_u32 m0, s38, 5120
  s_nop 0
  buffer_load_dwordx4 v5, s[8:11], s34 offen  lds
  s_waitcnt vmcnt(10) lgkmcnt(0)
  v_add_u32 v28, 98304, v24
  v_add_u32 v29, 98304, v25
  v_add_u32 v30, 98304, v26
  v_add_u32 v31, 98304, v27
  s_barrier
  v_mfma_f32_16x16x32_bf16 v[88:91], a[64:67], a[16:19], v[88:91]
  ds_read_b64_tr_b16 a[48:49], v28 offset:0
  v_mfma_f32_16x16x32_bf16 v[88:91], a[68:71], a[20:23], v[88:91]
  ds_read_b64_tr_b16 a[50:51], v28 offset:6144
  v_mfma_f32_16x16x32_bf16 v[136:139], a[64:67], a[24:27], v[136:139]
  ds_read_b64_tr_b16 a[52:53], v28 offset:12288
  v_mfma_f32_16x16x32_bf16 v[136:139], a[68:71], a[28:31], v[136:139]
  ds_read_b64_tr_b16 a[54:55], v28 offset:18432
  v_mfma_f32_16x16x32_bf16 v[92:95], a[72:75], a[16:19], v[92:95]
  ds_read_b64_tr_b16 a[56:57], v29 offset:0
  v_mfma_f32_16x16x32_bf16 v[92:95], a[76:79], a[20:23], v[92:95]
  ds_read_b64_tr_b16 a[58:59], v29 offset:6144
  v_mfma_f32_16x16x32_bf16 v[140:143], a[72:75], a[24:27], v[140:143]
  ds_read_b64_tr_b16 a[60:61], v29 offset:12288
  v_mfma_f32_16x16x32_bf16 v[140:143], a[76:79], a[28:31], v[140:143]
  ds_read_b64_tr_b16 a[62:63], v29 offset:18432
  ds_read_b64_tr_b16 a[64:65], v30 offset:0
  ds_read_b64_tr_b16 a[66:67], v30 offset:6144
  ds_read_b64_tr_b16 a[68:69], v30 offset:12288
  ds_read_b64_tr_b16 a[70:71], v30 offset:18432
  ds_read_b64_tr_b16 a[72:73], v31 offset:0
  ds_read_b64_tr_b16 a[74:75], v31 offset:6144
  s_waitcnt lgkmcnt(10)
  v_mfma_f32_16x16x32_bf16 v[48:51], a[48:51], a[32:35], v[48:51]
  ds_read_b64_tr_b16 a[76:77], v31 offset:12288
  v_mfma_f32_16x16x32_bf16 v[48:51], a[52:55], a[36:39], v[48:51]
  ds_read_b64_tr_b16 a[78:79], v31 offset:18432
  v_mfma_f32_16x16x32_bf16 v[96:99], a[48:51], a[40:43], v[96:99]
  ds_read_b64_tr_b16 a[80:81], v28 offset:128
  v_mfma_f32_16x16x32_bf16 v[96:99], a[52:55], a[44:47], v[96:99]
  ds_read_b64_tr_b16 a[82:83], v28 offset:6272
  s_add_u32 s35, s56, 24576
  buffer_load_dwordx4 a[16:19], v2, s[4:7], s35 offen offset:2048 sc1
  s_waitcnt lgkmcnt(10)
  v_mfma_f32_16x16x32_bf16 v[52:55], a[56:59], a[32:35], v[52:55]
  ds_read_b64_tr_b16 a[84:85], v28 offset:12416
  v_mfma_f32_16x16x32_bf16 v[52:55], a[60:63], a[36:39], v[52:55]
  ds_read_b64_tr_b16 a[86:87], v28 offset:18560
  v_mfma_f32_16x16x32_bf16 v[100:103], a[56:59], a[40:43], v[100:103]
  ds_read_b64_tr_b16 a[88:89], v29 offset:128
  v_mfma_f32_16x16x32_bf16 v[100:103], a[60:63], a[44:47], v[100:103]
  ds_read_b64_tr_b16 a[90:91], v29 offset:6272
  buffer_load_dwordx4 a[20:23], v2, s[4:7], s35 offen offset:3072 sc1
  s_waitcnt lgkmcnt(10)
  v_mfma_f32_16x16x32_bf16 v[56:59], a[64:67], a[32:35], v[56:59]
  ds_read_b64_tr_b16 a[92:93], v29 offset:12416
  v_mfma_f32_16x16x32_bf16 v[56:59], a[68:71], a[36:39], v[56:59]
  ds_read_b64_tr_b16 a[94:95], v29 offset:18560
  v_mfma_f32_16x16x32_bf16 v[104:107], a[64:67], a[40:43], v[104:107]
  ds_read_b64_tr_b16 a[96:97], v30 offset:128
  v_mfma_f32_16x16x32_bf16 v[104:107], a[68:71], a[44:47], v[104:107]
  ds_read_b64_tr_b16 a[98:99], v30 offset:6272
  s_add_u32 s35, s57, 24576
  buffer_load_dwordx4 a[24:27], v2, s[4:7], s35 offen offset:2048 sc1
  s_waitcnt lgkmcnt(10)
  v_mfma_f32_16x16x32_bf16 v[60:63], a[72:75], a[32:35], v[60:63]
  ds_read_b64_tr_b16 a[100:101], v30 offset:12416
  v_mfma_f32_16x16x32_bf16 v[60:63], a[76:79], a[36:39], v[60:63]
  ds_read_b64_tr_b16 a[102:103], v30 offset:18560
  v_mfma_f32_16x16x32_bf16 v[108:111], a[72:75], a[40:43], v[108:111]
  ds_read_b64_tr_b16 a[104:105], v31 offset:128
  v_mfma_f32_16x16x32_bf16 v[108:111], a[76:79], a[44:47], v[108:111]
  ds_read_b64_tr_b16 a[106:107], v31 offset:6272
  buffer_load_dwordx4 a[28:31], v2, s[4:7], s35 offen offset:3072 sc1
  s_waitcnt lgkmcnt(10)
  v_mfma_f32_16x16x32_bf16 v[64:67], a[80:83], a[32:35], v[64:67]
  ds_read_b64_tr_b16 a[108:109], v31 offset:12416
  v_mfma_f32_16x16x32_bf16 v[64:67], a[84:87], a[36:39], v[64:67]
  ds_read_b64_tr_b16 a[110:111], v31 offset:18560
  v_mfma_f32_16x16x32_bf16 v[112:115], a[80:83], a[40:43], v[112:115]
  ds_read_b64_tr_b16 a[48:49], v28 offset:256
  v_mfma_f32_16x16x32_bf16 v[112:115], a[84:87], a[44:47], v[112:115]
  ds_read_b64_tr_b16 a[50:51], v28 offset:6400
  s_add_u32 m0, s38, 49152
  s_add_u32 s34, s32, 516096
  buffer_load_dwordx4 v3, s[8:11], s34 offen  lds
  s_waitcnt lgkmcnt(10)
  v_mfma_f32_16x16x32_bf16 v[68:71], a[88:91], a[32:35], v[68:71]
  ds_read_b64_tr_b16 a[52:53], v28 offset:12544
  v_mfma_f32_16x16x32_bf16 v[68:71], a[92:95], a[36:39], v[68:71]
  ds_read_b64_tr_b16 a[54:55], v28 offset:18688
  v_mfma_f32_16x16x32_bf16 v[116:119], a[88:91], a[40:43], v[116:119]
  ds_read_b64_tr_b16 a[56:57], v29 offset:256
  v_mfma_f32_16x16x32_bf16 v[116:119], a[92:95], a[44:47], v[116:119]
  ds_read_b64_tr_b16 a[58:59], v29 offset:6400
  s_add_u32 m0, s38, 50176
  s_nop 0
  buffer_load_dwordx4 v4, s[8:11], s34 offen  lds
  s_waitcnt lgkmcnt(10)
  v_mfma_f32_16x16x32_bf16 v[72:75], a[96:99], a[32:35], v[72:75]
  ds_read_b64_tr_b16 a[60:61], v29 offset:12544
  v_mfma_f32_16x16x32_bf16 v[72:75], a[100:103], a[36:39], v[72:75]
  ds_read_b64_tr_b16 a[62:63], v29 offset:18688
  v_mfma_f32_16x16x32_bf16 v[120:123], a[96:99], a[40:43], v[120:123]
  ds_read_b64_tr_b16 a[64:65], v30 offset:256
  v_mfma_f32_16x16x32_bf16 v[120:123], a[100:103], a[44:47], v[120:123]
  ds_read_b64_tr_b16 a[66:67], v30 offset:6400
  s_add_u32 m0, s38, 51200
  s_nop 0
  buffer_load_dwordx4 v5, s[8:11], s34 offen  lds
  s_waitcnt lgkmcnt(10)
  v_mfma_f32_16x16x32_bf16 v[76:79], a[104:107], a[32:35], v[76:79]
  ds_read_b64_tr_b16 a[68:69], v30 offset:12544
  v_mfma_f32_16x16x32_bf16 v[76:79], a[108:111], a[36:39], v[76:79]
  ds_read_b64_tr_b16 a[70:71], v30 offset:18688
  v_mfma_f32_16x16x32_bf16 v[124:127], a[104:107], a[40:43], v[124:127]
  ds_read_b64_tr_b16 a[72:73], v31 offset:256
  v_mfma_f32_16x16x32_bf16 v[124:127], a[108:111], a[44:47], v[124:127]
  ds_read_b64_tr_b16 a[74:75], v31 offset:6400
  s_add_u32 m0, s38, 52224
  s_add_u32 s34, s32, 525312
  buffer_load_dwordx4 v3, s[8:11], s34 offen  lds
  s_waitcnt lgkmcnt(10)
  v_mfma_f32_16x16x32_bf16 v[80:83], a[48:51], a[32:35], v[80:83]
  ds_read_b64_tr_b16 a[76:77], v31 offset:12544
  v_mfma_f32_16x16x32_bf16 v[80:83], a[52:55], a[36:39], v[80:83]
  ds_read_b64_tr_b16 a[78:79], v31 offset:18688
  v_mfma_f32_16x16x32_bf16 v[128:131], a[48:51], a[40:43], v[128:131]
  v_mfma_f32_16x16x32_bf16 v[128:131], a[52:55], a[44:47], v[128:131]
  s_add_u32 m0, s38, 53248
  s_nop 0
  buffer_load_dwordx4 v4, s[8:11], s34 offen  lds
  s_waitcnt lgkmcnt(8)
  v_mfma_f32_16x16x32_bf16 v[84:87], a[56:59], a[32:35], v[84:87]
  v_mfma_f32_16x16x32_bf16 v[84:87], a[60:63], a[36:39], v[84:87]
  v_mfma_f32_16x16x32_bf16 v[132:135], a[56:59], a[40:43], v[132:135]
  v_mfma_f32_16x16x32_bf16 v[132:135], a[60:63], a[44:47], v[132:135]
  s_add_u32 m0, s38, 54272
  s_nop 0
  buffer_load_dwordx4 v5, s[8:11], s34 offen  lds
  s_waitcnt vmcnt(10) lgkmcnt(0)
  v_add_u32 v28, 0, v24
  v_add_u32 v29, 0, v25
  v_add_u32 v30, 0, v26
  v_add_u32 v31, 0, v27
  s_barrier
  v_mfma_f32_16x16x32_bf16 v[88:91], a[64:67], a[32:35], v[88:91]
  ds_read_b64_tr_b16 a[48:49], v28 offset:0
  v_mfma_f32_16x16x32_bf16 v[88:91], a[68:71], a[36:39], v[88:91]
  ds_read_b64_tr_b16 a[50:51], v28 offset:6144
  v_mfma_f32_16x16x32_bf16 v[136:139], a[64:67], a[40:43], v[136:139]
  ds_read_b64_tr_b16 a[52:53], v28 offset:12288
  v_mfma_f32_16x16x32_bf16 v[136:139], a[68:71], a[44:47], v[136:139]
  ds_read_b64_tr_b16 a[54:55], v28 offset:18432
  v_mfma_f32_16x16x32_bf16 v[92:95], a[72:75], a[32:35], v[92:95]
  ds_read_b64_tr_b16 a[56:57], v29 offset:0
  v_mfma_f32_16x16x32_bf16 v[92:95], a[76:79], a[36:39], v[92:95]
  ds_read_b64_tr_b16 a[58:59], v29 offset:6144
  v_mfma_f32_16x16x32_bf16 v[140:143], a[72:75], a[40:43], v[140:143]
  ds_read_b64_tr_b16 a[60:61], v29 offset:12288
  v_mfma_f32_16x16x32_bf16 v[140:143], a[76:79], a[44:47], v[140:143]
  ds_read_b64_tr_b16 a[62:63], v29 offset:18432
  ds_read_b64_tr_b16 a[64:65], v30 offset:0
  ds_read_b64_tr_b16 a[66:67], v30 offset:6144
  ds_read_b64_tr_b16 a[68:69], v30 offset:12288
  ds_read_b64_tr_b16 a[70:71], v30 offset:18432
  ds_read_b64_tr_b16 a[72:73], v31 offset:0
  ds_read_b64_tr_b16 a[74:75], v31 offset:6144
  s_waitcnt lgkmcnt(10)
  v_mfma_f32_16x16x32_bf16 v[48:51], a[48:51], a[0:3], v[48:51]
  ds_read_b64_tr_b16 a[76:77], v31 offset:12288
  v_mfma_f32_16x16x32_bf16 v[48:51], a[52:55], a[4:7], v[48:51]
  ds_read_b64_tr_b16 a[78:79], v31 offset:18432
  v_mfma_f32_16x16x32_bf16 v[96:99], a[48:51], a[8:11], v[96:99]
  ds_read_b64_tr_b16 a[80:81], v28 offset:128
  v_mfma_f32_16x16x32_bf16 v[96:99], a[52:55], a[12:15], v[96:99]
  ds_read_b64_tr_b16 a[82:83], v28 offset:6272
  s_waitcnt lgkmcnt(10)
  v_mfma_f32_16x16x32_bf16 v[52:55], a[56:59], a[0:3], v[52:55]
  ds_read_b64_tr_b16 a[84:85], v28 offset:12416
  v_mfma_f32_16x16x32_bf16 v[52:55], a[60:63], a[4:7], v[52:55]
  ds_read_b64_tr_b16 a[86:87], v28 offset:18560
  v_mfma_f32_16x16x32_bf16 v[100:103], a[56:59], a[8:11], v[100:103]
  ds_read_b64_tr_b16 a[88:89], v29 offset:128
  v_mfma_f32_16x16x32_bf16 v[100:103], a[60:63], a[12:15], v[100:103]
  ds_read_b64_tr_b16 a[90:91], v29 offset:6272
  s_waitcnt lgkmcnt(10)
  v_mfma_f32_16x16x32_bf16 v[56:59], a[64:67], a[0:3], v[56:59]
  ds_read_b64_tr_b16 a[92:93], v29 offset:12416
  v_mfma_f32_16x16x32_bf16 v[56:59], a[68:71], a[4:7], v[56:59]
  ds_read_b64_tr_b16 a[94:95], v29 offset:18560
  v_mfma_f32_16x16x32_bf16 v[104:107], a[64:67], a[8:11], v[104:107]
  ds_read_b64_tr_b16 a[96:97], v30 offset:128
  v_mfma_f32_16x16x32_bf16 v[104:107], a[68:71], a[12:15], v[104:107]
  ds_read_b64_tr_b16 a[98:99], v30 offset:6272
  s_waitcnt lgkmcnt(10)
  v_mfma_f32_16x16x32_bf16 v[60:63], a[72:75], a[0:3], v[60:63]
  ds_read_b64_tr_b16 a[100:101], v30 offset:12416
  v_mfma_f32_16x16x32_bf16 v[60:63], a[76:79], a[4:7], v[60:63]
  ds_read_b64_tr_b16 a[102:103], v30 offset:18560
  v_mfma_f32_16x16x32_bf16 v[108:111], a[72:75], a[8:11], v[108:111]
  ds_read_b64_tr_b16 a[104:105], v31 offset:128
  v_mfma_f32_16x16x32_bf16 v[108:111], a[76:79], a[12:15], v[108:111]
  ds_read_b64_tr_b16 a[106:107], v31 offset:6272
  s_waitcnt lgkmcnt(10)
  v_mfma_f32_16x16x32_bf16 v[64:67], a[80:83], a[0:3], v[64:67]
  ds_read_b64_tr_b16 a[108:109], v31 offset:12416
  v_mfma_f32_16x16x32_bf16 v[64:67], a[84:87], a[4:7], v[64:67]
  ds_read_b64_tr_b16 a[110:111], v31 offset:18560
  v_mfma_f32_16x16x32_bf16 v[112:115], a[80:83], a[8:11], v[112:115]
  ds_read_b64_tr_b16 a[48:49], v28 offset:256
  v_mfma_f32_16x16x32_bf16 v[112:115], a[84:87], a[12:15], v[112:115]
  ds_read_b64_tr_b16 a[50:51], v28 offset:6400
  s_waitcnt lgkmcnt(10)
  v_mfma_f32_16x16x32_bf16 v[68:71], a[88:91], a[0:3], v[68:71]
  ds_read_b64_tr_b16 a[52:53], v28 offset:12544
  v_mfma_f32_16x16x32_bf16 v[68:71], a[92:95], a[4:7], v[68:71]
  ds_read_b64_tr_b16 a[54:55], v28 offset:18688
  v_mfma_f32_16x16x32_bf16 v[116:119], a[88:91], a[8:11], v[116:119]
  ds_read_b64_tr_b16 a[56:57], v29 offset:256
  v_mfma_f32_16x16x32_bf16 v[116:119], a[92:95], a[12:15], v[116:119]
  ds_read_b64_tr_b16 a[58:59], v29 offset:6400
  s_waitcnt lgkmcnt(10)
  v_mfma_f32_16x16x32_bf16 v[72:75], a[96:99], a[0:3], v[72:75]
  ds_read_b64_tr_b16 a[60:61], v29 offset:12544
  v_mfma_f32_16x16x32_bf16 v[72:75], a[100:103], a[4:7], v[72:75]
  ds_read_b64_tr_b16 a[62:63], v29 offset:18688
  v_mfma_f32_16x16x32_bf16 v[120:123], a[96:99], a[8:11], v[120:123]
  ds_read_b64_tr_b16 a[64:65], v30 offset:256
  v_mfma_f32_16x16x32_bf16 v[120:123], a[100:103], a[12:15], v[120:123]
  ds_read_b64_tr_b16 a[66:67], v30 offset:6400
  s_waitcnt lgkmcnt(10)
  v_mfma_f32_16x16x32_bf16 v[76:79], a[104:107], a[0:3], v[76:79]
  ds_read_b64_tr_b16 a[68:69], v30 offset:12544
  v_mfma_f32_16x16x32_bf16 v[76:79], a[108:111], a[4:7], v[76:79]
  ds_read_b64_tr_b16 a[70:71], v30 offset:18688
  v_mfma_f32_16x16x32_bf16 v[124:127], a[104:107], a[8:11], v[124:127]
  ds_read_b64_tr_b16 a[72:73], v31 offset:256
  v_mfma_f32_16x16x32_bf16 v[124:127], a[108:111], a[12:15], v[124:127]
  ds_read_b64_tr_b16 a[74:75], v31 offset:6400
  s_waitcnt lgkmcnt(10)
  v_mfma_f32_16x16x32_bf16 v[80:83], a[48:51], a[0:3], v[80:83]
  ds_read_b64_tr_b16 a[76:77], v31 offset:12544
  v_mfma_f32_16x16x32_bf16 v[80:83], a[52:55], a[4:7], v[80:83]
  ds_read_b64_tr_b16 a[78:79], v31 offset:18688
  v_mfma_f32_16x16x32_bf16 v[128:131], a[48:51], a[8:11], v[128:131]
  v_mfma_f32_16x16x32_bf16 v[128:131], a[52:55], a[12:15], v[128:131]
  s_waitcnt lgkmcnt(8)
  v_mfma_f32_16x16x32_bf16 v[84:87], a[56:59], a[0:3], v[84:87]
  v_mfma_f32_16x16x32_bf16 v[84:87], a[60:63], a[4:7], v[84:87]
  v_mfma_f32_16x16x32_bf16 v[132:135], a[56:59], a[8:11], v[132:135]
  v_mfma_f32_16x16x32_bf16 v[132:135], a[60:63], a[12:15], v[132:135]
  s_waitcnt vmcnt(0) lgkmcnt(0)
  v_add_u32 v28, 49152, v24
  v_add_u32 v29, 49152, v25
  v_add_u32 v30, 49152, v26
  v_add_u32 v31, 49152, v27
  s_barrier
  v_mfma_f32_16x16x32_bf16 v[88:91], a[64:67], a[0:3], v[88:91]
  ds_read_b64_tr_b16 a[48:49], v30 offset:128
  v_mfma_f32_16x16x32_bf16 v[88:91], a[68:71], a[4:7], v[88:91]
  ds_read_b64_tr_b16 a[50:51], v30 offset:6272
  v_mfma_f32_16x16x32_bf16 v[136:139], a[64:67], a[8:11], v[136:139]
  ds_read_b64_tr_b16 a[52:53], v30 offset:12416
  v_mfma_f32_16x16x32_bf16 v[136:139], a[68:71], a[12:15], v[136:139]
  ds_read_b64_tr_b16 a[54:55], v30 offset:18560
  v_mfma_f32_16x16x32_bf16 v[92:95], a[72:75], a[0:3], v[92:95]
  ds_read_b64_tr_b16 a[56:57], v31 offset:128
  v_mfma_f32_16x16x32_bf16 v[92:95], a[76:79], a[4:7], v[92:95]
  ds_read_b64_tr_b16 a[58:59], v31 offset:6272
  v_mfma_f32_16x16x32_bf16 v[140:143], a[72:75], a[8:11], v[140:143]
  ds_read_b64_tr_b16 a[60:61], v31 offset:12416
  v_mfma_f32_16x16x32_bf16 v[140:143], a[76:79], a[12:15], v[140:143]
  ds_read_b64_tr_b16 a[62:63], v31 offset:18560
  ds_read_b64_tr_b16 a[64:65], v28 offset:256
  ds_read_b64_tr_b16 a[66:67], v28 offset:6400
  ds_read_b64_tr_b16 a[68:69], v28 offset:12544
  ds_read_b64_tr_b16 a[70:71], v28 offset:18688
  ds_read_b64_tr_b16 a[72:73], v29 offset:256
  ds_read_b64_tr_b16 a[74:75], v29 offset:6400
  s_waitcnt lgkmcnt(10)
  v_mfma_f32_16x16x32_bf16 v[72:75], a[48:51], a[16:19], v[72:75]
  ds_read_b64_tr_b16 a[76:77], v29 offset:12544
  v_mfma_f32_16x16x32_bf16 v[72:75], a[52:55], a[20:23], v[72:75]
  ds_read_b64_tr_b16 a[78:79], v29 offset:18688
  v_mfma_f32_16x16x32_bf16 v[120:123], a[48:51], a[24:27], v[120:123]
  ds_read_b64_tr_b16 a[80:81], v30 offset:256
  v_mfma_f32_16x16x32_bf16 v[120:123], a[52:55], a[28:31], v[120:123]
  ds_read_b64_tr_b16 a[82:83], v30 offset:6400
  s_waitcnt lgkmcnt(10)
  v_mfma_f32_16x16x32_bf16 v[76:79], a[56:59], a[16:19], v[76:79]
  ds_read_b64_tr_b16 a[84:85], v30 offset:12544
  v_mfma_f32_16x16x32_bf16 v[76:79], a[60:63], a[20:23], v[76:79]
  ds_read_b64_tr_b16 a[86:87], v30 offset:18688
  v_mfma_f32_16x16x32_bf16 v[124:127], a[56:59], a[24:27], v[124:127]
  ds_read_b64_tr_b16 a[88:89], v31 offset:256
  v_mfma_f32_16x16x32_bf16 v[124:127], a[60:63], a[28:31], v[124:127]
  ds_read_b64_tr_b16 a[90:91], v31 offset:6400
  s_waitcnt lgkmcnt(10)
  v_mfma_f32_16x16x32_bf16 v[80:83], a[64:67], a[16:19], v[80:83]
  ds_read_b64_tr_b16 a[92:93], v31 offset:12544
  v_mfma_f32_16x16x32_bf16 v[80:83], a[68:71], a[20:23], v[80:83]
  ds_read_b64_tr_b16 a[94:95], v31 offset:18688
  v_mfma_f32_16x16x32_bf16 v[128:131], a[64:67], a[24:27], v[128:131]
  ds_read_b64_tr_b16 a[96:97], v28 offset:0
  v_mfma_f32_16x16x32_bf16 v[128:131], a[68:71], a[28:31], v[128:131]
  ds_read_b64_tr_b16 a[98:99], v28 offset:6144
  s_waitcnt lgkmcnt(10)
  v_mfma_f32_16x16x32_bf16 v[84:87], a[72:75], a[16:19], v[84:87]
  ds_read_b64_tr_b16 a[100:101], v28 offset:12288
  v_mfma_f32_16x16x32_bf16 v[84:87], a[76:79], a[20:23], v[84:87]
  ds_read_b64_tr_b16 a[102:103], v28 offset:18432
  v_mfma_f32_16x16x32_bf16 v[132:135], a[72:75], a[24:27], v[132:135]
  ds_read_b64_tr_b16 a[104:105], v29 offset:0
  v_mfma_f32_16x16x32_bf16 v[132:135], a[76:79], a[28:31], v[132:135]
  ds_read_b64_tr_b16 a[106:107], v29 offset:6144
  s_waitcnt lgkmcnt(10)
  v_mfma_f32_16x16x32_bf16 v[88:91], a[80:83], a[16:19], v[88:91]
  ds_read_b64_tr_b16 a[108:109], v29 offset:12288
  v_mfma_f32_16x16x32_bf16 v[88:91], a[84:87], a[20:23], v[88:91]
  ds_read_b64_tr_b16 a[110:111], v29 offset:18432
  v_mfma_f32_16x16x32_bf16 v[136:139], a[80:83], a[24:27], v[136:139]
  ds_read_b64_tr_b16 a[48:49], v30 offset:0
  v_mfma_f32_16x16x32_bf16 v[136:139], a[84:87], a[28:31], v[136:139]
  ds_read_b64_tr_b16 a[50:51], v30 offset:6144
  ds_write_b128 v9, v[72:75] offset:0
  ds_write_b128 v9, v[120:123] offset:6144
  s_waitcnt lgkmcnt(10)
  v_mfma_f32_16x16x32_bf16 v[92:95], a[88:91], a[16:19], v[92:95]
  ds_read_b64_tr_b16 a[52:53], v30 offset:12288
  v_mfma_f32_16x16x32_bf16 v[92:95], a[92:95], a[20:23], v[92:95]
  ds_read_b64_tr_b16 a[54:55], v30 offset:18432
  v_mfma_f32_16x16x32_bf16 v[140:143], a[88:91], a[24:27], v[140:143]
  ds_read_b64_tr_b16 a[56:57], v31 offset:0
  v_mfma_f32_16x16x32_bf16 v[140:143], a[92:95], a[28:31], v[140:143]
  ds_read_b64_tr_b16 a[58:59], v31 offset:6144
  ds_write_b128 v9, v[76:79] offset:1024
  ds_write_b128 v9, v[124:127] offset:7168
  s_waitcnt lgkmcnt(10)
  v_mfma_f32_16x16x32_bf16 v[48:51], a[96:99], a[16:19], v[48:51]
  ds_read_b64_tr_b16 a[60:61], v31 offset:12288
  v_mfma_f32_16x16x32_bf16 v[48:51], a[100:103], a[20:23], v[48:51]
  ds_read_b64_tr_b16 a[62:63], v31 offset:18432
  v_mfma_f32_16x16x32_bf16 v[96:99], a[96:99], a[24:27], v[96:99]
  ds_read_b64_tr_b16 a[64:65], v28 offset:128
  v_mfma_f32_16x16x32_bf16 v[96:99], a[100:103], a[28:31], v[96:99]
  ds_read_b64_tr_b16 a[66:67], v28 offset:6272
  ds_write_b128 v9, v[80:83] offset:2048
  ds_write_b128 v9, v[128:131] offset:8192
  s_waitcnt lgkmcnt(10)
  v_mfma_f32_16x16x32_bf16 v[52:55], a[104:107], a[16:19], v[52:55]
  ds_read_b64_tr_b16 a[68:69], v28 offset:12416
  v_mfma_f32_16x16x32_bf16 v[52:55], a[108:111], a[20:23], v[52:55]
  ds_read_b64_tr_b16 a[70:71], v28 offset:18560
  v_mfma_f32_16x16x32_bf16 v[100:103], a[104:107], a[24:27], v[100:103]
  ds_read_b64_tr_b16 a[72:73], v29 offset:128
  v_mfma_f32_16x16x32_bf16 v[100:103], a[108:111], a[28:31], v[100:103]
  ds_read_b64_tr_b16 a[74:75], v29 offset:6272
  ds_write_b128 v9, v[84:87] offset:3072
  ds_write_b128 v9, v[132:135] offset:9216
  s_waitcnt lgkmcnt(10)
  v_mfma_f32_16x16x32_bf16 v[56:59], a[48:51], a[16:19], v[56:59]
  ds_read_b64_tr_b16 a[76:77], v29 offset:12416
  v_mfma_f32_16x16x32_bf16 v[56:59], a[52:55], a[20:23], v[56:59]
  ds_read_b64_tr_b16 a[78:79], v29 offset:18560
  v_mfma_f32_16x16x32_bf16 v[104:107], a[48:51], a[24:27], v[104:107]
  v_mfma_f32_16x16x32_bf16 v[104:107], a[52:55], a[28:31], v[104:107]
  ds_write_b128 v9, v[88:91] offset:4096
  ds_write_b128 v9, v[136:139] offset:10240
  s_waitcnt lgkmcnt(8)
  v_mfma_f32_16x16x32_bf16 v[60:63], a[56:59], a[16:19], v[60:63]
  v_mfma_f32_16x16x32_bf16 v[60:63], a[60:63], a[20:23], v[60:63]
  v_mfma_f32_16x16x32_bf16 v[108:111], a[56:59], a[24:27], v[108:111]
  v_mfma_f32_16x16x32_bf16 v[108:111], a[60:63], a[28:31], v[108:111]
  ds_write_b128 v9, v[92:95] offset:5120
  ds_write_b128 v9, v[140:143] offset:11264
  s_waitcnt lgkmcnt(2)
  v_mfma_f32_16x16x32_bf16 v[64:67], a[64:67], a[16:19], v[64:67]
  v_mfma_f32_16x16x32_bf16 v[64:67], a[68:71], a[20:23], v[64:67]
  v_mfma_f32_16x16x32_bf16 v[112:115], a[64:67], a[24:27], v[112:115]
  v_mfma_f32_16x16x32_bf16 v[112:115], a[68:71], a[28:31], v[112:115]
  v_mfma_f32_16x16x32_bf16 v[68:71], a[72:75], a[16:19], v[68:71]
  v_mfma_f32_16x16x32_bf16 v[68:71], a[76:79], a[20:23], v[68:71]
  v_mfma_f32_16x16x32_bf16 v[116:119], a[72:75], a[24:27], v[116:119]
  v_mfma_f32_16x16x32_bf16 v[116:119], a[76:79], a[28:31], v[116:119]
  s_mov_b32 s8, s46
  s_mov_b32 s9, s47
  s_mov_b32 s10, 4718592
  s_mov_b32 s11, 0x20000
  s_mul_i32 s39, s30, 3
  s_add_u32 s39, s39, s31
  s_mul_i32 s50, s39, 196608
  s_mul_i32 s34, s37, 3072
  s_add_u32 s50, s50, s34
  s_add_u32 s50, s50, 67108864
  s_lshl_b32 s52, s39, 12
  s_add_u32 s52, s52, 127926272
  s_lshl_b32 s34, s29, 10
  s_add_u32 s53, s52, s34
  s_lshl_b32 s34, s28, 7
  s_add_u32 s53, s53, s34
  s_lshl_b32 s40, s42, 1
  s_add_u32 s40, s40, s29
  s_waitcnt lgkmcnt(0)
  s_barrier
  ds_read_b128 v[84:87], v10 offset:3072
  ds_read_b128 v[132:135], v10 offset:9216
  ds_read_b128 v[88:91], v10 offset:4096
  ds_read_b128 v[136:139], v10 offset:10240
  ds_read_b128 v[92:95], v10 offset:5120
  ds_read_b128 v[140:143], v10 offset:11264
  ds_read_b128 v[72:75], v10 offset:0
  ds_read_b128 v[120:123], v10 offset:6144
  ds_read_b128 v[76:79], v10 offset:1024
  ds_read_b128 v[124:127], v10 offset:7168
  ds_read_b128 v[80:83], v10 offset:2048
  ds_read_b128 v[128:131], v10 offset:8192
  s_waitcnt lgkmcnt(11)
  v_add_f32 v60, v60, v84
  v_add_f32 v61, v61, v85
  v_add_f32 v62, v62, v86
  v_add_f32 v63, v63, v87
  v_cvt_pk_bf16_f32 v24, v60, v61
  v_cvt_pk_bf16_f32 v25, v62, v63
  s_add_u32 s34, s40, 1
  s_and_b32 s34, s34, 3
  s_lshl_b32 s34, s34, 2
  s_add_u32 s34, s34, s29
  s_mul_i32 s34, s34, 12288
  s_add_u32 s34, s34, s50
  s_waitcnt lgkmcnt(10)
  v_add_f32 v108, v108, v132
  v_add_f32 v109, v109, v133
  v_add_f32 v110, v110, v134
  v_add_f32 v111, v111, v135
  v_cvt_pk_bf16_f32 v26, v108, v109
  v_cvt_pk_bf16_f32 v27, v110, v111
  buffer_store_dwordx4 v[24:27], v2, s[4:7], s34 offen offset:0 sc1
  s_waitcnt lgkmcnt(9)
  v_add_f32 v64, v64, v88
  v_add_f32 v65, v65, v89
  v_add_f32 v66, v66, v90
  v_add_f32 v67, v67, v91
  v_cvt_pk_bf16_f32 v28, v64, v65
  v_cvt_pk_bf16_f32 v29, v66, v67
  s_waitcnt lgkmcnt(8)
  v_add_f32 v112, v112, v136
  v_add_f32 v113, v113, v137
  v_add_f32 v114, v114, v138
  v_add_f32 v115, v115, v139
  v_cvt_pk_bf16_f32 v30, v112, v113
  v_cvt_pk_bf16_f32 v31, v114, v115
  buffer_store_dwordx4 v[28:31], v2, s[4:7], s34 offen offset:1024 sc1
  s_waitcnt lgkmcnt(7)
  v_add_f32 v68, v68, v92
  v_add_f32 v69, v69, v93
  v_add_f32 v70, v70, v94
  v_add_f32 v71, v71, v95
  v_cvt_pk_bf16_f32 v32, v68, v69
  v_cvt_pk_bf16_f32 v33, v70, v71
  s_waitcnt lgkmcnt(6)
  v_add_f32 v116, v116, v140
  v_add_f32 v117, v117, v141
  v_add_f32 v118, v118, v142
  v_add_f32 v119, v119, v143
  v_cvt_pk_bf16_f32 v34, v116, v117
  v_cvt_pk_bf16_f32 v35, v118, v119
  buffer_store_dwordx4 v[32:35], v2, s[4:7], s34 offen offset:2048 sc1
  s_cmp_eq_u32 s42, 0
  s_cbranch_scc1 T_OWN
  s_waitcnt lgkmcnt(5)
  v_add_f32 v48, v48, v72
  v_add_f32 v49, v49, v73
  v_add_f32 v50, v50, v74
  v_add_f32 v51, v51, v75
  v_cvt_pk_bf16_f32 v36, v48, v49
  v_cvt_pk_bf16_f32 v37, v50, v51
  s_add_u32 s34, s40, 0
  s_and_b32 s34, s34, 3
  s_lshl_b32 s34, s34, 2
  s_add_u32 s34, s34, s29
  s_mul_i32 s34, s34, 12288
  s_add_u32 s34, s34, s50
  s_waitcnt lgkmcnt(4)
  v_add_f32 v96, v96, v120
  v_add_f32 v97, v97, v121
  v_add_f32 v98, v98, v122
  v_add_f32 v99, v99, v123
  v_cvt_pk_bf16_f32 v38, v96, v97
  v_cvt_pk_bf16_f32 v39, v98, v99
  buffer_store_dwordx4 v[36:39], v2, s[4:7], s34 offen offset:0 sc1
  s_waitcnt lgkmcnt(3)
  v_add_f32 v52, v52, v76
  v_add_f32 v53, v53, v77
  v_add_f32 v54, v54, v78
  v_add_f32 v55, v55, v79
  v_cvt_pk_bf16_f32 v40, v52, v53
  v_cvt_pk_bf16_f32 v41, v54, v55
  s_waitcnt lgkmcnt(2)
  v_add_f32 v100, v100, v124
  v_add_f32 v101, v101, v125
  v_add_f32 v102, v102, v126
  v_add_f32 v103, v103, v127
  v_cvt_pk_bf16_f32 v42, v100, v101
  v_cvt_pk_bf16_f32 v43, v102, v103
  buffer_store_dwordx4 v[40:43], v2, s[4:7], s34 offen offset:1024 sc1
  s_waitcnt lgkmcnt(1)
  v_add_f32 v56, v56, v80
  v_add_f32 v57, v57, v81
  v_add_f32 v58, v58, v82
  v_add_f32 v59, v59, v83
  v_cvt_pk_bf16_f32 v44, v56, v57
  v_cvt_pk_bf16_f32 v45, v58, v59
  s_waitcnt lgkmcnt(0)
  v_add_f32 v104, v104, v128
  v_add_f32 v105, v105, v129
  v_add_f32 v106, v106, v130
  v_add_f32 v107, v107, v131
  v_cvt_pk_bf16_f32 v46, v104, v105
  v_cvt_pk_bf16_f32 v47, v106, v107
  buffer_store_dwordx4 v[44:47], v2, s[4:7], s34 offen offset:2048 sc1
  s_waitcnt vmcnt(0)
  v_mov_b32 v12, s62
  v_mov_b32 v13, s63
  s_mov_b64 exec, 1
  buffer_store_dwordx2 v[12:13], v14, s[4:7], s53 offen sc0 sc1
  s_mov_b64 exec, -1
  s_branch T_FIN
T_OWN:
  s_waitcnt lgkmcnt(0)
  v_add_f32 v48, v48, v72
  v_add_f32 v49, v49, v73
  v_add_f32 v50, v50, v74
  v_add_f32 v51, v51, v75
  v_add_f32 v96, v96, v120
  v_add_f32 v97, v97, v121
  v_add_f32 v98, v98, v122
  v_add_f32 v99, v99, v123
  v_add_f32 v52, v52, v76
  v_add_f32 v53, v53, v77
  v_add_f32 v54, v54, v78
  v_add_f32 v55, v55, v79
  v_add_f32 v100, v100, v124
  v_add_f32 v101, v101, v125
  v_add_f32 v102, v102, v126
  v_add_f32 v103, v103, v127
  v_add_f32 v56, v56, v80
  v_add_f32 v57, v57, v81
  v_add_f32 v58, v58, v82
  v_add_f32 v59, v59, v83
  v_add_f32 v104, v104, v128
  v_add_f32 v105, v105, v129
  v_add_f32 v106, v106, v130
  v_add_f32 v107, v107, v131
  v_and_b32 v20, 3, v1
  v_max_u32 v20, 1, v20
  v_sub_u32 v21, s29, v20
  v_and_b32 v21, 3, v21
  v_lshlrev_b32 v21, 10, v21
  v_lshrrev_b32 v20, 1, v20
  v_lshl_add_u32 v20, v20, 9, v21
  s_lshl_b32 s34, s37, 7
  s_add_u32 s52, s52, s34
  v_and_b32 v10, 15, v1
  v_mul_u32_u24 v10, 2304, v10
  v_lshrrev_b32 v21, 4, v1
  v_lshl_add_u32 v3, v21, 3, v10
  s_mul_i32 s54, s43, 73728
  s_mul_i32 s34, s31, 384
  s_add_u32 s54, s54, s34
  s_mul_i32 s34, s29, 96
  s_add_u32 s54, s54, s34
  s_add_u32 s54, s54, 1152
  s_add_u32 s55, s54, 36864
  s_mul_i32 s34, s29, 49152
  s_add_u32 s50, s50, s34
  s_waitcnt vmcnt(0)
  v_mov_b32 v12, s62
  v_mov_b32 v13, s63
  s_mov_b64 exec, 1
  buffer_store_dwordx2 v[12:13], v14, s[4:7], s53 offen sc0 sc1
  s_mov_b64 exec, -1
  s_mov_b32 s61, 0x40000
T_P2:
  buffer_load_dwordx2 v[16:17], v20, s[4:7], s52 offen sc0 sc1
  s_waitcnt vmcnt(0)
  v_cmp_ne_u32 vcc, s62, v16
  v_cmp_ne_u32 s[58:59], s63, v17
  s_or_b64 vcc, vcc, s[58:59]
  s_cmp_eq_u64 vcc, 0
  s_cbranch_scc1 T_P2_G
  s_sleep 1
  s_sub_u32 s61, s61, 1
  s_cmp_lg_u32 s61, 0
  s_cbranch_scc1 T_P2
T_P2_G:
  s_add_u32 s34, s29, 1
  s_and_b32 s34, s34, 3
  s_mul_i32 s34, s34, 12288
  s_add_u32 s34, s34, s50
  buffer_load_dwordx4 v[72:75], v2, s[4:7], s34 offen offset:0 sc1
  buffer_load_dwordx4 v[76:79], v2, s[4:7], s34 offen offset:1024 sc1
  buffer_load_dwordx4 v[80:83], v2, s[4:7], s34 offen offset:2048 sc1
  s_add_u32 s34, s29, 2
  s_and_b32 s34, s34, 3
  s_mul_i32 s34, s34, 12288
  s_add_u32 s34, s34, s50
  buffer_load_dwordx4 v[84:87], v2, s[4:7], s34 offen offset:0 sc1
  buffer_load_dwordx4 v[88:91], v2, s[4:7], s34 offen offset:1024 sc1
  buffer_load_dwordx4 v[92:95], v2, s[4:7], s34 offen offset:2048 sc1
  s_add_u32 s34, s29, 3
  s_and_b32 s34, s34, 3
  s_mul_i32 s34, s34, 12288
  s_add_u32 s34, s34, s50
  buffer_load_dwordx4 v[120:123], v2, s[4:7], s34 offen offset:0 sc1
  buffer_load_dwordx4 v[124:127], v2, s[4:7], s34 offen offset:1024 sc1
  buffer_load_dwordx4 v[128:131], v2, s[4:7], s34 offen offset:2048 sc1
  s_mov_b32 s36, 0xffff0000
  s_waitcnt vmcnt(6)
  v_lshlrev_b32 v4, 16, v72
  v_and_b32 v5, s36, v72
  v_add_f32 v48, v48, v4
  v_add_f32 v49, v49, v5
  v_lshlrev_b32 v4, 16, v73
  v_and_b32 v5, s36, v73
  v_add_f32 v50, v50, v4
  v_add_f32 v51, v51, v5
  v_lshlrev_b32 v4, 16, v74
  v_and_b32 v5, s36, v74
  v_add_f32 v96, v96, v4
  v_add_f32 v97, v97, v5
  v_lshlrev_b32 v4, 16, v75
  v_and_b32 v5, s36, v75
  v_add_f32 v98, v98, v4
  v_add_f32 v99, v99, v5
  v_lshlrev_b32 v4, 16, v76
  v_and_b32 v5, s36, v76
  v_add_f32 v52, v52, v4
  v_add_f32 v53, v53, v5
  v_lshlrev_b32 v4, 16, v77
  v_and_b32 v5, s36, v77
  v_add_f32 v54, v54, v4
  v_add_f32 v55, v55, v5
  v_lshlrev_b32 v4, 16, v78
  v_and_b32 v5, s36, v78
  v_add_f32 v100, v100, v4
  v_add_f32 v101, v101, v5
  v_lshlrev_b32 v4, 16, v79
  v_and_b32 v5, s36, v79
  v_add_f32 v102, v102, v4
  v_add_f32 v103, v103, v5
  v_lshlrev_b32 v4, 16, v80
  v_and_b32 v5, s36, v80
  v_add_f32 v56, v56, v4
  v_add_f32 v57, v57, v5
  v_lshlrev_b32 v4, 16, v81
  v_and_b32 v5, s36, v81
  v_add_f32 v58, v58, v4
  v_add_f32 v59, v59, v5
  v_lshlrev_b32 v4, 16, v82
  v_and_b32 v5, s36, v82
  v_add_f32 v104, v104, v4
  v_add_f32 v105, v105, v5
  v_lshlrev_b32 v4, 16, v83
  v_and_b32 v5, s36, v83
  v_add_f32 v106, v106, v4
  v_add_f32 v107, v107, v5
  s_waitcnt vmcnt(3)
  v_lshlrev_b32 v4, 16, v84
  v_and_b32 v5, s36, v84
  v_add_f32 v48, v48, v4
  v_add_f32 v49, v49, v5
  v_lshlrev_b32 v4, 16, v85
  v_and_b32 v5, s36, v85
  v_add_f32 v50, v50, v4
  v_add_f32 v51, v51, v5
  v_lshlrev_b32 v4, 16, v86
  v_and_b32 v5, s36, v86
  v_add_f32 v96, v96, v4
  v_add_f32 v97, v97, v5
  v_lshlrev_b32 v4, 16, v87
  v_and_b32 v5, s36, v87
  v_add_f32 v98, v98, v4
  v_add_f32 v99, v99, v5
  v_lshlrev_b32 v4, 16, v88
  v_and_b32 v5, s36, v88
  v_add_f32 v52, v52, v4
  v_add_f32 v53, v53, v5
  v_lshlrev_b32 v4, 16, v89
  v_and_b32 v5, s36, v89
  v_add_f32 v54, v54, v4
  v_add_f32 v55, v55, v5
  v_lshlrev_b32 v4, 16, v90
  v_and_b32 v5, s36, v90
  v_add_f32 v100, v100, v4
  v_add_f32 v101, v101, v5
  v_lshlrev_b32 v4, 16, v91
  v_and_b32 v5, s36, v91
  v_add_f32 v102, v102, v4
  v_add_f32 v103, v103, v5
  v_lshlrev_b32 v4, 16, v92
  v_and_b32 v5, s36, v92
  v_add_f32 v56, v56, v4
  v_add_f32 v57, v57, v5
  v_lshlrev_b32 v4, 16, v93
  v_and_b32 v5, s36, v93
  v_add_f32 v58, v58, v4
  v_add_f32 v59, v59, v5
  v_lshlrev_b32 v4, 16, v94
  v_and_b32 v5, s36, v94
  v_add_f32 v104, v104, v4
  v_add_f32 v105, v105, v5
  v_lshlrev_b32 v4, 16, v95
  v_and_b32 v5, s36, v95
  v_add_f32 v106, v106, v4
  v_add_f32 v107, v107, v5
  s_waitcnt vmcnt(0)
  v_lshlrev_b32 v4, 16, v120
  v_and_b32 v5, s36, v120
  v_add_f32 v48, v48, v4
  v_add_f32 v49, v49, v5
  v_lshlrev_b32 v4, 16, v121
  v_and_b32 v5, s36, v121
  v_add_f32 v50, v50, v4
  v_add_f32 v51, v51, v5
  v_lshlrev_b32 v4, 16, v122
  v_and_b32 v5, s36, v122
  v_add_f32 v96, v96, v4
  v_add_f32 v97, v97, v5
  v_lshlrev_b32 v4, 16, v123
  v_and_b32 v5, s36, v123
  v_add_f32 v98, v98, v4
  v_add_f32 v99, v99, v5
  v_lshlrev_b32 v4, 16, v124
  v_and_b32 v5, s36, v124
  v_add_f32 v52, v52, v4
  v_add_f32 v53, v53, v5
  v_lshlrev_b32 v4, 16, v125
  v_and_b32 v5, s36, v125
  v_add_f32 v54, v54, v4
  v_add_f32 v55, v55, v5
  v_lshlrev_b32 v4, 16, v126
  v_and_b32 v5, s36, v126
  v_add_f32 v100, v100, v4
  v_add_f32 v101, v101, v5
  v_lshlrev_b32 v4, 16, v127
  v_and_b32 v5, s36, v127
  v_add_f32 v102, v102, v4
  v_add_f32 v103, v103, v5
  v_lshlrev_b32 v4, 16, v128
  v_and_b32 v5, s36, v128
  v_add_f32 v56, v56, v4
  v_add_f32 v57, v57, v5
  v_lshlrev_b32 v4, 16, v129
  v_and_b32 v5, s36, v129
  v_add_f32 v58, v58, v4
  v_add_f32 v59, v59, v5
  v_lshlrev_b32 v4, 16, v130
  v_and_b32 v5, s36, v130
  v_add_f32 v104, v104, v4
  v_add_f32 v105, v105, v5
  v_lshlrev_b32 v4, 16, v131
  v_and_b32 v5, s36, v131
  v_add_f32 v106, v106, v4
  v_add_f32 v107, v107, v5
  v_cvt_pk_bf16_f32 v48, v48, v49
  v_cvt_pk_bf16_f32 v49, v50, v51
  buffer_store_dwordx2 v[48:49], v3, s[8:11], s54 offen offset:0
  v_cvt_pk_bf16_f32 v52, v52, v53
  v_cvt_pk_bf16_f32 v53, v54, v55
  buffer_store_dwordx2 v[52:53], v3, s[8:11], s54 offen offset:32
  v_cvt_pk_bf16_f32 v56, v56, v57
  v_cvt_pk_bf16_f32 v57, v58, v59
  buffer_store_dwordx2 v[56:57], v3, s[8:11], s54 offen offset:64
  v_cvt_pk_bf16_f32 v96, v96, v97
  v_cvt_pk_bf16_f32 v97, v98, v99
  buffer_store_dwordx2 v[96:97], v3, s[8:11], s55 offen offset:0
  v_cvt_pk_bf16_f32 v100, v100, v101
  v_cvt_pk_bf16_f32 v101, v102, v103
  buffer_store_dwordx2 v[100:101], v3, s[8:11], s55 offen offset:32
  v_cvt_pk_bf16_f32 v104, v104, v105
  v_cvt_pk_bf16_f32 v105, v106, v107
  buffer_store_dwordx2 v[104:105], v3, s[8:11], s55 offen offset:64
  s_branch T_FIN
T_CONV:
  s_and_b32 s34, s2, 7
  s_mul_i32 s29, s34, 9
  s_lshr_b32 s35, s2, 3
  s_sub_u32 s35, s35, 24
  s_add_u32 s29, s29, s35
  s_mul_i32 s40, s34, 72
  s_add_u32 s40, s40, 64
  s_add_u32 s40, s40, s35
  s_mul_i32 s31, s28, 12992
  s_lshl_b32 s30, s29, 3
  s_add_u32 s30, s30, s28
  s_lshl_b32 s32, s30, 12
  s_lshl_b32 s41, s40, 12
  v_add_u32 v3, 2, v2
  s_waitcnt lgkmcnt(0)
  s_mov_b32 s8, s52
  s_mov_b32 s9, s53
  s_mov_b32 s10, 2359296
  s_mov_b32 s11, 0x20000
  s_mov_b32 s12, s54
  s_mov_b32 s13, s55
  s_mov_b32 s14, 1152
  s_mov_b32 s15, 0x20000
  s_mov_b32 s16, s46
  s_mov_b32 s17, s47
  s_mov_b32 s18, 4718592
  s_mov_b32 s19, 0x20000
  s_mov_b32 s20, s44
  s_mov_b32 s21, s45
  s_mov_b32 s22, 4718592
  s_mov_b32 s23, 0x20000
  s_load_dwordx2 s[24:25], s[90:91], 0
  s_mov_b32 s26, 2359296
  s_mov_b32 s27, 0x20000
  s_cmp_lg_u32 s28, 7
  s_cbranch_scc1 T_P3_G
  v_cmp_ne_u32 vcc, s62, v40
  v_cmp_ne_u32 s[58:59], s63, v41
  s_or_b64 vcc, vcc, s[58:59]
  v_cmp_ne_u32 s[58:59], s62, v42
  s_or_b64 vcc, vcc, s[58:59]
  v_cmp_ne_u32 s[58:59], s63, v43
  s_or_b64 vcc, vcc, s[58:59]
  v_cmp_ne_u32 s[58:59], s62, v44
  s_or_b64 vcc, vcc, s[58:59]
  v_cmp_ne_u32 s[58:59], s63, v45
  s_or_b64 vcc, vcc, s[58:59]
  v_cmp_ne_u32 s[58:59], s62, v46
  s_or_b64 vcc, vcc, s[58:59]
  v_cmp_ne_u32 s[58:59], s63, v47
  s_or_b64 vcc, vcc, s[58:59]
  s_cmp_eq_u64 vcc, 0
  s_cbranch_scc1 T_P3_G
  v_lshlrev_b32 v4, 7, v1
  s_mov_b32 s39, 131072000
  s_mov_b32 s61, 0x40000
T_P3:
  buffer_load_dwordx2 v[16:17], v4, s[4:7], s39 offen sc0 sc1
  s_add_u32 s34, s39, 8192
  buffer_load_dwordx2 v[18:19], v4, s[4:7], s34 offen sc0 sc1
  s_add_u32 s34, s39, 16384
  buffer_load_dwordx2 v[20:21], v4, s[4:7], s34 offen sc0 sc1
  s_add_u32 s34, s39, 24576
  buffer_load_dwordx2 v[22:23], v4, s[4:7], s34 offen sc0 sc1
  s_waitcnt vmcnt(0)
  v_cmp_ne_u32 vcc, s62, v16
  v_cmp_ne_u32 s[58:59], s63, v17
  s_or_b64 vcc, vcc, s[58:59]
  v_cmp_ne_u32 s[58:59], s62, v18
  s_or_b64 vcc, vcc, s[58:59]
  v_cmp_ne_u32 s[58:59], s63, v19
  s_or_b64 vcc, vcc, s[58:59]
  v_cmp_ne_u32 s[58:59], s62, v20
  s_or_b64 vcc, vcc, s[58:59]
  v_cmp_ne_u32 s[58:59], s63, v21
  s_or_b64 vcc, vcc, s[58:59]
  v_cmp_ne_u32 s[58:59], s62, v22
  s_or_b64 vcc, vcc, s[58:59]
  v_cmp_ne_u32 s[58:59], s63, v23
  s_or_b64 vcc, vcc, s[58:59]
  s_cmp_eq_u64 vcc, 0
  s_cbranch_scc1 T_P3_G
  s_sleep 1
  s_sub_u32 s61, s61, 1
  s_cmp_lg_u32 s61, 0
  s_cbranch_scc1 T_P3
T_P3_G:
  s_waitcnt vmcnt(0)
  s_barrier
  s_cmp_lg_u32 s28, 0
  s_cbranch_scc1 T_NS1
  v_mov_b32 v12, s62
  v_mov_b32 v13, s63
  s_mov_b64 exec, 1
  buffer_store_dwordx2 v[12:13], v14, s[4:7], s60 offen sc0 sc1
  s_mov_b64 exec, -1
T_NS1:
  s_add_u32 s33, s32, 100663296
  s_mov_b32 m0, s31
  s_nop 0
  buffer_load_dwordx4 v2, s[4:7], s33 offen offset:0 sc1 lds
  buffer_load_dwordx4 v2, s[4:7], s33 offen offset:1024 sc1 lds
  buffer_load_dwordx4 v2, s[4:7], s33 offen offset:2048 sc1 lds
  buffer_load_dwordx4 v2, s[4:7], s33 offen offset:3072 sc1 lds
  s_add_u32 m0, s31, 4640
  s_nop 0
  buffer_load_dwordx4 v2, s[8:11], s32 offen offset:0 lds
  buffer_load_dwordx4 v2, s[8:11], s32 offen offset:1024 lds
  buffer_load_dwordx4 v2, s[8:11], s32 offen offset:2048 lds
  buffer_load_dwordx4 v2, s[8:11], s32 offen offset:3072 lds
  s_add_u32 m0, s31, 8800
  s_nop 0
  buffer_load_dwordx4 v3, s[8:11], s32 offen offset:0 lds
  buffer_load_dwordx4 v3, s[8:11], s32 offen offset:1024 lds
  buffer_load_dwordx4 v3, s[8:11], s32 offen offset:2048 lds
  buffer_load_dwordx4 v3, s[8:11], s32 offen offset:3072 lds
  s_lshl_b32 s34, s30, 1
  buffer_load_ushort v5, v14, s[12:15], s34 offen
  buffer_load_ushort v6, v14, s[8:11], s32 offen
  buffer_load_ushort v7, v14, s[8:11], s32 offen offset:4094
  v_and_b32 v8, 15, v1
  v_lshrrev_b32 v9, 4, v1
  v_lshlrev_b32 v10, 5, v8
  v_lshl_add_u32 v10, v9, 3, v10
  v_and_b32 v24, 1, v8
  v_add_u32 v25, v8, v24
  v_lshl_add_u32 v25, v9, 3, v25
  v_lshlrev_b32 v25, 1, v25
  v_mul_u32_u24 v24, 4160, v24
  v_sub_u32 v25, v25, v24
  s_add_u32 s34, s31, 8768
  v_add_u32 v28, s34, v25
  v_add_u32 v29, 1024, v28
  v_add_u32 v30, 2048, v28
  v_add_u32 v31, 3072, v28
  v_lshlrev_b32 v24, 5, v8
  v_lshlrev_b32 v25, 4, v9
  v_sub_u32 v25, v25, v24
  s_add_u32 s34, s31, 480
  v_add_u32 v32, s34, v25
  v_lshl_add_u32 v33, v9, 3, v8
  v_sub_u32 v33, 15, v33
  v_bfe_u32 v34, v1, 2, 2
  v_mul_u32_u24 v34, 12992, v34
  v_lshl_add_u32 v34, v9, 5, v34
  v_and_b32 v25, 3, v1
  v_lshl_add_u32 v34, v25, 3, v34
  s_lshl_b32 s34, s28, 9
  s_add_u32 s34, s34, 4608
  v_add_u32 v34, s34, v34
  v_mul_u32_u24 v35, 2304, v1
  v_mov_b32 v24, 0
  v_mov_b32 v25, 0
  v_lshlrev_b32 v11, 3, v1
  v_add_u32 v11, s31, v11
  ds_write_b64 v11, v[24:25] offset:4096
  s_mov_b64 exec, 15
  ds_write_b64 v11, v[24:25] offset:4608
  ds_write_b64 v11, v[24:25] offset:8768
  s_mov_b64 exec, -1
  s_cmp_lg_u32 s28, 2
  s_cbranch_scc1 T_XZ0
  v_lshlrev_b32 v4, 3, v1
  v_add_u32 v4, 103936, v4
  ds_write_b64 v4, v[24:25] offset:4096
  s_mov_b64 exec, 15
  ds_write_b64 v4, v[24:25] offset:4608
  ds_write_b64 v4, v[24:25] offset:8768
  s_mov_b64 exec, -1
T_XZ0:
  s_waitcnt vmcnt(0)
  v_mov_b32 v24, s31
  ds_write_b16 v24, v6 offset:8798
  ds_write_b16 v24, v7 offset:12892
  ds_read_b128 a[32:35], v32 offset:3584
  ds_read2_b32 a[0:1], v28 offset0:0 offset1:1
  ds_read2_b32 a[2:3], v28 offset0:2 offset1:3
  ds_read_b128 a[36:39], v32 offset:3072
  ds_read2_b32 a[4:5], v28 offset0:128 offset1:129
  ds_read2_b32 a[6:7], v28 offset0:130 offset1:131
  ds_read_b128 a[40:43], v32 offset:2560
  ds_read2_b32 a[8:9], v29 offset0:0 offset1:1
  ds_read2_b32 a[10:11], v29 offset0:2 offset1:3
  ds_read_b128 a[44:47], v32 offset:2048
  ds_read2_b32 a[12:13], v29 offset0:128 offset1:129
  ds_read2_b32 a[14:15], v29 offset0:130 offset1:131
  ds_read_b128 a[48:51], v32 offset:1536
  ds_read2_b32 a[16:17], v30 offset0:0 offset1:1
  ds_read2_b32 a[18:19], v30 offset0:2 offset1:3
  ds_read_b128 a[52:55], v32 offset:1024
  ds_read2_b32 a[20:21], v30 offset0:128 offset1:129
  ds_read2_b32 a[22:23], v30 offset0:130 offset1:131
  ds_read_b128 a[56:59], v32 offset:512
  ds_read2_b32 a[24:25], v31 offset0:0 offset1:1
  ds_read2_b32 a[26:27], v31 offset0:2 offset1:3
  ds_read_b128 a[60:63], v32 offset:0
  ds_read2_b32 a[28:29], v31 offset0:128 offset1:129
  ds_read2_b32 a[30:31], v31 offset0:130 offset1:131
  v_lshlrev_b32 v25, 16, v5
  v_cmp_eq_u32 s[36:37], 0, v33
  v_cmp_eq_u32 vcc, 1, v33
  s_nop 1
  v_cndmask_b32 v120, 0, v5, s[36:37]
  v_cndmask_b32 v120, v120, v25, vcc
  v_cmp_eq_u32 s[36:37], 2, v33
  v_cmp_eq_u32 vcc, 3, v33
  s_nop 1
  v_cndmask_b32 v121, 0, v5, s[36:37]
  v_cndmask_b32 v121, v121, v25, vcc
  v_cmp_eq_u32 s[36:37], 4, v33
  v_cmp_eq_u32 vcc, 5, v33
  s_nop 1
  v_cndmask_b32 v122, 0, v5, s[36:37]
  v_cndmask_b32 v122, v122, v25, vcc
  v_cmp_eq_u32 s[36:37], 6, v33
  v_cmp_eq_u32 vcc, 7, v33
  s_nop 1
  v_cndmask_b32 v123, 0, v5, s[36:37]
  v_cndmask_b32 v123, v123, v25, vcc
  s_waitcnt lgkmcnt(0)
  v_mfma_f32_16x16x32_bf16 v[56:59], a[0:3], a[32:35], 0
  ds_read_b128 a[96:99], v32 offset:3648
  v_mfma_f32_16x16x32_bf16 v[56:59], v[120:123], a[32:35], v[56:59]
  ds_read2_b32 a[64:65], v28 offset0:16 offset1:17
  v_mfma_f32_16x16x32_bf16 v[60:63], a[4:7], a[32:35], 0
  v_mfma_f32_16x16x32_bf16 v[60:63], a[0:3], a[36:39], v[60:63]
  ds_read2_b32 a[66:67], v28 offset0:18 offset1:19
  v_mfma_f32_16x16x32_bf16 v[60:63], v[120:123], a[36:39], v[60:63]
  v_mfma_f32_16x16x32_bf16 v[64:67], a[8:11], a[32:35], 0
  ds_read_b128 a[100:103], v32 offset:3136
  v_mfma_f32_16x16x32_bf16 v[64:67], a[4:7], a[36:39], v[64:67]
  v_mfma_f32_16x16x32_bf16 v[64:67], a[0:3], a[40:43], v[64:67]
  ds_read2_b32 a[68:69], v28 offset0:144 offset1:145
  v_mfma_f32_16x16x32_bf16 v[64:67], v[120:123], a[40:43], v[64:67]
  v_mfma_f32_16x16x32_bf16 v[68:71], a[12:15], a[32:35], 0
  ds_read2_b32 a[70:71], v28 offset0:146 offset1:147
  v_mfma_f32_16x16x32_bf16 v[68:71], a[8:11], a[36:39], v[68:71]
  v_mfma_f32_16x16x32_bf16 v[68:71], a[4:7], a[40:43], v[68:71]
  ds_read_b128 a[104:107], v32 offset:2624
  v_mfma_f32_16x16x32_bf16 v[68:71], a[0:3], a[44:47], v[68:71]
  ds_read2_b32 a[72:73], v29 offset0:16 offset1:17
  v_mfma_f32_16x16x32_bf16 v[68:71], v[120:123], a[44:47], v[68:71]
  v_mfma_f32_16x16x32_bf16 v[72:75], a[16:19], a[32:35], 0
  ds_read2_b32 a[74:75], v29 offset0:18 offset1:19
  v_mfma_f32_16x16x32_bf16 v[72:75], a[12:15], a[36:39], v[72:75]
  v_mfma_f32_16x16x32_bf16 v[72:75], a[8:11], a[40:43], v[72:75]
  ds_read_b128 a[108:111], v32 offset:2112
  v_mfma_f32_16x16x32_bf16 v[72:75], a[4:7], a[44:47], v[72:75]
  v_mfma_f32_16x16x32_bf16 v[72:75], a[0:3], a[48:51], v[72:75]
  ds_read2_b32 a[76:77], v29 offset0:144 offset1:145
  v_mfma_f32_16x16x32_bf16 v[72:75], v[120:123], a[48:51], v[72:75]
  v_mfma_f32_16x16x32_bf16 v[76:79], a[20:23], a[32:35], 0
  ds_read2_b32 a[78:79], v29 offset0:146 offset1:147
  v_mfma_f32_16x16x32_bf16 v[76:79], a[16:19], a[36:39], v[76:79]
  v_mfma_f32_16x16x32_bf16 v[76:79], a[12:15], a[40:43], v[76:79]
  ds_read_b128 v[136:139], v32 offset:1600
  v_mfma_f32_16x16x32_bf16 v[76:79], a[8:11], a[44:47], v[76:79]
  ds_read2_b32 a[80:81], v30 offset0:16 offset1:17
  v_mfma_f32_16x16x32_bf16 v[76:79], a[4:7], a[48:51], v[76:79]
  v_mfma_f32_16x16x32_bf16 v[76:79], a[0:3], a[52:55], v[76:79]
  ds_read2_b32 a[82:83], v30 offset0:18 offset1:19
  v_mfma_f32_16x16x32_bf16 v[76:79], v[120:123], a[52:55], v[76:79]
  v_mfma_f32_16x16x32_bf16 v[80:83], a[24:27], a[32:35], 0
  ds_read_b128 v[140:143], v32 offset:1088
  v_mfma_f32_16x16x32_bf16 v[80:83], a[20:23], a[36:39], v[80:83]
  v_mfma_f32_16x16x32_bf16 v[80:83], a[16:19], a[40:43], v[80:83]
  ds_read2_b32 a[84:85], v30 offset0:144 offset1:145
  v_mfma_f32_16x16x32_bf16 v[80:83], a[12:15], a[44:47], v[80:83]
  v_mfma_f32_16x16x32_bf16 v[80:83], a[8:11], a[48:51], v[80:83]
  ds_read2_b32 a[86:87], v30 offset0:146 offset1:147
  v_mfma_f32_16x16x32_bf16 v[80:83], a[4:7], a[52:55], v[80:83]
  v_mfma_f32_16x16x32_bf16 v[80:83], a[0:3], a[56:59], v[80:83]
  ds_read_b128 v[16:19], v32 offset:576
  v_mfma_f32_16x16x32_bf16 v[80:83], v[120:123], a[56:59], v[80:83]
  ds_read2_b32 a[88:89], v31 offset0:16 offset1:17
  v_mfma_f32_16x16x32_bf16 v[84:87], a[28:31], a[32:35], 0
  v_mfma_f32_16x16x32_bf16 v[84:87], a[24:27], a[36:39], v[84:87]
  ds_read2_b32 a[90:91], v31 offset0:18 offset1:19
  v_mfma_f32_16x16x32_bf16 v[84:87], a[20:23], a[40:43], v[84:87]
  v_mfma_f32_16x16x32_bf16 v[84:87], a[16:19], a[44:47], v[84:87]
  ds_read_b128 v[20:23], v32 offset:64
  v_mfma_f32_16x16x32_bf16 v[84:87], a[12:15], a[48:51], v[84:87]
  v_mfma_f32_16x16x32_bf16 v[84:87], a[8:11], a[52:55], v[84:87]
  ds_read2_b32 a[92:93], v31 offset0:144 offset1:145
  v_mfma_f32_16x16x32_bf16 v[84:87], a[4:7], a[56:59], v[84:87]
  v_mfma_f32_16x16x32_bf16 v[84:87], a[0:3], a[60:63], v[84:87]
  ds_read2_b32 a[94:95], v31 offset0:146 offset1:147
  v_mfma_f32_16x16x32_bf16 v[84:87], v[120:123], a[60:63], v[84:87]
  s_cmp_gt_u32 s28, 2
  s_cbranch_scc1 T_XL
  s_cmp_eq_u32 s28, 1
  s_cbranch_scc1 T_XL1
  s_cmp_eq_u32 s28, 2
  s_cbranch_scc1 T_XL2
  s_mov_b32 m0, 103936
  s_add_u32 s34, s41, 100663296
  buffer_load_dwordx4 v2, s[4:7], s34 offen offset:0 sc1 lds
  buffer_load_dwordx4 v2, s[4:7], s34 offen offset:1024 sc1 lds
  buffer_load_dwordx4 v2, s[4:7], s34 offen offset:2048 sc1 lds
  buffer_load_dwordx4 v2, s[4:7], s34 offen offset:3072 sc1 lds
  s_branch T_XL
T_XL2:
  s_mov_b32 m0, 112736
  s_nop 0
  buffer_load_dwordx4 v3, s[8:11], s41 offen offset:0 lds
  buffer_load_dwordx4 v3, s[8:11], s41 offen offset:1024 lds
  buffer_load_dwordx4 v3, s[8:11], s41 offen offset:2048 lds
  buffer_load_dwordx4 v3, s[8:11], s41 offen offset:3072 lds
  s_branch T_XL
T_XL1:
  s_mov_b32 m0, 108576
  s_nop 0
  buffer_load_dwordx4 v2, s[8:11], s41 offen offset:0 lds
  buffer_load_dwordx4 v2, s[8:11], s41 offen offset:1024 lds
  buffer_load_dwordx4 v2, s[8:11], s41 offen offset:2048 lds
  buffer_load_dwordx4 v2, s[8:11], s41 offen offset:3072 lds
T_XL:
  s_lshl_b32 s34, s40, 1
  buffer_load_ushort v128, v14, s[12:15], s34 offen
  buffer_load_ushort v129, v14, s[8:11], s41 offen
  buffer_load_ushort v130, v14, s[8:11], s41 offen offset:4094
  v_mul_u32_u24 v4, 1152, v1
  s_mul_i32 s34, s28, 294912
  s_lshl_b32 s35, s29, 4
  s_add_u32 s35, s35, s34
  buffer_load_dwordx4 v[40:43], v4, s[24:27], s35 offen
  s_add_u32 s35, s35, 73728
  buffer_load_dwordx4 v[44:47], v4, s[24:27], s35 offen
  s_add_u32 s35, s35, 73728
  buffer_load_dwordx4 v[48:51], v4, s[24:27], s35 offen
  s_add_u32 s35, s35, 73728
  buffer_load_dwordx4 v[52:55], v4, s[24:27], s35 offen
  s_add_u32 s35, s35, 73728
  v_mul_u32_u24 v4, 576, v10
  s_lshl_b32 s35, s40, 1
  s_add_u32 s35, s35, s34
  buffer_load_ushort v132, v4, s[24:27], s35 offen offset:0
  buffer_load_ushort v133, v4, s[24:27], s35 offen offset:1152
  buffer_load_ushort v134, v4, s[24:27], s35 offen offset:2304
  buffer_load_ushort v135, v4, s[24:27], s35 offen offset:3456
  s_waitcnt lgkmcnt(0)
  v_mfma_f32_16x16x32_bf16 v[56:59], a[64:67], a[96:99], v[56:59]
  ds_read_b128 a[32:35], v32 offset:3712
  v_mfma_f32_16x16x32_bf16 v[60:63], a[68:71], a[96:99], v[60:63]
  ds_read2_b32 a[0:1], v28 offset0:32 offset1:33
  v_mfma_f32_16x16x32_bf16 v[60:63], a[64:67], a[100:103], v[60:63]
  v_mfma_f32_16x16x32_bf16 v[64:67], a[72:75], a[96:99], v[64:67]
  ds_read2_b32 a[2:3], v28 offset0:34 offset1:35
  v_mfma_f32_16x16x32_bf16 v[64:67], a[68:71], a[100:103], v[64:67]
  ds_read_b128 a[36:39], v32 offset:3200
  v_mfma_f32_16x16x32_bf16 v[64:67], a[64:67], a[104:107], v[64:67]
  v_mfma_f32_16x16x32_bf16 v[68:71], a[76:79], a[96:99], v[68:71]
  ds_read2_b32 a[4:5], v28 offset0:160 offset1:161
  v_mfma_f32_16x16x32_bf16 v[68:71], a[72:75], a[100:103], v[68:71]
  ds_read2_b32 a[6:7], v28 offset0:162 offset1:163
  v_mfma_f32_16x16x32_bf16 v[68:71], a[68:71], a[104:107], v[68:71]
  v_mfma_f32_16x16x32_bf16 v[68:71], a[64:67], a[108:111], v[68:71]
  ds_read_b128 a[40:43], v32 offset:2688
  v_mfma_f32_16x16x32_bf16 v[72:75], a[80:83], a[96:99], v[72:75]
  ds_read2_b32 a[8:9], v29 offset0:32 offset1:33
  v_mfma_f32_16x16x32_bf16 v[72:75], a[76:79], a[100:103], v[72:75]
  v_mfma_f32_16x16x32_bf16 v[72:75], a[72:75], a[104:107], v[72:75]
  ds_read2_b32 a[10:11], v29 offset0:34 offset1:35
  v_mfma_f32_16x16x32_bf16 v[72:75], a[68:71], a[108:111], v[72:75]
  ds_read_b128 a[44:47], v32 offset:2176
  v_mfma_f32_16x16x32_bf16 v[72:75], a[64:67], v[136:139], v[72:75]
  v_mfma_f32_16x16x32_bf16 v[76:79], a[84:87], a[96:99], v[76:79]
  ds_read2_b32 a[12:13], v29 offset0:160 offset1:161
  v_mfma_f32_16x16x32_bf16 v[76:79], a[80:83], a[100:103], v[76:79]
  ds_read2_b32 a[14:15], v29 offset0:162 offset1:163
  v_mfma_f32_16x16x32_bf16 v[76:79], a[76:79], a[104:107], v[76:79]
  v_mfma_f32_16x16x32_bf16 v[76:79], a[72:75], a[108:111], v[76:79]
  ds_read_b128 a[48:51], v32 offset:1664
  v_mfma_f32_16x16x32_bf16 v[76:79], a[68:71], v[136:139], v[76:79]
  ds_read2_b32 a[16:17], v30 offset0:32 offset1:33
  v_mfma_f32_16x16x32_bf16 v[76:79], a[64:67], v[140:143], v[76:79]
  v_mfma_f32_16x16x32_bf16 v[80:83], a[88:91], a[96:99], v[80:83]
  ds_read2_b32 a[18:19], v30 offset0:34 offset1:35
  v_mfma_f32_16x16x32_bf16 v[80:83], a[84:87], a[100:103], v[80:83]
  ds_read_b128 a[52:55], v32 offset:1152
  v_mfma_f32_16x16x32_bf16 v[80:83], a[80:83], a[104:107], v[80:83]
  v_mfma_f32_16x16x32_bf16 v[80:83], a[76:79], a[108:111], v[80:83]
  ds_read2_b32 a[20:21], v30 offset0:160 offset1:161
  v_mfma_f32_16x16x32_bf16 v[80:83], a[72:75], v[136:139], v[80:83]
  ds_read2_b32 a[22:23], v30 offset0:162 offset1:163
  v_mfma_f32_16x16x32_bf16 v[80:83], a[68:71], v[140:143], v[80:83]
  v_mfma_f32_16x16x32_bf16 v[80:83], a[64:67], v[16:19], v[80:83]
  ds_read_b128 a[56:59], v32 offset:640
  v_mfma_f32_16x16x32_bf16 v[84:87], a[92:95], a[96:99], v[84:87]
  ds_read2_b32 a[24:25], v31 offset0:32 offset1:33
  v_mfma_f32_16x16x32_bf16 v[84:87], a[88:91], a[100:103], v[84:87]
  v_mfma_f32_16x16x32_bf16 v[84:87], a[84:87], a[104:107], v[84:87]
  ds_read2_b32 a[26:27], v31 offset0:34 offset1:35
  v_mfma_f32_16x16x32_bf16 v[84:87], a[80:83], a[108:111], v[84:87]
  ds_read_b128 a[60:63], v32 offset:128
  v_mfma_f32_16x16x32_bf16 v[84:87], a[76:79], v[136:139], v[84:87]
  v_mfma_f32_16x16x32_bf16 v[84:87], a[72:75], v[140:143], v[84:87]
  ds_read2_b32 a[28:29], v31 offset0:160 offset1:161
  v_mfma_f32_16x16x32_bf16 v[84:87], a[68:71], v[16:19], v[84:87]
  ds_read2_b32 a[30:31], v31 offset0:162 offset1:163
  v_mfma_f32_16x16x32_bf16 v[84:87], a[64:67], v[20:23], v[84:87]
  s_waitcnt lgkmcnt(0)
  v_mfma_f32_16x16x32_bf16 v[56:59], a[0:3], a[32:35], v[56:59]
  ds_read_b128 a[96:99], v32 offset:3776
  v_mfma_f32_16x16x32_bf16 v[60:63], a[4:7], a[32:35], v[60:63]
  ds_read2_b32 a[64:65], v28 offset0:48 offset1:49
  v_mfma_f32_16x16x32_bf16 v[60:63], a[0:3], a[36:39], v[60:63]
  v_mfma_f32_16x16x32_bf16 v[64:67], a[8:11], a[32:35], v[64:67]
  ds_read2_b32 a[66:67], v28 offset0:50 offset1:51
  v_mfma_f32_16x16x32_bf16 v[64:67], a[4:7], a[36:39], v[64:67]
  ds_read_b128 a[100:103], v32 offset:3264
  v_mfma_f32_16x16x32_bf16 v[64:67], a[0:3], a[40:43], v[64:67]
  v_mfma_f32_16x16x32_bf16 v[68:71], a[12:15], a[32:35], v[68:71]
  ds_read2_b32 a[68:69], v28 offset0:176 offset1:177
  v_mfma_f32_16x16x32_bf16 v[68:71], a[8:11], a[36:39], v[68:71]
  ds_read2_b32 a[70:71], v28 offset0:178 offset1:179
  v_mfma_f32_16x16x32_bf16 v[68:71], a[4:7], a[40:43], v[68:71]
  v_mfma_f32_16x16x32_bf16 v[68:71], a[0:3], a[44:47], v[68:71]
  ds_read_b128 a[104:107], v32 offset:2752
  v_mfma_f32_16x16x32_bf16 v[72:75], a[16:19], a[32:35], v[72:75]
  ds_read2_b32 a[72:73], v29 offset0:48 offset1:49
  v_mfma_f32_16x16x32_bf16 v[72:75], a[12:15], a[36:39], v[72:75]
  v_mfma_f32_16x16x32_bf16 v[72:75], a[8:11], a[40:43], v[72:75]
  ds_read2_b32 a[74:75], v29 offset0:50 offset1:51
  v_mfma_f32_16x16x32_bf16 v[72:75], a[4:7], a[44:47], v[72:75]
  ds_read_b128 a[108:111], v32 offset:2240
  v_mfma_f32_16x16x32_bf16 v[72:75], a[0:3], a[48:51], v[72:75]
  v_mfma_f32_16x16x32_bf16 v[76:79], a[20:23], a[32:35], v[76:79]
  ds_read2_b32 a[76:77], v29 offset0:176 offset1:177
  v_mfma_f32_16x16x32_bf16 v[76:79], a[16:19], a[36:39], v[76:79]
  ds_read2_b32 a[78:79], v29 offset0:178 offset1:179
  v_mfma_f32_16x16x32_bf16 v[76:79], a[12:15], a[40:43], v[76:79]
  v_mfma_f32_16x16x32_bf16 v[76:79], a[8:11], a[44:47], v[76:79]
  ds_read_b128 v[136:139], v32 offset:1728
  v_mfma_f32_16x16x32_bf16 v[76:79], a[4:7], a[48:51], v[76:79]
  ds_read2_b32 a[80:81], v30 offset0:48 offset1:49
  v_mfma_f32_16x16x32_bf16 v[76:79], a[0:3], a[52:55], v[76:79]
  v_mfma_f32_16x16x32_bf16 v[80:83], a[24:27], a[32:35], v[80:83]
  ds_read2_b32 a[82:83], v30 offset0:50 offset1:51
  v_mfma_f32_16x16x32_bf16 v[80:83], a[20:23], a[36:39], v[80:83]
  ds_read_b128 v[140:143], v32 offset:1216
  v_mfma_f32_16x16x32_bf16 v[80:83], a[16:19], a[40:43], v[80:83]
  v_mfma_f32_16x16x32_bf16 v[80:83], a[12:15], a[44:47], v[80:83]
  ds_read2_b32 a[84:85], v30 offset0:176 offset1:177
  v_mfma_f32_16x16x32_bf16 v[80:83], a[8:11], a[48:51], v[80:83]
  ds_read2_b32 a[86:87], v30 offset0:178 offset1:179
  v_mfma_f32_16x16x32_bf16 v[80:83], a[4:7], a[52:55], v[80:83]
  v_mfma_f32_16x16x32_bf16 v[80:83], a[0:3], a[56:59], v[80:83]
  ds_read_b128 v[16:19], v32 offset:704
  v_mfma_f32_16x16x32_bf16 v[84:87], a[28:31], a[32:35], v[84:87]
  ds_read2_b32 a[88:89], v31 offset0:48 offset1:49
  v_mfma_f32_16x16x32_bf16 v[84:87], a[24:27], a[36:39], v[84:87]
  v_mfma_f32_16x16x32_bf16 v[84:87], a[20:23], a[40:43], v[84:87]
  ds_read2_b32 a[90:91], v31 offset0:50 offset1:51
  v_mfma_f32_16x16x32_bf16 v[84:87], a[16:19], a[44:47], v[84:87]
  ds_read_b128 v[20:23], v32 offset:192
  v_mfma_f32_16x16x32_bf16 v[84:87], a[12:15], a[48:51], v[84:87]
  v_mfma_f32_16x16x32_bf16 v[84:87], a[8:11], a[52:55], v[84:87]
  ds_read2_b32 a[92:93], v31 offset0:176 offset1:177
  v_mfma_f32_16x16x32_bf16 v[84:87], a[4:7], a[56:59], v[84:87]
  ds_read2_b32 a[94:95], v31 offset0:178 offset1:179
  v_mfma_f32_16x16x32_bf16 v[84:87], a[0:3], a[60:63], v[84:87]
  s_waitcnt lgkmcnt(0)
  v_mfma_f32_16x16x32_bf16 v[56:59], a[64:67], a[96:99], v[56:59]
  ds_read_b128 a[32:35], v32 offset:3840
  v_mfma_f32_16x16x32_bf16 v[60:63], a[68:71], a[96:99], v[60:63]
  ds_read2_b32 a[0:1], v28 offset0:64 offset1:65
  v_mfma_f32_16x16x32_bf16 v[60:63], a[64:67], a[100:103], v[60:63]
  v_mfma_f32_16x16x32_bf16 v[64:67], a[72:75], a[96:99], v[64:67]
  ds_read2_b32 a[2:3], v28 offset0:66 offset1:67
  v_mfma_f32_16x16x32_bf16 v[64:67], a[68:71], a[100:103], v[64:67]
  ds_read_b128 a[36:39], v32 offset:3328
  v_mfma_f32_16x16x32_bf16 v[64:67], a[64:67], a[104:107], v[64:67]
  v_mfma_f32_16x16x32_bf16 v[68:71], a[76:79], a[96:99], v[68:71]
  ds_read2_b32 a[4:5], v28 offset0:192 offset1:193
  v_mfma_f32_16x16x32_bf16 v[68:71], a[72:75], a[100:103], v[68:71]
  ds_read2_b32 a[6:7], v28 offset0:194 offset1:195
  v_mfma_f32_16x16x32_bf16 v[68:71], a[68:71], a[104:107], v[68:71]
  v_mfma_f32_16x16x32_bf16 v[68:71], a[64:67], a[108:111], v[68:71]
  ds_read_b128 a[40:43], v32 offset:2816
  v_mfma_f32_16x16x32_bf16 v[72:75], a[80:83], a[96:99], v[72:75]
  ds_read2_b32 a[8:9], v29 offset0:64 offset1:65
  v_mfma_f32_16x16x32_bf16 v[72:75], a[76:79], a[100:103], v[72:75]
  v_mfma_f32_16x16x32_bf16 v[72:75], a[72:75], a[104:107], v[72:75]
  ds_read2_b32 a[10:11], v29 offset0:66 offset1:67
  v_mfma_f32_16x16x32_bf16 v[72:75], a[68:71], a[108:111], v[72:75]
  ds_read_b128 a[44:47], v32 offset:2304
  v_mfma_f32_16x16x32_bf16 v[72:75], a[64:67], v[136:139], v[72:75]
  v_mfma_f32_16x16x32_bf16 v[76:79], a[84:87], a[96:99], v[76:79]
  ds_read2_b32 a[12:13], v29 offset0:192 offset1:193
  v_mfma_f32_16x16x32_bf16 v[76:79], a[80:83], a[100:103], v[76:79]
  ds_read2_b32 a[14:15], v29 offset0:194 offset1:195
  v_mfma_f32_16x16x32_bf16 v[76:79], a[76:79], a[104:107], v[76:79]
  v_mfma_f32_16x16x32_bf16 v[76:79], a[72:75], a[108:111], v[76:79]
  ds_read_b128 a[48:51], v32 offset:1792
  v_mfma_f32_16x16x32_bf16 v[76:79], a[68:71], v[136:139], v[76:79]
  ds_read2_b32 a[16:17], v30 offset0:64 offset1:65
  v_mfma_f32_16x16x32_bf16 v[76:79], a[64:67], v[140:143], v[76:79]
  v_mfma_f32_16x16x32_bf16 v[80:83], a[88:91], a[96:99], v[80:83]
  ds_read2_b32 a[18:19], v30 offset0:66 offset1:67
  v_mfma_f32_16x16x32_bf16 v[80:83], a[84:87], a[100:103], v[80:83]
  ds_read_b128 a[52:55], v32 offset:1280
  v_mfma_f32_16x16x32_bf16 v[80:83], a[80:83], a[104:107], v[80:83]
  v_mfma_f32_16x16x32_bf16 v[80:83], a[76:79], a[108:111], v[80:83]
  ds_read2_b32 a[20:21], v30 offset0:192 offset1:193
  v_mfma_f32_16x16x32_bf16 v[80:83], a[72:75], v[136:139], v[80:83]
  ds_read2_b32 a[22:23], v30 offset0:194 offset1:195
  v_mfma_f32_16x16x32_bf16 v[80:83], a[68:71], v[140:143], v[80:83]
  v_mfma_f32_16x16x32_bf16 v[80:83], a[64:67], v[16:19], v[80:83]
  ds_read_b128 a[56:59], v32 offset:768
  v_mfma_f32_16x16x32_bf16 v[84:87], a[92:95], a[96:99], v[84:87]
  ds_read2_b32 a[24:25], v31 offset0:64 offset1:65
  v_mfma_f32_16x16x32_bf16 v[84:87], a[88:91], a[100:103], v[84:87]
  v_mfma_f32_16x16x32_bf16 v[84:87], a[84:87], a[104:107], v[84:87]
  ds_read2_b32 a[26:27], v31 offset0:66 offset1:67
  v_mfma_f32_16x16x32_bf16 v[84:87], a[80:83], a[108:111], v[84:87]
  ds_read_b128 a[60:63], v32 offset:256
  v_mfma_f32_16x16x32_bf16 v[84:87], a[76:79], v[136:139], v[84:87]
  v_mfma_f32_16x16x32_bf16 v[84:87], a[72:75], v[140:143], v[84:87]
  ds_read2_b32 a[28:29], v31 offset0:192 offset1:193
  v_mfma_f32_16x16x32_bf16 v[84:87], a[68:71], v[16:19], v[84:87]
  ds_read2_b32 a[30:31], v31 offset0:194 offset1:195
  v_mfma_f32_16x16x32_bf16 v[84:87], a[64:67], v[20:23], v[84:87]
  s_waitcnt lgkmcnt(0)
  v_mfma_f32_16x16x32_bf16 v[56:59], a[0:3], a[32:35], v[56:59]
  ds_read_b128 a[96:99], v32 offset:3904
  v_mfma_f32_16x16x32_bf16 v[60:63], a[4:7], a[32:35], v[60:63]
  ds_read2_b32 a[64:65], v28 offset0:80 offset1:81
  v_mfma_f32_16x16x32_bf16 v[60:63], a[0:3], a[36:39], v[60:63]
  v_mfma_f32_16x16x32_bf16 v[64:67], a[8:11], a[32:35], v[64:67]
  ds_read2_b32 a[66:67], v28 offset0:82 offset1:83
  v_mfma_f32_16x16x32_bf16 v[64:67], a[4:7], a[36:39], v[64:67]
  ds_read_b128 a[100:103], v32 offset:3392
  v_mfma_f32_16x16x32_bf16 v[64:67], a[0:3], a[40:43], v[64:67]
  v_mfma_f32_16x16x32_bf16 v[68:71], a[12:15], a[32:35], v[68:71]
  ds_read2_b32 a[68:69], v28 offset0:208 offset1:209
  v_mfma_f32_16x16x32_bf16 v[68:71], a[8:11], a[36:39], v[68:71]
  ds_read2_b32 a[70:71], v28 offset0:210 offset1:211
  v_mfma_f32_16x16x32_bf16 v[68:71], a[4:7], a[40:43], v[68:71]
  v_mfma_f32_16x16x32_bf16 v[68:71], a[0:3], a[44:47], v[68:71]
  ds_read_b128 a[104:107], v32 offset:2880
  v_mfma_f32_16x16x32_bf16 v[72:75], a[16:19], a[32:35], v[72:75]
  ds_read2_b32 a[72:73], v29 offset0:80 offset1:81
  v_mfma_f32_16x16x32_bf16 v[72:75], a[12:15], a[36:39], v[72:75]
  v_mfma_f32_16x16x32_bf16 v[72:75], a[8:11], a[40:43], v[72:75]
  ds_read2_b32 a[74:75], v29 offset0:82 offset1:83
  v_mfma_f32_16x16x32_bf16 v[72:75], a[4:7], a[44:47], v[72:75]
  ds_read_b128 a[108:111], v32 offset:2368
  v_mfma_f32_16x16x32_bf16 v[72:75], a[0:3], a[48:51], v[72:75]
  v_mfma_f32_16x16x32_bf16 v[76:79], a[20:23], a[32:35], v[76:79]
  ds_read2_b32 a[76:77], v29 offset0:208 offset1:209
  v_mfma_f32_16x16x32_bf16 v[76:79], a[16:19], a[36:39], v[76:79]
  ds_read2_b32 a[78:79], v29 offset0:210 offset1:211
  v_mfma_f32_16x16x32_bf16 v[76:79], a[12:15], a[40:43], v[76:79]
  v_mfma_f32_16x16x32_bf16 v[76:79], a[8:11], a[44:47], v[76:79]
  ds_read_b128 v[136:139], v32 offset:1856
  v_mfma_f32_16x16x32_bf16 v[76:79], a[4:7], a[48:51], v[76:79]
  ds_read2_b32 a[80:81], v30 offset0:80 offset1:81
  v_mfma_f32_16x16x32_bf16 v[76:79], a[0:3], a[52:55], v[76:79]
  v_mfma_f32_16x16x32_bf16 v[80:83], a[24:27], a[32:35], v[80:83]
  ds_read2_b32 a[82:83], v30 offset0:82 offset1:83
  v_mfma_f32_16x16x32_bf16 v[80:83], a[20:23], a[36:39], v[80:83]
  ds_read_b128 v[140:143], v32 offset:1344
  v_mfma_f32_16x16x32_bf16 v[80:83], a[16:19], a[40:43], v[80:83]
  v_mfma_f32_16x16x32_bf16 v[80:83], a[12:15], a[44:47], v[80:83]
  ds_read2_b32 a[84:85], v30 offset0:208 offset1:209
  v_mfma_f32_16x16x32_bf16 v[80:83], a[8:11], a[48:51], v[80:83]
  ds_read2_b32 a[86:87], v30 offset0:210 offset1:211
  v_mfma_f32_16x16x32_bf16 v[80:83], a[4:7], a[52:55], v[80:83]
  v_mfma_f32_16x16x32_bf16 v[80:83], a[0:3], a[56:59], v[80:83]
  ds_read_b128 v[16:19], v32 offset:832
  v_mfma_f32_16x16x32_bf16 v[84:87], a[28:31], a[32:35], v[84:87]
  ds_read2_b32 a[88:89], v31 offset0:80 offset1:81
  v_mfma_f32_16x16x32_bf16 v[84:87], a[24:27], a[36:39], v[84:87]
  v_mfma_f32_16x16x32_bf16 v[84:87], a[20:23], a[40:43], v[84:87]
  ds_read2_b32 a[90:91], v31 offset0:82 offset1:83
  v_mfma_f32_16x16x32_bf16 v[84:87], a[16:19], a[44:47], v[84:87]
  ds_read_b128 v[20:23], v32 offset:320
  v_mfma_f32_16x16x32_bf16 v[84:87], a[12:15], a[48:51], v[84:87]
  v_mfma_f32_16x16x32_bf16 v[84:87], a[8:11], a[52:55], v[84:87]
  ds_read2_b32 a[92:93], v31 offset0:208 offset1:209
  v_mfma_f32_16x16x32_bf16 v[84:87], a[4:7], a[56:59], v[84:87]
  ds_read2_b32 a[94:95], v31 offset0:210 offset1:211
  v_mfma_f32_16x16x32_bf16 v[84:87], a[0:3], a[60:63], v[84:87]
  s_waitcnt lgkmcnt(0)
  v_mfma_f32_16x16x32_bf16 v[56:59], a[64:67], a[96:99], v[56:59]
  ds_read_b128 a[32:35], v32 offset:3968
  v_mfma_f32_16x16x32_bf16 v[60:63], a[68:71], a[96:99], v[60:63]
  ds_read2_b32 a[0:1], v28 offset0:96 offset1:97
  v_mfma_f32_16x16x32_bf16 v[60:63], a[64:67], a[100:103], v[60:63]
  v_mfma_f32_16x16x32_bf16 v[64:67], a[72:75], a[96:99], v[64:67]
  ds_read2_b32 a[2:3], v28 offset0:98 offset1:99
  v_mfma_f32_16x16x32_bf16 v[64:67], a[68:71], a[100:103], v[64:67]
  ds_read_b128 a[36:39], v32 offset:3456
  v_mfma_f32_16x16x32_bf16 v[64:67], a[64:67], a[104:107], v[64:67]
  v_mfma_f32_16x16x32_bf16 v[68:71], a[76:79], a[96:99], v[68:71]
  ds_read2_b32 a[4:5], v28 offset0:224 offset1:225
  v_mfma_f32_16x16x32_bf16 v[68:71], a[72:75], a[100:103], v[68:71]
  ds_read2_b32 a[6:7], v28 offset0:226 offset1:227
  v_mfma_f32_16x16x32_bf16 v[68:71], a[68:71], a[104:107], v[68:71]
  v_mfma_f32_16x16x32_bf16 v[68:71], a[64:67], a[108:111], v[68:71]
  ds_read_b128 a[40:43], v32 offset:2944
  v_mfma_f32_16x16x32_bf16 v[72:75], a[80:83], a[96:99], v[72:75]
  ds_read2_b32 a[8:9], v29 offset0:96 offset1:97
  v_mfma_f32_16x16x32_bf16 v[72:75], a[76:79], a[100:103], v[72:75]
  v_mfma_f32_16x16x32_bf16 v[72:75], a[72:75], a[104:107], v[72:75]
  ds_read2_b32 a[10:11], v29 offset0:98 offset1:99
  v_mfma_f32_16x16x32_bf16 v[72:75], a[68:71], a[108:111], v[72:75]
  ds_read_b128 a[44:47], v32 offset:2432
  v_mfma_f32_16x16x32_bf16 v[72:75], a[64:67], v[136:139], v[72:75]
  v_mfma_f32_16x16x32_bf16 v[76:79], a[84:87], a[96:99], v[76:79]
  ds_read2_b32 a[12:13], v29 offset0:224 offset1:225
  v_mfma_f32_16x16x32_bf16 v[76:79], a[80:83], a[100:103], v[76:79]
  ds_read2_b32 a[14:15], v29 offset0:226 offset1:227
  v_mfma_f32_16x16x32_bf16 v[76:79], a[76:79], a[104:107], v[76:79]
  v_mfma_f32_16x16x32_bf16 v[76:79], a[72:75], a[108:111], v[76:79]
  ds_read_b128 a[48:51], v32 offset:1920
  v_mfma_f32_16x16x32_bf16 v[76:79], a[68:71], v[136:139], v[76:79]
  ds_read2_b32 a[16:17], v30 offset0:96 offset1:97
  v_mfma_f32_16x16x32_bf16 v[76:79], a[64:67], v[140:143], v[76:79]
  v_mfma_f32_16x16x32_bf16 v[80:83], a[88:91], a[96:99], v[80:83]
  ds_read2_b32 a[18:19], v30 offset0:98 offset1:99
  v_mfma_f32_16x16x32_bf16 v[80:83], a[84:87], a[100:103], v[80:83]
  ds_read_b128 a[52:55], v32 offset:1408
  v_mfma_f32_16x16x32_bf16 v[80:83], a[80:83], a[104:107], v[80:83]
  v_mfma_f32_16x16x32_bf16 v[80:83], a[76:79], a[108:111], v[80:83]
  ds_read2_b32 a[20:21], v30 offset0:224 offset1:225
  v_mfma_f32_16x16x32_bf16 v[80:83], a[72:75], v[136:139], v[80:83]
  ds_read2_b32 a[22:23], v30 offset0:226 offset1:227
  v_mfma_f32_16x16x32_bf16 v[80:83], a[68:71], v[140:143], v[80:83]
  v_mfma_f32_16x16x32_bf16 v[80:83], a[64:67], v[16:19], v[80:83]
  ds_read_b128 a[56:59], v32 offset:896
  v_mfma_f32_16x16x32_bf16 v[84:87], a[92:95], a[96:99], v[84:87]
  ds_read2_b32 a[24:25], v31 offset0:96 offset1:97
  v_mfma_f32_16x16x32_bf16 v[84:87], a[88:91], a[100:103], v[84:87]
  v_mfma_f32_16x16x32_bf16 v[84:87], a[84:87], a[104:107], v[84:87]
  ds_read2_b32 a[26:27], v31 offset0:98 offset1:99
  v_mfma_f32_16x16x32_bf16 v[84:87], a[80:83], a[108:111], v[84:87]
  ds_read_b128 a[60:63], v32 offset:384
  v_mfma_f32_16x16x32_bf16 v[84:87], a[76:79], v[136:139], v[84:87]
  v_mfma_f32_16x16x32_bf16 v[84:87], a[72:75], v[140:143], v[84:87]
  ds_read2_b32 a[28:29], v31 offset0:224 offset1:225
  v_mfma_f32_16x16x32_bf16 v[84:87], a[68:71], v[16:19], v[84:87]
  ds_read2_b32 a[30:31], v31 offset0:226 offset1:227
  v_mfma_f32_16x16x32_bf16 v[84:87], a[64:67], v[20:23], v[84:87]
  s_waitcnt lgkmcnt(0)
  v_mfma_f32_16x16x32_bf16 v[56:59], a[0:3], a[32:35], v[56:59]
  ds_read_b128 a[96:99], v32 offset:4032
  v_mfma_f32_16x16x32_bf16 v[60:63], a[4:7], a[32:35], v[60:63]
  ds_read2_b32 a[64:65], v28 offset0:112 offset1:113
  v_mfma_f32_16x16x32_bf16 v[60:63], a[0:3], a[36:39], v[60:63]
  v_mfma_f32_16x16x32_bf16 v[64:67], a[8:11], a[32:35], v[64:67]
  ds_read2_b32 a[66:67], v28 offset0:114 offset1:115
  v_mfma_f32_16x16x32_bf16 v[64:67], a[4:7], a[36:39], v[64:67]
  ds_read_b128 a[100:103], v32 offset:3520
  v_mfma_f32_16x16x32_bf16 v[64:67], a[0:3], a[40:43], v[64:67]
  v_mfma_f32_16x16x32_bf16 v[68:71], a[12:15], a[32:35], v[68:71]
  ds_read2_b32 a[68:69], v28 offset0:240 offset1:241
  v_mfma_f32_16x16x32_bf16 v[68:71], a[8:11], a[36:39], v[68:71]
  ds_read2_b32 a[70:71], v28 offset0:242 offset1:243
  v_mfma_f32_16x16x32_bf16 v[68:71], a[4:7], a[40:43], v[68:71]
  v_mfma_f32_16x16x32_bf16 v[68:71], a[0:3], a[44:47], v[68:71]
  ds_read_b128 a[104:107], v32 offset:3008
  v_mfma_f32_16x16x32_bf16 v[72:75], a[16:19], a[32:35], v[72:75]
  ds_read2_b32 a[72:73], v29 offset0:112 offset1:113
  v_mfma_f32_16x16x32_bf16 v[72:75], a[12:15], a[36:39], v[72:75]
  v_mfma_f32_16x16x32_bf16 v[72:75], a[8:11], a[40:43], v[72:75]
  ds_read2_b32 a[74:75], v29 offset0:114 offset1:115
  v_mfma_f32_16x16x32_bf16 v[72:75], a[4:7], a[44:47], v[72:75]
  ds_read_b128 a[108:111], v32 offset:2496
  v_mfma_f32_16x16x32_bf16 v[72:75], a[0:3], a[48:51], v[72:75]
  v_mfma_f32_16x16x32_bf16 v[76:79], a[20:23], a[32:35], v[76:79]
  ds_read2_b32 a[76:77], v29 offset0:240 offset1:241
  v_mfma_f32_16x16x32_bf16 v[76:79], a[16:19], a[36:39], v[76:79]
  ds_read2_b32 a[78:79], v29 offset0:242 offset1:243
  v_mfma_f32_16x16x32_bf16 v[76:79], a[12:15], a[40:43], v[76:79]
  v_mfma_f32_16x16x32_bf16 v[76:79], a[8:11], a[44:47], v[76:79]
  ds_read_b128 v[136:139], v32 offset:1984
  v_mfma_f32_16x16x32_bf16 v[76:79], a[4:7], a[48:51], v[76:79]
  ds_read2_b32 a[80:81], v30 offset0:112 offset1:113
  v_mfma_f32_16x16x32_bf16 v[76:79], a[0:3], a[52:55], v[76:79]
  v_mfma_f32_16x16x32_bf16 v[80:83], a[24:27], a[32:35], v[80:83]
  ds_read2_b32 a[82:83], v30 offset0:114 offset1:115
  v_mfma_f32_16x16x32_bf16 v[80:83], a[20:23], a[36:39], v[80:83]
  ds_read_b128 v[140:143], v32 offset:1472
  v_mfma_f32_16x16x32_bf16 v[80:83], a[16:19], a[40:43], v[80:83]
  v_mfma_f32_16x16x32_bf16 v[80:83], a[12:15], a[44:47], v[80:83]
  ds_read2_b32 a[84:85], v30 offset0:240 offset1:241
  v_mfma_f32_16x16x32_bf16 v[80:83], a[8:11], a[48:51], v[80:83]
  ds_read2_b32 a[86:87], v30 offset0:242 offset1:243
  v_mfma_f32_16x16x32_bf16 v[80:83], a[4:7], a[52:55], v[80:83]
  v_mfma_f32_16x16x32_bf16 v[80:83], a[0:3], a[56:59], v[80:83]
  ds_read_b128 v[16:19], v32 offset:960
  v_mfma_f32_16x16x32_bf16 v[84:87], a[28:31], a[32:35], v[84:87]
  ds_read2_b32 a[88:89], v31 offset0:112 offset1:113
  v_mfma_f32_16x16x32_bf16 v[84:87], a[24:27], a[36:39], v[84:87]
  v_mfma_f32_16x16x32_bf16 v[84:87], a[20:23], a[40:43], v[84:87]
  ds_read2_b32 a[90:91], v31 offset0:114 offset1:115
  v_mfma_f32_16x16x32_bf16 v[84:87], a[16:19], a[44:47], v[84:87]
  ds_read_b128 v[20:23], v32 offset:448
  v_mfma_f32_16x16x32_bf16 v[84:87], a[12:15], a[48:51], v[84:87]
  v_mfma_f32_16x16x32_bf16 v[84:87], a[8:11], a[52:55], v[84:87]
  ds_read2_b32 a[92:93], v31 offset0:240 offset1:241
  v_mfma_f32_16x16x32_bf16 v[84:87], a[4:7], a[56:59], v[84:87]
  ds_read2_b32 a[94:95], v31 offset0:242 offset1:243
  v_mfma_f32_16x16x32_bf16 v[84:87], a[0:3], a[60:63], v[84:87]
  s_waitcnt vmcnt(0)
  s_cmp_lg_u32 s28, 2
  s_cbranch_scc1 T_XZ
  v_mov_b32 v4, 103936
  ds_write_b16 v4, v129 offset:8798
  ds_write_b16 v4, v130 offset:12892
T_XZ:
  s_cmp_eq_u32 s28, 0
  s_cselect_b32 s34, -1, 0
  v_and_b32 v128, s34, v128
  v_lshlrev_b32 v25, 16, v128
  v_cmp_eq_u32 s[36:37], 0, v33
  v_cmp_eq_u32 vcc, 1, v33
  s_nop 1
  v_cndmask_b32 v124, 0, v128, s[36:37]
  v_cndmask_b32 v124, v124, v25, vcc
  v_cmp_eq_u32 s[36:37], 2, v33
  v_cmp_eq_u32 vcc, 3, v33
  s_nop 1
  v_cndmask_b32 v125, 0, v128, s[36:37]
  v_cndmask_b32 v125, v125, v25, vcc
  v_cmp_eq_u32 s[36:37], 4, v33
  v_cmp_eq_u32 vcc, 5, v33
  s_nop 1
  v_cndmask_b32 v126, 0, v128, s[36:37]
  v_cndmask_b32 v126, v126, v25, vcc
  v_cmp_eq_u32 s[36:37], 6, v33
  v_cmp_eq_u32 vcc, 7, v33
  s_nop 1
  v_cndmask_b32 v127, 0, v128, s[36:37]
  v_cndmask_b32 v127, v127, v25, vcc
  s_waitcnt lgkmcnt(0)
  s_barrier
  s_lshl_b32 s34, s28, 6
  s_add_u32 s34, s34, 103936
  s_sub_u32 s34, s34, s31
  v_add_u32 v28, s34, v28
  v_add_u32 v29, s34, v29
  v_add_u32 v30, s34, v30
  v_add_u32 v31, s34, v31
  v_add_u32 v32, s34, v32
  v_mfma_f32_16x16x32_bf16 v[56:59], a[64:67], a[96:99], v[56:59]
  ds_read_b128 a[32:35], v32 offset:3584
  v_mfma_f32_16x16x32_bf16 v[60:63], a[68:71], a[96:99], v[60:63]
  ds_read2_b32 a[0:1], v28 offset0:0 offset1:1
  v_mfma_f32_16x16x32_bf16 v[60:63], a[64:67], a[100:103], v[60:63]
  v_mfma_f32_16x16x32_bf16 v[64:67], a[72:75], a[96:99], v[64:67]
  ds_read2_b32 a[2:3], v28 offset0:2 offset1:3
  v_mfma_f32_16x16x32_bf16 v[64:67], a[68:71], a[100:103], v[64:67]
  ds_read_b128 a[36:39], v32 offset:3072
  v_mfma_f32_16x16x32_bf16 v[64:67], a[64:67], a[104:107], v[64:67]
  v_mfma_f32_16x16x32_bf16 v[68:71], a[76:79], a[96:99], v[68:71]
  ds_read2_b32 a[4:5], v28 offset0:128 offset1:129
  v_mfma_f32_16x16x32_bf16 v[68:71], a[72:75], a[100:103], v[68:71]
  ds_read2_b32 a[6:7], v28 offset0:130 offset1:131
  v_mfma_f32_16x16x32_bf16 v[68:71], a[68:71], a[104:107], v[68:71]
  v_mfma_f32_16x16x32_bf16 v[68:71], a[64:67], a[108:111], v[68:71]
  ds_read_b128 a[40:43], v32 offset:2560
  v_mfma_f32_16x16x32_bf16 v[72:75], a[80:83], a[96:99], v[72:75]
  ds_read2_b32 a[8:9], v29 offset0:0 offset1:1
  v_mfma_f32_16x16x32_bf16 v[72:75], a[76:79], a[100:103], v[72:75]
  v_mfma_f32_16x16x32_bf16 v[72:75], a[72:75], a[104:107], v[72:75]
  ds_read2_b32 a[10:11], v29 offset0:2 offset1:3
  v_mfma_f32_16x16x32_bf16 v[72:75], a[68:71], a[108:111], v[72:75]
  ds_read_b128 a[44:47], v32 offset:2048
  v_mfma_f32_16x16x32_bf16 v[72:75], a[64:67], v[136:139], v[72:75]
  v_mfma_f32_16x16x32_bf16 v[76:79], a[84:87], a[96:99], v[76:79]
  ds_read2_b32 a[12:13], v29 offset0:128 offset1:129
  v_mfma_f32_16x16x32_bf16 v[76:79], a[80:83], a[100:103], v[76:79]
  ds_read2_b32 a[14:15], v29 offset0:130 offset1:131
  v_mfma_f32_16x16x32_bf16 v[76:79], a[76:79], a[104:107], v[76:79]
  v_mfma_f32_16x16x32_bf16 v[76:79], a[72:75], a[108:111], v[76:79]
  ds_read_b128 a[48:51], v32 offset:1536
  v_mfma_f32_16x16x32_bf16 v[76:79], a[68:71], v[136:139], v[76:79]
  ds_read2_b32 a[16:17], v30 offset0:0 offset1:1
  v_mfma_f32_16x16x32_bf16 v[76:79], a[64:67], v[140:143], v[76:79]
  v_mfma_f32_16x16x32_bf16 v[80:83], a[88:91], a[96:99], v[80:83]
  ds_read2_b32 a[18:19], v30 offset0:2 offset1:3
  v_mfma_f32_16x16x32_bf16 v[80:83], a[84:87], a[100:103], v[80:83]
  ds_read_b128 a[52:55], v32 offset:1024
  v_mfma_f32_16x16x32_bf16 v[80:83], a[80:83], a[104:107], v[80:83]
  v_mfma_f32_16x16x32_bf16 v[80:83], a[76:79], a[108:111], v[80:83]
  ds_read2_b32 a[20:21], v30 offset0:128 offset1:129
  v_mfma_f32_16x16x32_bf16 v[80:83], a[72:75], v[136:139], v[80:83]
  ds_read2_b32 a[22:23], v30 offset0:130 offset1:131
  v_mfma_f32_16x16x32_bf16 v[80:83], a[68:71], v[140:143], v[80:83]
  v_mfma_f32_16x16x32_bf16 v[80:83], a[64:67], v[16:19], v[80:83]
  ds_read_b128 a[56:59], v32 offset:512
  v_mfma_f32_16x16x32_bf16 v[84:87], a[92:95], a[96:99], v[84:87]
  ds_read2_b32 a[24:25], v31 offset0:0 offset1:1
  v_mfma_f32_16x16x32_bf16 v[84:87], a[88:91], a[100:103], v[84:87]
  v_mfma_f32_16x16x32_bf16 v[84:87], a[84:87], a[104:107], v[84:87]
  ds_read2_b32 a[26:27], v31 offset0:2 offset1:3
  v_mfma_f32_16x16x32_bf16 v[84:87], a[80:83], a[108:111], v[84:87]
  ds_read_b128 a[60:63], v32 offset:0
  v_mfma_f32_16x16x32_bf16 v[84:87], a[76:79], v[136:139], v[84:87]
  v_mfma_f32_16x16x32_bf16 v[84:87], a[72:75], v[140:143], v[84:87]
  ds_read2_b32 a[28:29], v31 offset0:128 offset1:129
  v_mfma_f32_16x16x32_bf16 v[84:87], a[68:71], v[16:19], v[84:87]
  ds_read2_b32 a[30:31], v31 offset0:130 offset1:131
  v_mfma_f32_16x16x32_bf16 v[84:87], a[64:67], v[20:23], v[84:87]
  s_waitcnt lgkmcnt(0)
  v_mfma_f32_16x16x32_bf16 v[88:91], a[0:3], a[32:35], 0
  v_mfma_f32_16x16x32_bf16 v[88:91], v[124:127], a[32:35], v[88:91]
  v_mfma_f32_16x16x32_bf16 v[92:95], a[4:7], a[32:35], 0
  v_mfma_f32_16x16x32_bf16 v[92:95], a[0:3], a[36:39], v[92:95]
  v_mfma_f32_16x16x32_bf16 v[92:95], v[124:127], a[36:39], v[92:95]
  v_mfma_f32_16x16x32_bf16 v[96:99], a[8:11], a[32:35], 0
  v_mfma_f32_16x16x32_bf16 v[96:99], a[4:7], a[36:39], v[96:99]
  v_mfma_f32_16x16x32_bf16 v[96:99], a[0:3], a[40:43], v[96:99]
  v_mfma_f32_16x16x32_bf16 v[96:99], v[124:127], a[40:43], v[96:99]
  v_mfma_f32_16x16x32_bf16 v[100:103], a[12:15], a[32:35], 0
  v_mfma_f32_16x16x32_bf16 v[100:103], a[8:11], a[36:39], v[100:103]
  v_mfma_f32_16x16x32_bf16 v[100:103], a[4:7], a[40:43], v[100:103]
  v_mfma_f32_16x16x32_bf16 v[100:103], a[0:3], a[44:47], v[100:103]
  v_mfma_f32_16x16x32_bf16 v[100:103], v[124:127], a[44:47], v[100:103]
  v_mfma_f32_16x16x32_bf16 v[104:107], a[16:19], a[32:35], 0
  v_mfma_f32_16x16x32_bf16 v[104:107], a[12:15], a[36:39], v[104:107]
  v_mfma_f32_16x16x32_bf16 v[104:107], a[8:11], a[40:43], v[104:107]
  v_mfma_f32_16x16x32_bf16 v[104:107], a[4:7], a[44:47], v[104:107]
  v_mfma_f32_16x16x32_bf16 v[104:107], a[0:3], a[48:51], v[104:107]
  v_mfma_f32_16x16x32_bf16 v[104:107], v[124:127], a[48:51], v[104:107]
  v_mfma_f32_16x16x32_bf16 v[108:111], a[20:23], a[32:35], 0
  v_mfma_f32_16x16x32_bf16 v[108:111], a[16:19], a[36:39], v[108:111]
  v_mfma_f32_16x16x32_bf16 v[108:111], a[12:15], a[40:43], v[108:111]
  v_mfma_f32_16x16x32_bf16 v[108:111], a[8:11], a[44:47], v[108:111]
  v_mfma_f32_16x16x32_bf16 v[108:111], a[4:7], a[48:51], v[108:111]
  v_mfma_f32_16x16x32_bf16 v[108:111], a[0:3], a[52:55], v[108:111]
  v_mfma_f32_16x16x32_bf16 v[108:111], v[124:127], a[52:55], v[108:111]
  v_mfma_f32_16x16x32_bf16 v[112:115], a[24:27], a[32:35], 0
  v_mfma_f32_16x16x32_bf16 v[112:115], a[20:23], a[36:39], v[112:115]
  v_mfma_f32_16x16x32_bf16 v[112:115], a[16:19], a[40:43], v[112:115]
  v_mfma_f32_16x16x32_bf16 v[112:115], a[12:15], a[44:47], v[112:115]
  v_mfma_f32_16x16x32_bf16 v[112:115], a[8:11], a[48:51], v[112:115]
  v_mfma_f32_16x16x32_bf16 v[112:115], a[4:7], a[52:55], v[112:115]
  v_mfma_f32_16x16x32_bf16 v[112:115], a[0:3], a[56:59], v[112:115]
  v_mfma_f32_16x16x32_bf16 v[112:115], v[124:127], a[56:59], v[112:115]
  v_mfma_f32_16x16x32_bf16 v[116:119], a[28:31], a[32:35], 0
  v_mfma_f32_16x16x32_bf16 v[116:119], a[24:27], a[36:39], v[116:119]
  v_mfma_f32_16x16x32_bf16 v[116:119], a[20:23], a[40:43], v[116:119]
  v_mfma_f32_16x16x32_bf16 v[116:119], a[16:19], a[44:47], v[116:119]
  v_mfma_f32_16x16x32_bf16 v[116:119], a[12:15], a[48:51], v[116:119]
  v_mfma_f32_16x16x32_bf16 v[116:119], a[8:11], a[52:55], v[116:119]
  v_mfma_f32_16x16x32_bf16 v[116:119], a[4:7], a[56:59], v[116:119]
  v_mfma_f32_16x16x32_bf16 v[116:119], a[0:3], a[60:63], v[116:119]
  v_mfma_f32_16x16x32_bf16 v[116:119], v[124:127], a[60:63], v[116:119]
  s_mov_b32 s34, 0xffff0000
  s_add_u32 s35, s31, 4608
  v_add_u32 v11, s35, v10
  s_mul_i32 s35, s28, 4160
  s_add_u32 s35, s35, 116928
  v_add_u32 v15, s35, v10
  v_bfe_u32 v6, v1, 2, 2
  v_mul_u32_u24 v6, 4160, v6
  v_lshl_add_u32 v6, v9, 5, v6
  v_and_b32 v7, 3, v1
  v_lshl_add_u32 v6, v7, 3, v6
  s_lshl_b32 s35, s28, 9
  s_add_u32 s35, s35, 116928
  v_add_u32 v6, s35, v6
  v_cvt_pk_bf16_f32 v24, v56, v57
  v_cvt_pk_bf16_f32 v25, v58, v59
  v_lshlrev_b32 v4, 16, v24
  v_and_b32 v5, s34, v24
  v_sub_f32 v56, v56, v4
  v_sub_f32 v57, v57, v5
  v_lshlrev_b32 v4, 16, v25
  v_and_b32 v5, s34, v25
  v_sub_f32 v58, v58, v4
  v_sub_f32 v59, v59, v5
  ds_write_b64 v11, v[24:25] offset:0
  v_cvt_pk_bf16_f32 v56, v56, v57
  v_cvt_pk_bf16_f32 v57, v58, v59
  ds_write_b64 v15, v[56:57] offset:0
  v_cvt_pk_bf16_f32 v24, v60, v61
  v_cvt_pk_bf16_f32 v25, v62, v63
  v_lshlrev_b32 v4, 16, v24
  v_and_b32 v5, s34, v24
  v_sub_f32 v60, v60, v4
  v_sub_f32 v61, v61, v5
  v_lshlrev_b32 v4, 16, v25
  v_and_b32 v5, s34, v25
  v_sub_f32 v62, v62, v4
  v_sub_f32 v63, v63, v5
  ds_write_b64 v11, v[24:25] offset:512
  v_cvt_pk_bf16_f32 v60, v60, v61
  v_cvt_pk_bf16_f32 v61, v62, v63
  ds_write_b64 v15, v[60:61] offset:512
  v_cvt_pk_bf16_f32 v24, v64, v65
  v_cvt_pk_bf16_f32 v25, v66, v67
  v_lshlrev_b32 v4, 16, v24
  v_and_b32 v5, s34, v24
  v_sub_f32 v64, v64, v4
  v_sub_f32 v65, v65, v5
  v_lshlrev_b32 v4, 16, v25
  v_and_b32 v5, s34, v25
  v_sub_f32 v66, v66, v4
  v_sub_f32 v67, v67, v5
  ds_write_b64 v11, v[24:25] offset:1024
  v_cvt_pk_bf16_f32 v64, v64, v65
  v_cvt_pk_bf16_f32 v65, v66, v67
  ds_write_b64 v15, v[64:65] offset:1024
  v_cvt_pk_bf16_f32 v24, v68, v69
  v_cvt_pk_bf16_f32 v25, v70, v71
  v_lshlrev_b32 v4, 16, v24
  v_and_b32 v5, s34, v24
  v_sub_f32 v68, v68, v4
  v_sub_f32 v69, v69, v5
  v_lshlrev_b32 v4, 16, v25
  v_and_b32 v5, s34, v25
  v_sub_f32 v70, v70, v4
  v_sub_f32 v71, v71, v5
  ds_write_b64 v11, v[24:25] offset:1536
  v_cvt_pk_bf16_f32 v68, v68, v69
  v_cvt_pk_bf16_f32 v69, v70, v71
  ds_write_b64 v15, v[68:69] offset:1536
  v_cvt_pk_bf16_f32 v24, v72, v73
  v_cvt_pk_bf16_f32 v25, v74, v75
  v_lshlrev_b32 v4, 16, v24
  v_and_b32 v5, s34, v24
  v_sub_f32 v72, v72, v4
  v_sub_f32 v73, v73, v5
  v_lshlrev_b32 v4, 16, v25
  v_and_b32 v5, s34, v25
  v_sub_f32 v74, v74, v4
  v_sub_f32 v75, v75, v5
  ds_write_b64 v11, v[24:25] offset:2048
  v_cvt_pk_bf16_f32 v72, v72, v73
  v_cvt_pk_bf16_f32 v73, v74, v75
  ds_write_b64 v15, v[72:73] offset:2048
  v_cvt_pk_bf16_f32 v24, v76, v77
  v_cvt_pk_bf16_f32 v25, v78, v79
  v_lshlrev_b32 v4, 16, v24
  v_and_b32 v5, s34, v24
  v_sub_f32 v76, v76, v4
  v_sub_f32 v77, v77, v5
  v_lshlrev_b32 v4, 16, v25
  v_and_b32 v5, s34, v25
  v_sub_f32 v78, v78, v4
  v_sub_f32 v79, v79, v5
  ds_write_b64 v11, v[24:25] offset:2560
  v_cvt_pk_bf16_f32 v76, v76, v77
  v_cvt_pk_bf16_f32 v77, v78, v79
  ds_write_b64 v15, v[76:77] offset:2560
  v_cvt_pk_bf16_f32 v24, v80, v81
  v_cvt_pk_bf16_f32 v25, v82, v83
  v_lshlrev_b32 v4, 16, v24
  v_and_b32 v5, s34, v24
  v_sub_f32 v80, v80, v4
  v_sub_f32 v81, v81, v5
  v_lshlrev_b32 v4, 16, v25
  v_and_b32 v5, s34, v25
  v_sub_f32 v82, v82, v4
  v_sub_f32 v83, v83, v5
  ds_write_b64 v11, v[24:25] offset:3072
  v_cvt_pk_bf16_f32 v80, v80, v81
  v_cvt_pk_bf16_f32 v81, v82, v83
  ds_write_b64 v15, v[80:81] offset:3072
  v_cvt_pk_bf16_f32 v24, v84, v85
  v_cvt_pk_bf16_f32 v25, v86, v87
  v_lshlrev_b32 v4, 16, v24
  v_and_b32 v5, s34, v24
  v_sub_f32 v84, v84, v4
  v_sub_f32 v85, v85, v5
  v_lshlrev_b32 v4, 16, v25
  v_and_b32 v5, s34, v25
  v_sub_f32 v86, v86, v4
  v_sub_f32 v87, v87, v5
  ds_write_b64 v11, v[24:25] offset:3584
  v_cvt_pk_bf16_f32 v84, v84, v85
  v_cvt_pk_bf16_f32 v85, v86, v87
  ds_write_b64 v15, v[84:85] offset:3584
  v_add_u32 v11, s31, v2
  ds_write_b128 v11, v[88:91] offset:0
  ds_write_b128 v11, v[92:95] offset:1024
  ds_write_b128 v11, v[96:99] offset:2048
  ds_write_b128 v11, v[100:103] offset:3072
  ds_write_b128 v11, v[104:107] offset:8768
  ds_write_b128 v11, v[108:111] offset:9792
  ds_write_b128 v11, v[112:115] offset:10816
  ds_write_b128 v11, v[116:119] offset:11840
  s_mul_i32 s41, s28, 589824
  s_lshl_b32 s34, s29, 4
  s_add_u32 s35, s41, s34
  s_and_b32 s34, s28, 3
  s_lshl_b32 s34, s34, 10
  s_lshr_b32 s33, s28, 2
  s_mul_i32 s33, s33, 8768
  s_add_u32 s34, s34, s33
  v_add_u32 v11, s34, v2
  v_add_u32 v15, 51968, v11
  s_waitcnt lgkmcnt(0)
  s_barrier
  ds_read_b128 v[88:91], v11 offset:0
  ds_read_b128 v[92:95], v11 offset:12992
  ds_read_b128 v[96:99], v11 offset:25984
  ds_read_b128 v[100:103], v11 offset:38976
  ds_read_b128 v[104:107], v15 offset:0
  ds_read_b128 v[108:111], v15 offset:12992
  ds_read_b128 v[112:115], v15 offset:25984
  ds_read_b128 v[116:119], v15 offset:38976
  ds_read_b64_tr_b16 v[56:57], v34 offset:0
  ds_read_b64_tr_b16 v[58:59], v34 offset:51968
  ds_read_b64_tr_b16 v[72:73], v6 offset:0
  ds_read_b64_tr_b16 v[74:75], v6 offset:16640
  ds_read_b64_tr_b16 v[60:61], v34 offset:128
  ds_read_b64_tr_b16 v[62:63], v34 offset:52096
  ds_read_b64_tr_b16 v[76:77], v6 offset:128
  ds_read_b64_tr_b16 v[78:79], v6 offset:16768
  ds_read_b64_tr_b16 v[64:65], v34 offset:256
  ds_read_b64_tr_b16 v[66:67], v34 offset:52224
  ds_read_b64_tr_b16 v[80:81], v6 offset:256
  ds_read_b64_tr_b16 v[82:83], v6 offset:16896
  ds_read_b64_tr_b16 v[68:69], v34 offset:384
  ds_read_b64_tr_b16 v[70:71], v34 offset:52352
  ds_read_b64_tr_b16 v[84:85], v6 offset:384
  ds_read_b64_tr_b16 v[86:87], v6 offset:17024
  s_waitcnt lgkmcnt(12)
  s_mov_b32 s34, 0xffff0000
  v_lshlrev_b32 v24, 16, v56
  v_and_b32 v25, s34, v56
  v_lshlrev_b32 v4, 16, v72
  v_and_b32 v5, s34, v72
  v_add_f32 v24, v24, v4
  v_add_f32 v25, v25, v5
  v_lshlrev_b32 v4, 16, v40
  v_and_b32 v5, s34, v40
  v_mul_f32 v24, v24, v4
  v_mul_f32 v25, v25, v5
  v_cvt_pk_bf16_f32 v56, v24, v25
  v_lshlrev_b32 v24, 16, v57
  v_and_b32 v25, s34, v57
  v_lshlrev_b32 v4, 16, v73
  v_and_b32 v5, s34, v73
  v_add_f32 v24, v24, v4
  v_add_f32 v25, v25, v5
  v_lshlrev_b32 v4, 16, v41
  v_and_b32 v5, s34, v41
  v_mul_f32 v24, v24, v4
  v_mul_f32 v25, v25, v5
  v_cvt_pk_bf16_f32 v57, v24, v25
  v_lshlrev_b32 v24, 16, v58
  v_and_b32 v25, s34, v58
  v_lshlrev_b32 v4, 16, v74
  v_and_b32 v5, s34, v74
  v_add_f32 v24, v24, v4
  v_add_f32 v25, v25, v5
  v_lshlrev_b32 v4, 16, v42
  v_and_b32 v5, s34, v42
  v_mul_f32 v24, v24, v4
  v_mul_f32 v25, v25, v5
  v_cvt_pk_bf16_f32 v58, v24, v25
  v_lshlrev_b32 v24, 16, v59
  v_and_b32 v25, s34, v59
  v_lshlrev_b32 v4, 16, v75
  v_and_b32 v5, s34, v75
  v_add_f32 v24, v24, v4
  v_add_f32 v25, v25, v5
  v_lshlrev_b32 v4, 16, v43
  v_and_b32 v5, s34, v43
  v_mul_f32 v24, v24, v4
  v_mul_f32 v25, v25, v5
  v_cvt_pk_bf16_f32 v59, v24, v25
  buffer_store_dwordx4 v[56:59], v35, s[16:19], s35 offen
  s_add_u32 s35, s35, 147456
  s_waitcnt lgkmcnt(8)
  v_lshlrev_b32 v24, 16, v60
  v_and_b32 v25, s34, v60
  v_lshlrev_b32 v4, 16, v76
  v_and_b32 v5, s34, v76
  v_add_f32 v24, v24, v4
  v_add_f32 v25, v25, v5
  v_lshlrev_b32 v4, 16, v44
  v_and_b32 v5, s34, v44
  v_mul_f32 v24, v24, v4
  v_mul_f32 v25, v25, v5
  v_cvt_pk_bf16_f32 v60, v24, v25
  v_lshlrev_b32 v24, 16, v61
  v_and_b32 v25, s34, v61
  v_lshlrev_b32 v4, 16, v77
  v_and_b32 v5, s34, v77
  v_add_f32 v24, v24, v4
  v_add_f32 v25, v25, v5
  v_lshlrev_b32 v4, 16, v45
  v_and_b32 v5, s34, v45
  v_mul_f32 v24, v24, v4
  v_mul_f32 v25, v25, v5
  v_cvt_pk_bf16_f32 v61, v24, v25
  v_lshlrev_b32 v24, 16, v62
  v_and_b32 v25, s34, v62
  v_lshlrev_b32 v4, 16, v78
  v_and_b32 v5, s34, v78
  v_add_f32 v24, v24, v4
  v_add_f32 v25, v25, v5
  v_lshlrev_b32 v4, 16, v46
  v_and_b32 v5, s34, v46
  v_mul_f32 v24, v24, v4
  v_mul_f32 v25, v25, v5
  v_cvt_pk_bf16_f32 v62, v24, v25
  v_lshlrev_b32 v24, 16, v63
  v_and_b32 v25, s34, v63
  v_lshlrev_b32 v4, 16, v79
  v_and_b32 v5, s34, v79
  v_add_f32 v24, v24, v4
  v_add_f32 v25, v25, v5
  v_lshlrev_b32 v4, 16, v47
  v_and_b32 v5, s34, v47
  v_mul_f32 v24, v24, v4
  v_mul_f32 v25, v25, v5
  v_cvt_pk_bf16_f32 v63, v24, v25
  buffer_store_dwordx4 v[60:63], v35, s[16:19], s35 offen
  s_add_u32 s35, s35, 147456
  s_waitcnt lgkmcnt(4)
  v_lshlrev_b32 v24, 16, v64
  v_and_b32 v25, s34, v64
  v_lshlrev_b32 v4, 16, v80
  v_and_b32 v5, s34, v80
  v_add_f32 v24, v24, v4
  v_add_f32 v25, v25, v5
  v_lshlrev_b32 v4, 16, v48
  v_and_b32 v5, s34, v48
  v_mul_f32 v24, v24, v4
  v_mul_f32 v25, v25, v5
  v_cvt_pk_bf16_f32 v64, v24, v25
  v_lshlrev_b32 v24, 16, v65
  v_and_b32 v25, s34, v65
  v_lshlrev_b32 v4, 16, v81
  v_and_b32 v5, s34, v81
  v_add_f32 v24, v24, v4
  v_add_f32 v25, v25, v5
  v_lshlrev_b32 v4, 16, v49
  v_and_b32 v5, s34, v49
  v_mul_f32 v24, v24, v4
  v_mul_f32 v25, v25, v5
  v_cvt_pk_bf16_f32 v65, v24, v25
  v_lshlrev_b32 v24, 16, v66
  v_and_b32 v25, s34, v66
  v_lshlrev_b32 v4, 16, v82
  v_and_b32 v5, s34, v82
  v_add_f32 v24, v24, v4
  v_add_f32 v25, v25, v5
  v_lshlrev_b32 v4, 16, v50
  v_and_b32 v5, s34, v50
  v_mul_f32 v24, v24, v4
  v_mul_f32 v25, v25, v5
  v_cvt_pk_bf16_f32 v66, v24, v25
  v_lshlrev_b32 v24, 16, v67
  v_and_b32 v25, s34, v67
  v_lshlrev_b32 v4, 16, v83
  v_and_b32 v5, s34, v83
  v_add_f32 v24, v24, v4
  v_add_f32 v25, v25, v5
  v_lshlrev_b32 v4, 16, v51
  v_and_b32 v5, s34, v51
  v_mul_f32 v24, v24, v4
  v_mul_f32 v25, v25, v5
  v_cvt_pk_bf16_f32 v67, v24, v25
  buffer_store_dwordx4 v[64:67], v35, s[16:19], s35 offen
  s_add_u32 s35, s35, 147456
  s_waitcnt lgkmcnt(0)
  v_lshlrev_b32 v24, 16, v68
  v_and_b32 v25, s34, v68
  v_lshlrev_b32 v4, 16, v84
  v_and_b32 v5, s34, v84
  v_add_f32 v24, v24, v4
  v_add_f32 v25, v25, v5
  v_lshlrev_b32 v4, 16, v52
  v_and_b32 v5, s34, v52
  v_mul_f32 v24, v24, v4
  v_mul_f32 v25, v25, v5
  v_cvt_pk_bf16_f32 v68, v24, v25
  v_lshlrev_b32 v24, 16, v69
  v_and_b32 v25, s34, v69
  v_lshlrev_b32 v4, 16, v85
  v_and_b32 v5, s34, v85
  v_add_f32 v24, v24, v4
  v_add_f32 v25, v25, v5
  v_lshlrev_b32 v4, 16, v53
  v_and_b32 v5, s34, v53
  v_mul_f32 v24, v24, v4
  v_mul_f32 v25, v25, v5
  v_cvt_pk_bf16_f32 v69, v24, v25
  v_lshlrev_b32 v24, 16, v70
  v_and_b32 v25, s34, v70
  v_lshlrev_b32 v4, 16, v86
  v_and_b32 v5, s34, v86
  v_add_f32 v24, v24, v4
  v_add_f32 v25, v25, v5
  v_lshlrev_b32 v4, 16, v54
  v_and_b32 v5, s34, v54
  v_mul_f32 v24, v24, v4
  v_mul_f32 v25, v25, v5
  v_cvt_pk_bf16_f32 v70, v24, v25
  v_lshlrev_b32 v24, 16, v71
  v_and_b32 v25, s34, v71
  v_lshlrev_b32 v4, 16, v87
  v_and_b32 v5, s34, v87
  v_add_f32 v24, v24, v4
  v_add_f32 v25, v25, v5
  v_lshlrev_b32 v4, 16, v55
  v_and_b32 v5, s34, v55
  v_mul_f32 v24, v24, v4
  v_mul_f32 v25, v25, v5
  v_cvt_pk_bf16_f32 v71, v24, v25
  buffer_store_dwordx4 v[68:71], v35, s[16:19], s35 offen
  s_add_u32 s35, s35, 147456
  v_add_f32 v88, v88, v104
  v_add_f32 v89, v89, v105
  v_add_f32 v90, v90, v106
  v_add_f32 v91, v91, v107
  v_add_f32 v92, v92, v108
  v_add_f32 v93, v93, v109
  v_add_f32 v94, v94, v110
  v_add_f32 v95, v95, v111
  v_add_f32 v96, v96, v112
  v_add_f32 v97, v97, v113
  v_add_f32 v98, v98, v114
  v_add_f32 v99, v99, v115
  v_add_f32 v100, v100, v116
  v_add_f32 v101, v101, v117
  v_add_f32 v102, v102, v118
  v_add_f32 v103, v103, v119
  v_add_f32 v88, v88, v96
  v_add_f32 v89, v89, v97
  v_add_f32 v90, v90, v98
  v_add_f32 v91, v91, v99
  v_add_f32 v92, v92, v100
  v_add_f32 v93, v93, v101
  v_add_f32 v94, v94, v102
  v_add_f32 v95, v95, v103
  v_add_f32 v88, v88, v92
  v_add_f32 v89, v89, v93
  v_add_f32 v90, v90, v94
  v_add_f32 v91, v91, v95
  s_mov_b32 s34, 0xffff0000
  v_lshlrev_b32 v24, 16, v132
  v_lshlrev_b32 v25, 16, v133
  v_lshlrev_b32 v4, 16, v134
  v_lshlrev_b32 v5, 16, v135
  v_mul_f32 v88, v88, v24
  v_mul_f32 v89, v89, v25
  v_mul_f32 v90, v90, v4
  v_mul_f32 v91, v91, v5
  v_cvt_pk_bf16_f32 v88, v88, v89
  v_cvt_pk_bf16_f32 v89, v90, v91
  v_mul_u32_u24 v24, 1152, v10
  s_lshl_b32 s34, s40, 1
  s_add_u32 s41, s41, s34
  s_add_u32 s34, s41, 4608
  buffer_store_short v88, v24, s[16:19], s41 offen
  buffer_store_short_d16_hi v88, v24, s[16:19], s41 offen offset:2304
  buffer_store_short v89, v24, s[16:19], s34 offen
  buffer_store_short_d16_hi v89, v24, s[16:19], s34 offen offset:2304
T_FIN:
F1_END:
  s_endpgm
.section .rodata,"a"
.p2align 6
.amdhsa_kernel concat_heads__ssm_conv_h3__compressed_kv_cla__prompt_kernel
.amdhsa_next_free_vgpr 256
.amdhsa_next_free_sgpr 102
.amdhsa_accum_offset 144
.amdhsa_group_segment_fixed_size 0
.amdhsa_kernarg_size 120
.amdhsa_user_sgpr_count 2
.amdhsa_user_sgpr_kernarg_segment_ptr 1
.amdhsa_system_sgpr_workgroup_id_x 1
.end_amdhsa_kernel
.text
```
